```python
import torch

def _softmax(x, axis=-1):
    return torch.softmax(x, dim=axis)
def _gelu(x):
    return torch.nn.functional.gelu(x, approximate="tanh")
def _silu(x):
    return torch.nn.functional.silu(x)
def _sigmoid(x):
    return torch.sigmoid(x)
def _layernorm(x, axis=-1, eps=1e-5):
    m = x.mean(dim=axis, keepdim=True)
    v = x.var(dim=axis, keepdim=True, unbiased=False)
    return (x - m) / torch.sqrt(v + eps)
def _scatter_add(tgt, idx, src, axis=0):
    return tgt.clone().index_add_(axis, idx, src)
def _segment_sum(src, seg, n):
    out = torch.zeros((n,) + src.shape[1:], dtype=src.dtype)
    return out.index_add_(0, seg, src)
def _pad(x, pw):
    flat = tuple(v for pair in reversed(pw) for v in pair)
    return torch.nn.functional.pad(x, flat)

kernel_name = 'gated_mix__linear_attn_block__dense_activation_relu__prompt'

def setup_inputs():

    _w = (lambda a: (lambda t: t.to(torch.bfloat16) if t.is_floating_point() else t)(torch.as_tensor(a)))
    def _A_setup():
        B, S, D = 1, 2048, 1024
        return {
            "x": _w((lambda *s: torch.randn(*s, dtype=torch.bfloat16) * 0.05)(B, S, D)),
            "wqkv": _w((lambda *s: torch.randn(*s, dtype=torch.bfloat16) * 0.8)(D, 3 * D)),
            "wo": _w((lambda *s: torch.randn(*s, dtype=torch.bfloat16) * 0.2)(D, D)),
        }
    _A_in = _A_setup()

    def _B_setup():
        B, S, D, Dff = 1, 2048, 1024, 3584
        return {
            "x": _w((lambda *s: torch.randn(*s, dtype=torch.bfloat16) * 0.05)(B, S, D)),
            "w1": _w((lambda *s: torch.randn(*s, dtype=torch.bfloat16) * 0.05)(D, Dff)),
            "w2": _w((lambda *s: torch.randn(*s, dtype=torch.bfloat16) * 0.05)(Dff, D)),
        }
    _B_in = _B_setup()

    return {
        "A_x": _A_in["x"],
        "A_wqkv": _A_in["wqkv"],
        "A_wo": _A_in["wo"],
        "B_x": _B_in["x"],
        "B_w1": _B_in["w1"],
        "B_w2": _B_in["w2"],
        "gate_w": _w((lambda *s: torch.randn(*s, dtype=torch.bfloat16) * 0.05)(1024) * 16.0),
    }

def reference(A_x, A_wqkv, A_wo, B_x, B_w1, B_w2, gate_w):
    def _A_ref(x, wqkv, wo):
        B, S, D = x.shape
        H = 32; Dh = D // H
        qkv = (lambda x, *d: x.permute(*d))((x @ wqkv).reshape(B, S, 3, H, Dh), 2, 0, 3, 1, 4)
        q, k, v = qkv[0], qkv[1], qkv[2]
        phi = lambda t: torch.where(t > 0, t + 1, torch.exp(t)) + 1e-6
        pq, pk = phi(q), phi(k)
        kv = torch.einsum("bhsd,bhse->bhde", pk, v)
        z = torch.einsum("bhsd->bhd", pk)
        num = torch.einsum("bhqd,bhde->bhqe", pq, kv)
        den = torch.einsum("bhqd,bhd->bhq", pq, z)[..., None] + 1e-6
        o = num / den
        return (lambda x, *d: x.permute(*d))(o, 0, 2, 1, 3).reshape(B, S, D) @ wo

    def _B_ref(x, w1, w2):
        h = torch.einsum("bsd,df->bsf", x, w1)
        zero = torch.zeros_like(h)
        h = torch.maximum(h, zero)
        return torch.einsum("bsf,fd->bsd", h, w2)

    x = A_x
    g = _sigmoid((x * gate_w).sum(-1, keepdims=True))
    a = _A_ref(x, A_wqkv, A_wo)
    b = _B_ref(x, B_w1, B_w2)
    return g * a + (1 - g) * b
```

```asm
; @launch grid=(256,1,1) block=(512,1,1) lds=163840
.amdgcn_target "amdgcn-amd-amdhsa--gfx950"
.text
.globl gated_mix__linear_attn_block__dense_activation_relu__prompt_kernel
.p2align 8
.type gated_mix__linear_attn_block__dense_activation_relu__prompt_kernel,@function
gated_mix__linear_attn_block__dense_activation_relu__prompt_kernel:
    s_cmp_ge_u32 s2, 256
    s_cbranch_scc1 L_exit
    s_load_dwordx16 s[4:19], s[0:1], 0
    s_getpc_b64 s[96:97]
L_pc:
    s_mov_b32 s98, L_codeend-L_pc
    s_mov_b32 s99, 0x20000
    s_lshr_b32 s30, s2, 3
    s_lshl_b32 s100, s30, 11
    v_lshlrev_b32 v1, 2, v0
    buffer_load_dword v47, v1, s[96:99], s100 offen
    s_load_dwordx4 s[24:27], s[0:1], 64
    v_lshrrev_b32 v1, 6, v0
    v_and_b32 v0, 63, v0
    s_and_b32 s44, s2, 7
    v_readfirstlane_b32 s3, v1
    s_lshr_b32 s31, s44, 2
    s_and_b32 s32, s44, 3
    s_xor_b32 s3, s3, 4
    s_and_b32 s33, s30, 3
    s_lshl_b32 s36, s31, 2
    s_add_u32 s36, s36, s33
    s_lshr_b32 s33, s30, 2
    s_lshr_b32 s34, s33, 2
    s_lshl_b32 s37, s32, 1
    s_add_u32 s37, s37, s34
    s_and_b32 s38, s33, 3
    s_and_b32 s34, s33, 1
    s_lshl_b32 s39, s37, 1
    s_add_u32 s39, s39, s34
    s_and_b32 s40, s32, 1
    s_xor_b32 s41, s33, 2
    s_lshr_b32 s42, s32, 1
    s_xor_b32 s34, s31, s36
    s_xor_b32 s34, s34, 0
    s_and_b32 s34, s34, 1
    s_lshl_b32 s43, s34, 13
    s_cmp_lt_u32 s3, 4
    s_cbranch_scc1 L_compute
    s_cmp_lt_u32 s3, 6
    s_cbranch_scc1 L_loader
    s_mov_b32 s68, s30
    s_mov_b32 s87, s31
    s_branch L_helper
L_loader:
    s_sub_u32 s45, s3, 4
    v_lshrrev_b32 v1, 5, v0
    v_bfe_u32 v2, v0, 4, 1
    v_lshlrev_b32 v1, 4, v1
    v_lshl_add_u32 v1, v2, 2, v1
    v_bfe_u32 v2, v0, 3, 1
    v_add_u32 v1, v1, v2
    s_lshl_b32 s61, s45, 3
    v_add_u32 v1, s61, v1
    v_and_b32 v2, 7, v0
    v_lshlrev_b32 v2, 4, v2
    s_lshl_b32 s61, s36, 19
    v_lshl_add_u32 v4, v1, 11, v2
    v_add_u32 v4, s61, v4
    v_add_u32 v5, 3040, v4
    s_mul_i32 s66, s45, 2112
    s_mov_b32 s61, s66
    s_mov_b32 s62, 0
    s_mov_b32 s63, 0
    s_mov_b32 s64, 0
    s_add_u32 s65, s66, 101376
    s_add_u32 s67, s66, 101376
    s_add_u32 s68, s66, 156160
    s_lshl_b32 s69, s45, 9
    s_sub_u32 s69, s69, s66
    s_add_u32 s69, s69, 12672
    s_mov_b32 s30, 0x400000
    s_mov_b32 s31, 0x20000
    s_mov_b32 s50, 0x600000
    s_mov_b32 s51, 0x20000
    s_mov_b32 s58, 0x700000
    s_mov_b32 s59, 0x20000
    s_mov_b32 s55, 0x20000
    s_waitcnt lgkmcnt(0)
    s_mov_b64 s[28:29], s[4:5]
    s_mov_b64 s[48:49], s[6:7]
    s_mov_b64 s[56:57], s[12:13]
    s_cmp_ge_u32 s38, 2
    s_cselect_b64 s[52:53], s[12:13], s[6:7]
    s_cselect_b32 s54, s58, s50
    s_mov_b32 m0, s61
    s_add_u32 s46, s62, s63
    buffer_load_dwordx4 v4, s[28:31], s46 offen lds
    buffer_load_dwordx4 v5, s[28:31], s46 offen offset:1056 lds
    s_add_u32 m0, m0, 4224
    s_add_u32 s46, s46, 0x10000
    buffer_load_dwordx4 v4, s[28:31], s46 offen lds
    buffer_load_dwordx4 v5, s[28:31], s46 offen offset:1056 lds
    s_add_u32 m0, m0, 4224
    s_add_u32 s46, s46, 0x10000
    buffer_load_dwordx4 v4, s[28:31], s46 offen lds
    buffer_load_dwordx4 v5, s[28:31], s46 offen offset:1056 lds
    s_add_u32 m0, m0, 4224
    s_add_u32 s46, s46, 0x10000
    buffer_load_dwordx4 v4, s[28:31], s46 offen lds
    buffer_load_dwordx4 v5, s[28:31], s46 offen offset:1056 lds
    s_add_u32 s61, s61, 16896
    s_cmp_eq_u32 s61, s67
    s_cselect_b32 s61, s66, s61
    s_xor_b32 s63, s63, 0x40000
    s_cselect_b32 s47, 0, 128
    s_add_u32 s62, s62, s47
    s_and_b32 s62, s62, 2047
    s_mov_b32 m0, s61
    s_add_u32 s46, s62, s63
    buffer_load_dwordx4 v4, s[28:31], s46 offen lds
    buffer_load_dwordx4 v5, s[28:31], s46 offen offset:1056 lds
    s_add_u32 m0, m0, 4224
    s_add_u32 s46, s46, 0x10000
    buffer_load_dwordx4 v4, s[28:31], s46 offen lds
    buffer_load_dwordx4 v5, s[28:31], s46 offen offset:1056 lds
    s_add_u32 m0, m0, 4224
    s_add_u32 s46, s46, 0x10000
    buffer_load_dwordx4 v4, s[28:31], s46 offen lds
    buffer_load_dwordx4 v5, s[28:31], s46 offen offset:1056 lds
    s_add_u32 m0, m0, 4224
    s_add_u32 s46, s46, 0x10000
    buffer_load_dwordx4 v4, s[28:31], s46 offen lds
    buffer_load_dwordx4 v5, s[28:31], s46 offen offset:1056 lds
    s_add_u32 s61, s61, 16896
    s_cmp_eq_u32 s61, s67
    s_cselect_b32 s61, s66, s61
    s_xor_b32 s63, s63, 0x40000
    s_cselect_b32 s47, 0, 128
    s_add_u32 s62, s62, s47
    s_and_b32 s62, s62, 2047
    s_movk_i32 s60, 6144
    s_cmp_ge_u32 s38, 2
    s_cselect_b32 s60, 7168, s60
    s_cselect_b32 s82, 0, 2048
    s_lshl_b32 s83, s39, 7
    s_add_u32 s82, s82, s83
    v_mul_u32_u24 v6, 6144, v1
    v_add3_u32 v6, v6, v2, s82
    v_add_u32 v7, 11232, v6
    s_mul_i32 s84, s37, 7
    s_lshl_b32 s85, s38, 1
    s_add_u32 s85, s85, s84
    s_sub_u32 s86, s85, 2
    s_lshl_b32 s86, s86, 7
    s_add_u32 s83, s83, 4096
    s_cmp_ge_u32 s38, 2
    s_cselect_b32 s82, s86, s83
    v_mul_lo_u32 v8, v1, s60
    v_add3_u32 v8, v8, v2, s82
    s_lshl_b32 s83, s60, 1
    s_sub_u32 s83, s83, 1056
    v_add_u32 v9, s83, v8
    s_sub_u32 s85, s85, 1
    s_add_u32 s86, s84, s38
    s_cmp_ge_u32 s38, 2
    s_cselect_b32 s82, s85, s86
    s_lshl_b32 s82, s82, 7
    v_mul_u32_u24 v10, 7168, v1
    v_add3_u32 v10, v10, v2, s82
    v_add_u32 v11, 13280, v10
    v_bfe_u32 v12, v0, 4, 1
    v_bfe_u32 v13, v0, 3, 1
    v_lshlrev_b32 v12, 2, v12
    v_lshl_add_u32 v12, v13, 3, v12
    v_bfe_u32 v13, v0, 1, 2
    v_add_u32 v12, v12, v13
    s_lshl_b32 s82, s45, 4
    v_add_u32 v12, s82, v12
    v_mul_u32_u24 v12, 7168, v12
    v_and_b32 v13, 1, v0
    v_lshl_add_u32 v12, v13, 4, v12
    s_add_u32 s82, s84, 6
    s_lshl_b32 s82, s82, 7
    s_lshl_b32 s83, s38, 5
    s_add_u32 s82, s82, s83
    v_add_u32 v12, s82, v12
    s_lshl_b32 s60, s60, 5
    s_add_u32 m0, s65, 0
    s_mul_i32 s35, s64, 196608
    buffer_load_dwordx4 v6, s[48:51], s35 offen lds
    buffer_load_dwordx4 v7, s[48:51], s35 offen offset:1056 lds
    s_add_u32 m0, s65, 4224
    s_mul_i32 s35, s64, s60
    buffer_load_dwordx4 v8, s[52:55], s35 offen lds
    buffer_load_dwordx4 v9, s[52:55], s35 offen offset:1056 lds
    s_add_u32 m0, s65, 8448
    s_mul_i32 s35, s64, 229376
    buffer_load_dwordx4 v10, s[56:59], s35 offen lds
    buffer_load_dwordx4 v11, s[56:59], s35 offen offset:1056 lds
    s_add_u32 m0, s65, s69
    s_mov_b32 exec_hi, 0
    buffer_load_dwordx4 v12, s[56:59], s35 offen lds
    s_mov_b32 exec_hi, -1
    s_add_u32 s65, s65, 13696
    s_cmp_eq_u32 s65, s68
    s_cselect_b32 s65, s67, s65
    s_add_u32 s64, s64, 1
    s_and_b32 s64, s64, 31
    s_add_u32 m0, s65, 0
    s_mul_i32 s35, s64, 196608
    buffer_load_dwordx4 v6, s[48:51], s35 offen lds
    buffer_load_dwordx4 v7, s[48:51], s35 offen offset:1056 lds
    s_add_u32 m0, s65, 4224
    s_mul_i32 s35, s64, s60
    buffer_load_dwordx4 v8, s[52:55], s35 offen lds
    buffer_load_dwordx4 v9, s[52:55], s35 offen offset:1056 lds
    s_add_u32 m0, s65, 8448
    s_mul_i32 s35, s64, 229376
    buffer_load_dwordx4 v10, s[56:59], s35 offen lds
    buffer_load_dwordx4 v11, s[56:59], s35 offen offset:1056 lds
    s_add_u32 m0, s65, s69
    s_mov_b32 exec_hi, 0
    buffer_load_dwordx4 v12, s[56:59], s35 offen lds
    s_mov_b32 exec_hi, -1
    s_add_u32 s65, s65, 13696
    s_cmp_eq_u32 s65, s68
    s_cselect_b32 s65, s67, s65
    s_add_u32 s64, s64, 1
    s_and_b32 s64, s64, 31
    s_waitcnt vmcnt(7)
    s_barrier
    s_mov_b32 m0, s61
    s_add_u32 s46, s62, s63
    buffer_load_dwordx4 v4, s[28:31], s46 offen lds
    buffer_load_dwordx4 v5, s[28:31], s46 offen offset:1056 lds
    s_add_u32 m0, m0, 4224
    s_add_u32 s46, s46, 0x10000
    buffer_load_dwordx4 v4, s[28:31], s46 offen lds
    buffer_load_dwordx4 v5, s[28:31], s46 offen offset:1056 lds
    s_add_u32 m0, m0, 4224
    s_add_u32 s46, s46, 0x10000
    buffer_load_dwordx4 v4, s[28:31], s46 offen lds
    buffer_load_dwordx4 v5, s[28:31], s46 offen offset:1056 lds
    s_add_u32 m0, m0, 4224
    s_add_u32 s46, s46, 0x10000
    buffer_load_dwordx4 v4, s[28:31], s46 offen lds
    buffer_load_dwordx4 v5, s[28:31], s46 offen offset:1056 lds
    s_add_u32 s61, s61, 16896
    s_cmp_eq_u32 s61, s67
    s_cselect_b32 s61, s66, s61
    s_xor_b32 s63, s63, 0x40000
    s_cselect_b32 s47, 0, 128
    s_add_u32 s62, s62, s47
    s_and_b32 s62, s62, 2047
    s_mov_b32 m0, s61
    s_add_u32 s46, s62, s63
    buffer_load_dwordx4 v4, s[28:31], s46 offen lds
    buffer_load_dwordx4 v5, s[28:31], s46 offen offset:1056 lds
    s_add_u32 m0, m0, 4224
    s_add_u32 s46, s46, 0x10000
    buffer_load_dwordx4 v4, s[28:31], s46 offen lds
    buffer_load_dwordx4 v5, s[28:31], s46 offen offset:1056 lds
    s_add_u32 m0, m0, 4224
    s_add_u32 s46, s46, 0x10000
    buffer_load_dwordx4 v4, s[28:31], s46 offen lds
    buffer_load_dwordx4 v5, s[28:31], s46 offen offset:1056 lds
    s_add_u32 m0, m0, 4224
    s_add_u32 s46, s46, 0x10000
    buffer_load_dwordx4 v4, s[28:31], s46 offen lds
    buffer_load_dwordx4 v5, s[28:31], s46 offen offset:1056 lds
    s_add_u32 s61, s61, 16896
    s_cmp_eq_u32 s61, s67
    s_cselect_b32 s61, s66, s61
    s_xor_b32 s63, s63, 0x40000
    s_cselect_b32 s47, 0, 128
    s_add_u32 s62, s62, s47
    s_and_b32 s62, s62, 2047
    s_add_u32 m0, s65, 0
    s_mul_i32 s35, s64, 196608
    buffer_load_dwordx4 v6, s[48:51], s35 offen lds
    buffer_load_dwordx4 v7, s[48:51], s35 offen offset:1056 lds
    s_add_u32 m0, s65, 4224
    s_mul_i32 s35, s64, s60
    buffer_load_dwordx4 v8, s[52:55], s35 offen lds
    buffer_load_dwordx4 v9, s[52:55], s35 offen offset:1056 lds
    s_add_u32 m0, s65, 8448
    s_mul_i32 s35, s64, 229376
    buffer_load_dwordx4 v10, s[56:59], s35 offen lds
    buffer_load_dwordx4 v11, s[56:59], s35 offen offset:1056 lds
    s_add_u32 m0, s65, s69
    s_mov_b32 exec_hi, 0
    buffer_load_dwordx4 v12, s[56:59], s35 offen lds
    s_mov_b32 exec_hi, -1
    s_add_u32 s65, s65, 13696
    s_cmp_eq_u32 s65, s68
    s_cselect_b32 s65, s67, s65
    s_add_u32 s64, s64, 1
    s_and_b32 s64, s64, 31
    s_waitcnt vmcnt(23)
    s_barrier
    s_add_u32 m0, s65, 0
    s_mul_i32 s35, s64, 196608
    buffer_load_dwordx4 v6, s[48:51], s35 offen lds
    buffer_load_dwordx4 v7, s[48:51], s35 offen offset:1056 lds
    s_add_u32 m0, s65, 4224
    s_mul_i32 s35, s64, s60
    buffer_load_dwordx4 v8, s[52:55], s35 offen lds
    buffer_load_dwordx4 v9, s[52:55], s35 offen offset:1056 lds
    s_add_u32 m0, s65, 8448
    s_mul_i32 s35, s64, 229376
    buffer_load_dwordx4 v10, s[56:59], s35 offen lds
    buffer_load_dwordx4 v11, s[56:59], s35 offen offset:1056 lds
    s_add_u32 m0, s65, s69
    s_mov_b32 exec_hi, 0
    buffer_load_dwordx4 v12, s[56:59], s35 offen lds
    s_mov_b32 exec_hi, -1
    s_add_u32 s65, s65, 13696
    s_cmp_eq_u32 s65, s68
    s_cselect_b32 s65, s67, s65
    s_add_u32 s64, s64, 1
    s_and_b32 s64, s64, 31
    s_mov_b32 m0, s61
    s_add_u32 s46, s62, s63
    buffer_load_dwordx4 v4, s[28:31], s46 offen lds
    buffer_load_dwordx4 v5, s[28:31], s46 offen offset:1056 lds
    s_add_u32 m0, m0, 4224
    s_add_u32 s46, s46, 0x10000
    buffer_load_dwordx4 v4, s[28:31], s46 offen lds
    buffer_load_dwordx4 v5, s[28:31], s46 offen offset:1056 lds
    s_add_u32 m0, m0, 4224
    s_add_u32 s46, s46, 0x10000
    buffer_load_dwordx4 v4, s[28:31], s46 offen lds
    buffer_load_dwordx4 v5, s[28:31], s46 offen offset:1056 lds
    s_add_u32 m0, m0, 4224
    s_add_u32 s46, s46, 0x10000
    buffer_load_dwordx4 v4, s[28:31], s46 offen lds
    buffer_load_dwordx4 v5, s[28:31], s46 offen offset:1056 lds
    s_add_u32 s61, s61, 16896
    s_cmp_eq_u32 s61, s67
    s_cselect_b32 s61, s66, s61
    s_xor_b32 s63, s63, 0x40000
    s_cselect_b32 s47, 0, 128
    s_add_u32 s62, s62, s47
    s_and_b32 s62, s62, 2047
    s_add_u32 m0, s65, 0
    s_mul_i32 s35, s64, 196608
    buffer_load_dwordx4 v6, s[48:51], s35 offen lds
    buffer_load_dwordx4 v7, s[48:51], s35 offen offset:1056 lds
    s_add_u32 m0, s65, 4224
    s_mul_i32 s35, s64, s60
    buffer_load_dwordx4 v8, s[52:55], s35 offen lds
    buffer_load_dwordx4 v9, s[52:55], s35 offen offset:1056 lds
    s_add_u32 m0, s65, 8448
    s_mul_i32 s35, s64, 229376
    buffer_load_dwordx4 v10, s[56:59], s35 offen lds
    buffer_load_dwordx4 v11, s[56:59], s35 offen offset:1056 lds
    s_add_u32 m0, s65, s69
    s_mov_b32 exec_hi, 0
    buffer_load_dwordx4 v12, s[56:59], s35 offen lds
    s_mov_b32 exec_hi, -1
    s_add_u32 s65, s65, 13696
    s_cmp_eq_u32 s65, s68
    s_cselect_b32 s65, s67, s65
    s_add_u32 s64, s64, 1
    s_and_b32 s64, s64, 31
    s_waitcnt vmcnt(22)
    s_barrier
    s_mov_b32 m0, s61
    s_add_u32 s46, s62, s63
    buffer_load_dwordx4 v4, s[28:31], s46 offen lds
    buffer_load_dwordx4 v5, s[28:31], s46 offen offset:1056 lds
    s_add_u32 m0, m0, 4224
    s_add_u32 s46, s46, 0x10000
    buffer_load_dwordx4 v4, s[28:31], s46 offen lds
    buffer_load_dwordx4 v5, s[28:31], s46 offen offset:1056 lds
    s_add_u32 m0, m0, 4224
    s_add_u32 s46, s46, 0x10000
    buffer_load_dwordx4 v4, s[28:31], s46 offen lds
    buffer_load_dwordx4 v5, s[28:31], s46 offen offset:1056 lds
    s_add_u32 m0, m0, 4224
    s_add_u32 s46, s46, 0x10000
    buffer_load_dwordx4 v4, s[28:31], s46 offen lds
    buffer_load_dwordx4 v5, s[28:31], s46 offen offset:1056 lds
    s_add_u32 s61, s61, 16896
    s_cmp_eq_u32 s61, s67
    s_cselect_b32 s61, s66, s61
    s_xor_b32 s63, s63, 0x40000
    s_cselect_b32 s47, 0, 128
    s_add_u32 s62, s62, s47
    s_and_b32 s62, s62, 2047
    s_add_u32 m0, s65, 0
    s_mul_i32 s35, s64, 196608
    buffer_load_dwordx4 v6, s[48:51], s35 offen lds
    buffer_load_dwordx4 v7, s[48:51], s35 offen offset:1056 lds
    s_add_u32 m0, s65, 4224
    s_mul_i32 s35, s64, s60
    buffer_load_dwordx4 v8, s[52:55], s35 offen lds
    buffer_load_dwordx4 v9, s[52:55], s35 offen offset:1056 lds
    s_add_u32 m0, s65, 8448
    s_mul_i32 s35, s64, 229376
    buffer_load_dwordx4 v10, s[56:59], s35 offen lds
    buffer_load_dwordx4 v11, s[56:59], s35 offen offset:1056 lds
    s_add_u32 m0, s65, s69
    s_mov_b32 exec_hi, 0
    buffer_load_dwordx4 v12, s[56:59], s35 offen lds
    s_mov_b32 exec_hi, -1
    s_add_u32 s65, s65, 13696
    s_cmp_eq_u32 s65, s68
    s_cselect_b32 s65, s67, s65
    s_add_u32 s64, s64, 1
    s_and_b32 s64, s64, 31
    s_mov_b32 m0, s61
    s_add_u32 s46, s62, s63
    buffer_load_dwordx4 v4, s[28:31], s46 offen lds
    buffer_load_dwordx4 v5, s[28:31], s46 offen offset:1056 lds
    s_add_u32 m0, m0, 4224
    s_add_u32 s46, s46, 0x10000
    buffer_load_dwordx4 v4, s[28:31], s46 offen lds
    buffer_load_dwordx4 v5, s[28:31], s46 offen offset:1056 lds
    s_add_u32 m0, m0, 4224
    s_add_u32 s46, s46, 0x10000
    buffer_load_dwordx4 v4, s[28:31], s46 offen lds
    buffer_load_dwordx4 v5, s[28:31], s46 offen offset:1056 lds
    s_add_u32 m0, m0, 4224
    s_add_u32 s46, s46, 0x10000
    buffer_load_dwordx4 v4, s[28:31], s46 offen lds
    buffer_load_dwordx4 v5, s[28:31], s46 offen offset:1056 lds
    s_add_u32 s61, s61, 16896
    s_cmp_eq_u32 s61, s67
    s_cselect_b32 s61, s66, s61
    s_xor_b32 s63, s63, 0x40000
    s_cselect_b32 s47, 0, 128
    s_add_u32 s62, s62, s47
    s_and_b32 s62, s62, 2047
    s_mov_b32 s34, 19
L_l1:
    s_waitcnt vmcnt(30)
    s_barrier
    s_add_u32 m0, s65, 0
    s_mul_i32 s35, s64, 196608
    buffer_load_dwordx4 v6, s[48:51], s35 offen lds
    buffer_load_dwordx4 v7, s[48:51], s35 offen offset:1056 lds
    s_add_u32 m0, s65, 4224
    s_mul_i32 s35, s64, s60
    buffer_load_dwordx4 v8, s[52:55], s35 offen lds
    buffer_load_dwordx4 v9, s[52:55], s35 offen offset:1056 lds
    s_add_u32 m0, s65, 8448
    s_mul_i32 s35, s64, 229376
    buffer_load_dwordx4 v10, s[56:59], s35 offen lds
    buffer_load_dwordx4 v11, s[56:59], s35 offen offset:1056 lds
    s_add_u32 m0, s65, s69
    s_mov_b32 exec_hi, 0
    buffer_load_dwordx4 v12, s[56:59], s35 offen lds
    s_mov_b32 exec_hi, -1
    s_add_u32 s65, s65, 13696
    s_cmp_eq_u32 s65, s68
    s_cselect_b32 s65, s67, s65
    s_add_u32 s64, s64, 1
    s_and_b32 s64, s64, 31
    s_mov_b32 m0, s61
    s_add_u32 s46, s62, s63
    buffer_load_dwordx4 v4, s[28:31], s46 offen lds
    buffer_load_dwordx4 v5, s[28:31], s46 offen offset:1056 lds
    s_add_u32 m0, m0, 4224
    s_add_u32 s46, s46, 0x10000
    buffer_load_dwordx4 v4, s[28:31], s46 offen lds
    buffer_load_dwordx4 v5, s[28:31], s46 offen offset:1056 lds
    s_add_u32 m0, m0, 4224
    s_add_u32 s46, s46, 0x10000
    buffer_load_dwordx4 v4, s[28:31], s46 offen lds
    buffer_load_dwordx4 v5, s[28:31], s46 offen offset:1056 lds
    s_add_u32 m0, m0, 4224
    s_add_u32 s46, s46, 0x10000
    buffer_load_dwordx4 v4, s[28:31], s46 offen lds
    buffer_load_dwordx4 v5, s[28:31], s46 offen offset:1056 lds
    s_add_u32 s61, s61, 16896
    s_cmp_eq_u32 s61, s67
    s_cselect_b32 s61, s66, s61
    s_xor_b32 s63, s63, 0x40000
    s_cselect_b32 s47, 0, 128
    s_add_u32 s62, s62, s47
    s_and_b32 s62, s62, 2047
    s_sub_u32 s34, s34, 1
    s_cmp_lg_u32 s34, 0
    s_cbranch_scc1 L_l1
    s_waitcnt vmcnt(30)
    s_barrier
    s_add_u32 m0, s65, 0
    s_mul_i32 s35, s64, 196608
    buffer_load_dwordx4 v6, s[48:51], s35 offen lds
    buffer_load_dwordx4 v7, s[48:51], s35 offen offset:1056 lds
    s_add_u32 m0, s65, 4224
    s_mul_i32 s35, s64, s60
    buffer_load_dwordx4 v8, s[52:55], s35 offen lds
    buffer_load_dwordx4 v9, s[52:55], s35 offen offset:1056 lds
    s_add_u32 m0, s65, 8448
    s_mul_i32 s35, s64, 229376
    buffer_load_dwordx4 v10, s[56:59], s35 offen lds
    buffer_load_dwordx4 v11, s[56:59], s35 offen offset:1056 lds
    s_add_u32 m0, s65, s69
    s_mov_b32 exec_hi, 0
    buffer_load_dwordx4 v12, s[56:59], s35 offen lds
    s_mov_b32 exec_hi, -1
    s_add_u32 s65, s65, 13696
    s_cmp_eq_u32 s65, s68
    s_cselect_b32 s65, s67, s65
    s_add_u32 s64, s64, 1
    s_and_b32 s64, s64, 31
    s_mov_b32 m0, s61
    s_add_u32 s46, s62, s63
    buffer_load_dwordx4 v4, s[28:31], s46 offen lds
    buffer_load_dwordx4 v5, s[28:31], s46 offen offset:1056 lds
    s_add_u32 m0, m0, 4224
    s_add_u32 s46, s46, 0x10000
    buffer_load_dwordx4 v4, s[28:31], s46 offen lds
    buffer_load_dwordx4 v5, s[28:31], s46 offen offset:1056 lds
    s_add_u32 m0, m0, 4224
    s_add_u32 s46, s46, 0x10000
    buffer_load_dwordx4 v4, s[28:31], s46 offen lds
    buffer_load_dwordx4 v5, s[28:31], s46 offen offset:1056 lds
    s_add_u32 m0, m0, 4224
    s_add_u32 s46, s46, 0x10000
    buffer_load_dwordx4 v4, s[28:31], s46 offen lds
    buffer_load_dwordx4 v5, s[28:31], s46 offen offset:1056 lds
    s_add_u32 s61, s61, 16896
    s_cmp_eq_u32 s61, s67
    s_cselect_b32 s61, s66, s61
    s_xor_b32 s63, s63, 0x40000
    s_cselect_b32 s47, 0, 128
    s_add_u32 s62, s62, s47
    s_and_b32 s62, s62, 2047
    s_mov_b32 s20, s26
    s_mov_b32 s21, s27
    s_mov_b32 s22, 0x10000000
    s_mov_b32 s23, 0x20000
    s_mov_b32 s10, 0x200000
    s_mov_b32 s11, 0x20000
    s_waitcnt vmcnt(30)
    s_barrier
    s_add_u32 m0, s65, 0
    s_mul_i32 s35, s64, 196608
    buffer_load_dwordx4 v6, s[48:51], s35 offen lds
    buffer_load_dwordx4 v7, s[48:51], s35 offen offset:1056 lds
    s_add_u32 m0, s65, 4224
    s_mul_i32 s35, s64, s60
    buffer_load_dwordx4 v8, s[52:55], s35 offen lds
    buffer_load_dwordx4 v9, s[52:55], s35 offen offset:1056 lds
    s_add_u32 m0, s65, 8448
    s_mul_i32 s35, s64, 229376
    buffer_load_dwordx4 v10, s[56:59], s35 offen lds
    buffer_load_dwordx4 v11, s[56:59], s35 offen offset:1056 lds
    s_add_u32 m0, s65, s69
    s_mov_b32 exec_hi, 0
    buffer_load_dwordx4 v12, s[56:59], s35 offen lds
    s_mov_b32 exec_hi, -1
    s_add_u32 s65, s65, 13696
    s_cmp_eq_u32 s65, s68
    s_cselect_b32 s65, s67, s65
    s_add_u32 s64, s64, 1
    s_and_b32 s64, s64, 31
    s_mov_b32 m0, s61
    s_add_u32 s46, s62, s63
    buffer_load_dwordx4 v4, s[28:31], s46 offen lds
    buffer_load_dwordx4 v5, s[28:31], s46 offen offset:1056 lds
    s_add_u32 m0, m0, 4224
    s_add_u32 s46, s46, 0x10000
    buffer_load_dwordx4 v4, s[28:31], s46 offen lds
    buffer_load_dwordx4 v5, s[28:31], s46 offen offset:1056 lds
    s_add_u32 m0, m0, 4224
    s_add_u32 s46, s46, 0x10000
    buffer_load_dwordx4 v4, s[28:31], s46 offen lds
    buffer_load_dwordx4 v5, s[28:31], s46 offen offset:1056 lds
    s_add_u32 m0, m0, 4224
    s_add_u32 s46, s46, 0x10000
    buffer_load_dwordx4 v4, s[28:31], s46 offen lds
    buffer_load_dwordx4 v5, s[28:31], s46 offen offset:1056 lds
    s_add_u32 s61, s61, 16896
    s_cmp_eq_u32 s61, s67
    s_cselect_b32 s61, s66, s61
    s_xor_b32 s63, s63, 0x40000
    s_cselect_b32 s47, 0, 128
    s_add_u32 s62, s62, s47
    s_and_b32 s62, s62, 2047
    s_mov_b64 s[12:13], s[14:15]
    s_mov_b32 s14, 0x700000
    s_mov_b32 s15, 0x20000
    v_lshrrev_b32 v1, 5, v0
    v_bfe_u32 v3, v0, 4, 1
    v_lshlrev_b32 v1, 3, v1
    v_lshl_add_u32 v1, v3, 4, v1
    s_waitcnt vmcnt(30)
    s_barrier
    s_add_u32 m0, s65, 0
    s_mul_i32 s35, s64, 196608
    buffer_load_dwordx4 v6, s[48:51], s35 offen lds
    buffer_load_dwordx4 v7, s[48:51], s35 offen offset:1056 lds
    s_add_u32 m0, s65, 4224
    s_mul_i32 s35, s64, s60
    buffer_load_dwordx4 v8, s[52:55], s35 offen lds
    buffer_load_dwordx4 v9, s[52:55], s35 offen offset:1056 lds
    s_add_u32 m0, s65, 8448
    s_mul_i32 s35, s64, 229376
    buffer_load_dwordx4 v10, s[56:59], s35 offen lds
    buffer_load_dwordx4 v11, s[56:59], s35 offen offset:1056 lds
    s_add_u32 m0, s65, s69
    s_mov_b32 exec_hi, 0
    buffer_load_dwordx4 v12, s[56:59], s35 offen lds
    s_mov_b32 exec_hi, -1
    s_add_u32 s65, s65, 13696
    s_cmp_eq_u32 s65, s68
    s_cselect_b32 s65, s67, s65
    s_add_u32 s64, s64, 1
    s_and_b32 s64, s64, 31
    s_mov_b32 m0, s61
    s_add_u32 s46, s62, s63
    buffer_load_dwordx4 v4, s[28:31], s46 offen lds
    buffer_load_dwordx4 v5, s[28:31], s46 offen offset:1056 lds
    s_add_u32 m0, m0, 4224
    s_add_u32 s46, s46, 0x10000
    buffer_load_dwordx4 v4, s[28:31], s46 offen lds
    buffer_load_dwordx4 v5, s[28:31], s46 offen offset:1056 lds
    s_add_u32 m0, m0, 4224
    s_add_u32 s46, s46, 0x10000
    buffer_load_dwordx4 v4, s[28:31], s46 offen lds
    buffer_load_dwordx4 v5, s[28:31], s46 offen offset:1056 lds
    s_add_u32 m0, m0, 4224
    s_add_u32 s46, s46, 0x10000
    buffer_load_dwordx4 v4, s[28:31], s46 offen lds
    buffer_load_dwordx4 v5, s[28:31], s46 offen offset:1056 lds
    s_add_u32 s61, s61, 16896
    s_cmp_eq_u32 s61, s67
    s_cselect_b32 s61, s66, s61
    s_xor_b32 s63, s63, 0x40000
    s_cselect_b32 s47, 0, 128
    s_add_u32 s62, s62, s47
    s_and_b32 s62, s62, 2047
    v_bfe_u32 v3, v0, 3, 1
    v_add_u32 v1, v1, v3
    s_lshl_b32 s4, s45, 2
    v_add_u32 v1, s4, v1
    s_lshl_b32 s4, s41, 8
    s_lshl_b32 s5, s42, 7
    s_waitcnt vmcnt(30)
    s_barrier
    s_add_u32 m0, s65, 0
    s_mul_i32 s35, s64, 196608
    buffer_load_dwordx4 v6, s[48:51], s35 offen lds
    buffer_load_dwordx4 v7, s[48:51], s35 offen offset:1056 lds
    s_add_u32 m0, s65, 4224
    s_mul_i32 s35, s64, s60
    buffer_load_dwordx4 v8, s[52:55], s35 offen lds
    buffer_load_dwordx4 v9, s[52:55], s35 offen offset:1056 lds
    s_add_u32 m0, s65, 8448
    s_mul_i32 s35, s64, 229376
    buffer_load_dwordx4 v10, s[56:59], s35 offen lds
    buffer_load_dwordx4 v11, s[56:59], s35 offen offset:1056 lds
    s_add_u32 m0, s65, s69
    s_mov_b32 exec_hi, 0
    buffer_load_dwordx4 v12, s[56:59], s35 offen lds
    s_mov_b32 exec_hi, -1
    s_add_u32 s65, s65, 13696
    s_cmp_eq_u32 s65, s68
    s_cselect_b32 s65, s67, s65
    s_add_u32 s64, s64, 1
    s_and_b32 s64, s64, 31
    s_mov_b32 m0, s61
    s_add_u32 s46, s62, s63
    buffer_load_dwordx4 v4, s[28:31], s46 offen lds
    buffer_load_dwordx4 v5, s[28:31], s46 offen offset:1056 lds
    s_add_u32 m0, m0, 4224
    s_add_u32 s46, s46, 0x10000
    buffer_load_dwordx4 v4, s[28:31], s46 offen lds
    buffer_load_dwordx4 v5, s[28:31], s46 offen offset:1056 lds
    s_add_u32 m0, m0, 4224
    s_add_u32 s46, s46, 0x10000
    buffer_load_dwordx4 v4, s[28:31], s46 offen lds
    buffer_load_dwordx4 v5, s[28:31], s46 offen offset:1056 lds
    s_add_u32 m0, m0, 4224
    s_add_u32 s46, s46, 0x10000
    buffer_load_dwordx4 v4, s[28:31], s46 offen lds
    buffer_load_dwordx4 v5, s[28:31], s46 offen offset:1056 lds
    s_add_u32 s61, s61, 16896
    s_cmp_eq_u32 s61, s67
    s_cselect_b32 s61, s66, s61
    s_xor_b32 s63, s63, 0x40000
    s_cselect_b32 s47, 0, 128
    s_add_u32 s62, s62, s47
    s_and_b32 s62, s62, 2047
    s_add_u32 s4, s4, s5
    v_lshl_add_u32 v14, v1, 11, v2
    v_add_u32 v14, s4, v14
    v_xor_b32 v16, 128, v14
    v_add_u32 v15, 3040, v14
    v_add_u32 v17, 3040, v16
    s_lshl_b32 s5, s36, 19
    s_waitcnt vmcnt(30)
    s_barrier
    s_add_u32 m0, s65, 0
    s_mul_i32 s35, s64, 196608
    buffer_load_dwordx4 v6, s[48:51], s35 offen lds
    buffer_load_dwordx4 v7, s[48:51], s35 offen offset:1056 lds
    s_add_u32 m0, s65, 4224
    s_mul_i32 s35, s64, s60
    buffer_load_dwordx4 v8, s[52:55], s35 offen lds
    buffer_load_dwordx4 v9, s[52:55], s35 offen offset:1056 lds
    s_add_u32 m0, s65, 8448
    s_mul_i32 s35, s64, 229376
    buffer_load_dwordx4 v10, s[56:59], s35 offen lds
    buffer_load_dwordx4 v11, s[56:59], s35 offen offset:1056 lds
    s_add_u32 m0, s65, s69
    s_mov_b32 exec_hi, 0
    buffer_load_dwordx4 v12, s[56:59], s35 offen lds
    s_mov_b32 exec_hi, -1
    s_add_u32 s65, s65, 13696
    s_cmp_eq_u32 s65, s68
    s_cselect_b32 s65, s67, s65
    s_add_u32 s64, s64, 1
    s_and_b32 s64, s64, 31
    s_mov_b32 m0, s61
    s_add_u32 s46, s62, s63
    buffer_load_dwordx4 v4, s[28:31], s46 offen lds
    buffer_load_dwordx4 v5, s[28:31], s46 offen offset:1056 lds
    s_add_u32 m0, m0, 4224
    s_add_u32 s46, s46, 0x10000
    buffer_load_dwordx4 v4, s[28:31], s46 offen lds
    buffer_load_dwordx4 v5, s[28:31], s46 offen offset:1056 lds
    s_add_u32 m0, m0, 4224
    s_add_u32 s46, s46, 0x10000
    buffer_load_dwordx4 v4, s[28:31], s46 offen lds
    buffer_load_dwordx4 v5, s[28:31], s46 offen offset:1056 lds
    s_add_u32 m0, m0, 4224
    s_add_u32 s46, s46, 0x10000
    buffer_load_dwordx4 v4, s[28:31], s46 offen lds
    buffer_load_dwordx4 v5, s[28:31], s46 offen offset:1056 lds
    s_add_u32 s61, s61, 16896
    s_cmp_eq_u32 s61, s67
    s_cselect_b32 s61, s66, s61
    s_xor_b32 s63, s63, 0x40000
    s_cselect_b32 s47, 0, 128
    s_add_u32 s62, s62, s47
    s_and_b32 s62, s62, 2047
    s_sub_u32 s4, s4, s5
    v_add_u32 v24, s4, v4
    v_xor_b32 v26, 128, v24
    v_add_u32 v25, 3040, v24
    v_add_u32 v27, 3040, v26
    s_mul_i32 s6, s32, 1835008
    s_mul_i32 s7, s32, 262144
    s_waitcnt vmcnt(30)
    s_barrier
    s_add_u32 m0, s65, 0
    s_mul_i32 s35, s64, 196608
    buffer_load_dwordx4 v6, s[48:51], s35 offen lds
    buffer_load_dwordx4 v7, s[48:51], s35 offen offset:1056 lds
    s_add_u32 m0, s65, 4224
    s_mul_i32 s35, s64, s60
    buffer_load_dwordx4 v8, s[52:55], s35 offen lds
    buffer_load_dwordx4 v9, s[52:55], s35 offen offset:1056 lds
    s_add_u32 m0, s65, 8448
    s_mul_i32 s35, s64, 229376
    buffer_load_dwordx4 v10, s[56:59], s35 offen lds
    buffer_load_dwordx4 v11, s[56:59], s35 offen offset:1056 lds
    s_add_u32 m0, s65, s69
    s_mov_b32 exec_hi, 0
    buffer_load_dwordx4 v12, s[56:59], s35 offen lds
    s_mov_b32 exec_hi, -1
    s_add_u32 s65, s65, 13696
    s_cmp_eq_u32 s65, s68
    s_cselect_b32 s65, s67, s65
    s_add_u32 s64, s64, 1
    s_and_b32 s64, s64, 31
    s_mov_b32 m0, s61
    s_add_u32 s46, s62, s63
    buffer_load_dwordx4 v4, s[28:31], s46 offen lds
    buffer_load_dwordx4 v5, s[28:31], s46 offen offset:1056 lds
    s_add_u32 m0, m0, 4224
    s_add_u32 s46, s46, 0x10000
    buffer_load_dwordx4 v4, s[28:31], s46 offen lds
    buffer_load_dwordx4 v5, s[28:31], s46 offen offset:1056 lds
    s_add_u32 m0, m0, 4224
    s_add_u32 s46, s46, 0x10000
    buffer_load_dwordx4 v4, s[28:31], s46 offen lds
    buffer_load_dwordx4 v5, s[28:31], s46 offen offset:1056 lds
    s_add_u32 m0, m0, 4224
    s_add_u32 s46, s46, 0x10000
    buffer_load_dwordx4 v4, s[28:31], s46 offen lds
    buffer_load_dwordx4 v5, s[28:31], s46 offen offset:1056 lds
    s_add_u32 s61, s61, 16896
    s_cmp_eq_u32 s61, s67
    s_cselect_b32 s61, s66, s61
    s_xor_b32 s63, s63, 0x40000
    s_cselect_b32 s47, 0, 128
    s_add_u32 s62, s62, s47
    s_and_b32 s62, s62, 2047
    s_mov_b64 s[24:25], s[12:13]
    s_mov_b32 s26, s14
    s_mov_b32 s27, 0x20000
    s_mov_b32 s4, 0xb9874210
    s_mov_b32 s5, 0xd6ca53
    s_cmp_eq_u32 s41, 3
    s_cselect_b32 s4, 0xb9874201, s4
    s_cselect_b32 s5, 0xd6ca53, s5
    s_cmp_eq_u32 s41, 0
    s_cselect_b32 s4, 0x98741032, s4
    s_cselect_b32 s5, 0xd6ca5b, s5
    s_cmp_eq_u32 s41, 1
    s_cselect_b32 s4, 0x98721054, s4
    s_cselect_b32 s5, 0xd6ca3b, s5
    s_cmp_eq_u32 s41, 6
    s_cselect_b32 s4, 0xb9842107, s4
    s_cselect_b32 s5, 0xd6ca53, s5
    s_cmp_eq_u32 s41, 7
    s_cselect_b32 s4, 0xb9742108, s4
    s_cselect_b32 s5, 0xd6ca53, s5
    s_cmp_eq_u32 s41, 4
    s_cselect_b32 s4, 0x874210a9, s4
    s_cselect_b32 s5, 0xd6c53b, s5
    s_cmp_eq_u32 s41, 5
    s_cselect_b32 s4, 0x874210cb, s4
    s_cselect_b32 s5, 0xd6a539, s5
    s_waitcnt vmcnt(15)
    s_barrier
    s_add_u32 m0, s65, 0
    s_mul_i32 s35, s64, 196608
    buffer_load_dwordx4 v6, s[48:51], s35 offen lds
    buffer_load_dwordx4 v7, s[48:51], s35 offen offset:1056 lds
    s_add_u32 m0, s65, 4224
    s_mul_i32 s35, s64, s60
    buffer_load_dwordx4 v8, s[52:55], s35 offen lds
    buffer_load_dwordx4 v9, s[52:55], s35 offen offset:1056 lds
    s_add_u32 m0, s65, 8448
    s_mul_i32 s35, s64, 229376
    buffer_load_dwordx4 v10, s[56:59], s35 offen lds
    buffer_load_dwordx4 v11, s[56:59], s35 offen offset:1056 lds
    s_add_u32 m0, s65, s69
    s_mov_b32 exec_hi, 0
    buffer_load_dwordx4 v12, s[56:59], s35 offen lds
    s_mov_b32 exec_hi, -1
    s_add_u32 s65, s65, 13696
    s_cmp_eq_u32 s65, s68
    s_cselect_b32 s65, s67, s65
    s_add_u32 s64, s64, 1
    s_and_b32 s64, s64, 31
    s_waitcnt vmcnt(7)
    s_barrier
    s_bfe_u32 s16, s4, 0x40000
    s_lshl_b32 s16, s16, 17
    s_add_u32 s16, s16, s6
    s_add_u32 m0, s66, 33792
    s_add_u32 s47, s16, 0
    buffer_load_dwordx4 v14, s[12:15], s47 offen offset:0 sc1 lds
    buffer_load_dwordx4 v15, s[12:15], s47 offen offset:1056 sc1 lds
    s_add_u32 m0, s66, 38016
    s_add_u32 s47, s16, 65536
    buffer_load_dwordx4 v14, s[12:15], s47 offen offset:0 sc1 lds
    buffer_load_dwordx4 v15, s[12:15], s47 offen offset:1056 sc1 lds
    s_add_u32 m0, s66, 42240
    s_add_u32 s47, s16, 0
    buffer_load_dwordx4 v16, s[24:27], s47 offen offset:0 sc1 lds
    buffer_load_dwordx4 v17, s[24:27], s47 offen offset:1056 sc1 lds
    s_add_u32 m0, s66, 46464
    s_add_u32 s47, s16, 65536
    buffer_load_dwordx4 v16, s[24:27], s47 offen offset:0 sc1 lds
    buffer_load_dwordx4 v17, s[24:27], s47 offen offset:1056 sc1 lds
    s_waitcnt vmcnt(8)
    s_barrier
    s_bfe_u32 s16, s4, 0x40004
    s_lshl_b32 s16, s16, 17
    s_add_u32 s16, s16, s6
    s_add_u32 m0, s66, 50688
    s_add_u32 s47, s16, 0
    buffer_load_dwordx4 v14, s[12:15], s47 offen offset:0 sc1 lds
    buffer_load_dwordx4 v15, s[12:15], s47 offen offset:1056 sc1 lds
    s_add_u32 m0, s66, 54912
    s_add_u32 s47, s16, 65536
    buffer_load_dwordx4 v14, s[12:15], s47 offen offset:0 sc1 lds
    buffer_load_dwordx4 v15, s[12:15], s47 offen offset:1056 sc1 lds
    s_add_u32 m0, s66, 59136
    s_add_u32 s47, s16, 0
    buffer_load_dwordx4 v16, s[24:27], s47 offen offset:0 sc1 lds
    buffer_load_dwordx4 v17, s[24:27], s47 offen offset:1056 sc1 lds
    s_add_u32 m0, s66, 63360
    s_add_u32 s47, s16, 65536
    buffer_load_dwordx4 v16, s[24:27], s47 offen offset:0 sc1 lds
    buffer_load_dwordx4 v17, s[24:27], s47 offen offset:1056 sc1 lds
    v_mov_b32 v227, 163832
    ds_read_b32 v227, v227
    s_waitcnt lgkmcnt(0)
    v_readfirstlane_b32 s79, v227
    s_nop 1
    s_xor_b32 s43, s43, s79
    s_barrier
    s_bfe_u32 s16, s4, 0x40008
    s_lshl_b32 s16, s16, 17
    s_add_u32 s16, s16, s6
    s_add_u32 m0, s66, 67584
    s_add_u32 s47, s16, 0
    buffer_load_dwordx4 v14, s[12:15], s47 offen offset:0 sc1 lds
    buffer_load_dwordx4 v15, s[12:15], s47 offen offset:1056 sc1 lds
    s_add_u32 m0, s66, 71808
    s_add_u32 s47, s16, 65536
    buffer_load_dwordx4 v14, s[12:15], s47 offen offset:0 sc1 lds
    buffer_load_dwordx4 v15, s[12:15], s47 offen offset:1056 sc1 lds
    s_add_u32 m0, s66, 76032
    s_add_u32 s47, s16, 0
    buffer_load_dwordx4 v16, s[24:27], s47 offen offset:0 sc1 lds
    buffer_load_dwordx4 v17, s[24:27], s47 offen offset:1056 sc1 lds
    s_add_u32 m0, s66, 80256
    s_add_u32 s47, s16, 65536
    buffer_load_dwordx4 v16, s[24:27], s47 offen offset:0 sc1 lds
    buffer_load_dwordx4 v17, s[24:27], s47 offen offset:1056 sc1 lds
    s_barrier
    s_cmp_ge_u32 s38, 2
    s_cselect_b64 vcc, -1, 0
    s_waitcnt vmcnt(16)
    s_barrier
    s_call_b64 s[84:85], L_qp0
    s_bfe_u32 s16, s4, 0x4000c
    s_lshl_b32 s16, s16, 17
    s_add_u32 s16, s16, s6
    s_add_u32 m0, s66, 84480
    s_add_u32 s47, s16, 0
    buffer_load_dwordx4 v14, s[12:15], s47 offen offset:0 sc1 lds
    buffer_load_dwordx4 v15, s[12:15], s47 offen offset:1056 sc1 lds
    s_add_u32 m0, s66, 88704
    s_add_u32 s47, s16, 65536
    buffer_load_dwordx4 v14, s[12:15], s47 offen offset:0 sc1 lds
    buffer_load_dwordx4 v15, s[12:15], s47 offen offset:1056 sc1 lds
    s_add_u32 m0, s66, 92928
    s_add_u32 s47, s16, 0
    buffer_load_dwordx4 v16, s[24:27], s47 offen offset:0 sc1 lds
    buffer_load_dwordx4 v17, s[24:27], s47 offen offset:1056 sc1 lds
    s_add_u32 m0, s66, 97152
    s_add_u32 s47, s16, 65536
    buffer_load_dwordx4 v16, s[24:27], s47 offen offset:0 sc1 lds
    buffer_load_dwordx4 v17, s[24:27], s47 offen offset:1056 sc1 lds
    s_waitcnt vmcnt(16)
    s_barrier
    s_bfe_u32 s16, s4, 0x40010
    s_lshl_b32 s16, s16, 17
    s_add_u32 s16, s16, s6
    s_add_u32 m0, s66, 101376
    s_add_u32 s47, s16, 0
    buffer_load_dwordx4 v14, s[12:15], s47 offen offset:0 sc1 lds
    buffer_load_dwordx4 v15, s[12:15], s47 offen offset:1056 sc1 lds
    s_add_u32 m0, s66, 105600
    s_add_u32 s47, s16, 65536
    buffer_load_dwordx4 v14, s[12:15], s47 offen offset:0 sc1 lds
    buffer_load_dwordx4 v15, s[12:15], s47 offen offset:1056 sc1 lds
    s_add_u32 m0, s66, 109824
    s_add_u32 s47, s16, 0
    buffer_load_dwordx4 v16, s[24:27], s47 offen offset:0 sc1 lds
    buffer_load_dwordx4 v17, s[24:27], s47 offen offset:1056 sc1 lds
    s_add_u32 m0, s66, 114048
    s_add_u32 s47, s16, 65536
    buffer_load_dwordx4 v16, s[24:27], s47 offen offset:0 sc1 lds
    buffer_load_dwordx4 v17, s[24:27], s47 offen offset:1056 sc1 lds
    s_cmp_lt_u32 s38, 2
    s_cbranch_scc1 L_qc_2
    s_call_b64 s[84:85], L_qp1
L_qc_2:
    s_waitcnt vmcnt(16)
    s_barrier
    s_bfe_u32 s16, s4, 0x40014
    s_lshl_b32 s16, s16, 17
    s_add_u32 s16, s16, s6
    s_add_u32 m0, s66, 118272
    s_add_u32 s47, s16, 0
    buffer_load_dwordx4 v14, s[12:15], s47 offen offset:0 sc1 lds
    buffer_load_dwordx4 v15, s[12:15], s47 offen offset:1056 sc1 lds
    s_add_u32 m0, s66, 122496
    s_add_u32 s47, s16, 65536
    buffer_load_dwordx4 v14, s[12:15], s47 offen offset:0 sc1 lds
    buffer_load_dwordx4 v15, s[12:15], s47 offen offset:1056 sc1 lds
    s_add_u32 m0, s66, 126720
    s_add_u32 s47, s16, 0
    buffer_load_dwordx4 v16, s[24:27], s47 offen offset:0 sc1 lds
    buffer_load_dwordx4 v17, s[24:27], s47 offen offset:1056 sc1 lds
    s_add_u32 m0, s66, 130944
    s_add_u32 s47, s16, 65536
    buffer_load_dwordx4 v16, s[24:27], s47 offen offset:0 sc1 lds
    buffer_load_dwordx4 v17, s[24:27], s47 offen offset:1056 sc1 lds
    s_bfe_u32 s16, s4, 0x40018
    s_lshl_b32 s16, s16, 17
    s_add_u32 s16, s16, s6
    s_add_u32 m0, s66, 0
    s_add_u32 s47, s16, 0
    buffer_load_dwordx4 v14, s[12:15], s47 offen offset:0 sc1 lds
    buffer_load_dwordx4 v15, s[12:15], s47 offen offset:1056 sc1 lds
    s_cmp_lt_u32 s38, 2
    s_cbranch_scc1 L_qc_3
    s_call_b64 s[84:85], L_qp2
L_qc_3:
    s_waitcnt vmcnt(18)
    s_barrier
    s_bfe_u32 s16, s4, 0x40018
    s_lshl_b32 s16, s16, 17
    s_add_u32 s16, s16, s6
    s_add_u32 m0, s66, 4224
    s_add_u32 s47, s16, 65536
    buffer_load_dwordx4 v14, s[12:15], s47 offen offset:0 sc1 lds
    buffer_load_dwordx4 v15, s[12:15], s47 offen offset:1056 sc1 lds
    s_add_u32 m0, s66, 8448
    s_add_u32 s47, s16, 0
    buffer_load_dwordx4 v16, s[24:27], s47 offen offset:0 sc1 lds
    buffer_load_dwordx4 v17, s[24:27], s47 offen offset:1056 sc1 lds
    s_add_u32 m0, s66, 12672
    s_add_u32 s47, s16, 65536
    buffer_load_dwordx4 v16, s[24:27], s47 offen offset:0 sc1 lds
    buffer_load_dwordx4 v17, s[24:27], s47 offen offset:1056 sc1 lds
    s_bfe_u32 s16, s4, 0x4001c
    s_lshl_b32 s16, s16, 17
    s_add_u32 s16, s16, s6
    s_add_u32 m0, s66, 16896
    s_add_u32 s47, s16, 0
    buffer_load_dwordx4 v14, s[12:15], s47 offen offset:0 sc1 lds
    buffer_load_dwordx4 v15, s[12:15], s47 offen offset:1056 sc1 lds
    s_add_u32 m0, s66, 21120
    s_add_u32 s47, s16, 65536
    buffer_load_dwordx4 v14, s[12:15], s47 offen offset:0 sc1 lds
    buffer_load_dwordx4 v15, s[12:15], s47 offen offset:1056 sc1 lds
    s_cmp_lt_u32 s38, 2
    s_cbranch_scc1 L_qc_4
    s_call_b64 s[84:85], L_qp3
L_qc_4:
    s_waitcnt vmcnt(20)
    s_barrier
    s_bfe_u32 s16, s4, 0x4001c
    s_lshl_b32 s16, s16, 17
    s_add_u32 s16, s16, s6
    s_add_u32 m0, s66, 25344
    s_add_u32 s47, s16, 0
    buffer_load_dwordx4 v16, s[24:27], s47 offen offset:0 sc1 lds
    buffer_load_dwordx4 v17, s[24:27], s47 offen offset:1056 sc1 lds
    s_add_u32 m0, s66, 29568
    s_add_u32 s47, s16, 65536
    buffer_load_dwordx4 v16, s[24:27], s47 offen offset:0 sc1 lds
    buffer_load_dwordx4 v17, s[24:27], s47 offen offset:1056 sc1 lds
    s_bfe_u32 s16, s5, 0x40000
    s_lshl_b32 s16, s16, 17
    s_add_u32 s16, s16, s6
    s_add_u32 m0, s66, 33792
    s_add_u32 s47, s16, 0
    buffer_load_dwordx4 v14, s[12:15], s47 offen offset:0 sc1 lds
    buffer_load_dwordx4 v15, s[12:15], s47 offen offset:1056 sc1 lds
    s_add_u32 m0, s66, 38016
    s_add_u32 s47, s16, 65536
    buffer_load_dwordx4 v14, s[12:15], s47 offen offset:0 sc1 lds
    buffer_load_dwordx4 v15, s[12:15], s47 offen offset:1056 sc1 lds
    s_add_u32 m0, s66, 42240
    s_add_u32 s47, s16, 0
    buffer_load_dwordx4 v16, s[24:27], s47 offen offset:0 sc1 lds
    buffer_load_dwordx4 v17, s[24:27], s47 offen offset:1056 sc1 lds
    s_add_u32 m0, s66, 46464
    s_add_u32 s47, s16, 65536
    buffer_load_dwordx4 v16, s[24:27], s47 offen offset:0 sc1 lds
    buffer_load_dwordx4 v17, s[24:27], s47 offen offset:1056 sc1 lds
    s_cmp_lt_u32 s38, 2
    s_cbranch_scc1 L_qc_5
    s_call_b64 s[84:85], L_qp4
L_qc_5:
    s_waitcnt vmcnt(24)
    s_barrier
    s_bfe_u32 s16, s5, 0x40004
    s_lshl_b32 s16, s16, 17
    s_add_u32 s16, s16, s6
    s_add_u32 m0, s66, 50688
    s_add_u32 s47, s16, 0
    buffer_load_dwordx4 v14, s[12:15], s47 offen offset:0 sc1 lds
    buffer_load_dwordx4 v15, s[12:15], s47 offen offset:1056 sc1 lds
    s_add_u32 m0, s66, 54912
    s_add_u32 s47, s16, 65536
    buffer_load_dwordx4 v14, s[12:15], s47 offen offset:0 sc1 lds
    buffer_load_dwordx4 v15, s[12:15], s47 offen offset:1056 sc1 lds
    s_add_u32 m0, s66, 59136
    s_add_u32 s47, s16, 0
    buffer_load_dwordx4 v16, s[24:27], s47 offen offset:0 sc1 lds
    buffer_load_dwordx4 v17, s[24:27], s47 offen offset:1056 sc1 lds
    s_add_u32 m0, s66, 63360
    s_add_u32 s47, s16, 65536
    buffer_load_dwordx4 v16, s[24:27], s47 offen offset:0 sc1 lds
    buffer_load_dwordx4 v17, s[24:27], s47 offen offset:1056 sc1 lds
    s_bfe_u32 s16, s5, 0x40008
    s_lshl_b32 s16, s16, 17
    s_add_u32 s16, s16, s6
    s_add_u32 m0, s66, 67584
    s_add_u32 s47, s16, 0
    buffer_load_dwordx4 v14, s[12:15], s47 offen offset:0 sc1 lds
    buffer_load_dwordx4 v15, s[12:15], s47 offen offset:1056 sc1 lds
    s_waitcnt vmcnt(26)
    s_barrier
    s_bfe_u32 s16, s5, 0x40008
    s_lshl_b32 s16, s16, 17
    s_add_u32 s16, s16, s6
    s_add_u32 m0, s66, 71808
    s_add_u32 s47, s16, 65536
    buffer_load_dwordx4 v14, s[12:15], s47 offen offset:0 sc1 lds
    buffer_load_dwordx4 v15, s[12:15], s47 offen offset:1056 sc1 lds
    s_add_u32 m0, s66, 76032
    s_add_u32 s47, s16, 0
    buffer_load_dwordx4 v16, s[24:27], s47 offen offset:0 sc1 lds
    buffer_load_dwordx4 v17, s[24:27], s47 offen offset:1056 sc1 lds
    s_add_u32 m0, s66, 80256
    s_add_u32 s47, s16, 65536
    buffer_load_dwordx4 v16, s[24:27], s47 offen offset:0 sc1 lds
    buffer_load_dwordx4 v17, s[24:27], s47 offen offset:1056 sc1 lds
    s_bfe_u32 s16, s5, 0x4000c
    s_lshl_b32 s16, s16, 17
    s_add_u32 s16, s16, s6
    s_add_u32 m0, s66, 84480
    s_add_u32 s47, s16, 0
    buffer_load_dwordx4 v14, s[12:15], s47 offen offset:0 sc1 lds
    buffer_load_dwordx4 v15, s[12:15], s47 offen offset:1056 sc1 lds
    s_add_u32 m0, s66, 88704
    s_add_u32 s47, s16, 65536
    buffer_load_dwordx4 v14, s[12:15], s47 offen offset:0 sc1 lds
    buffer_load_dwordx4 v15, s[12:15], s47 offen offset:1056 sc1 lds
    s_add_u32 m0, s66, 92928
    s_add_u32 s47, s16, 0
    buffer_load_dwordx4 v16, s[24:27], s47 offen offset:0 sc1 lds
    buffer_load_dwordx4 v17, s[24:27], s47 offen offset:1056 sc1 lds
    s_waitcnt vmcnt(30)
    s_barrier
    s_bfe_u32 s16, s5, 0x4000c
    s_lshl_b32 s16, s16, 17
    s_add_u32 s16, s16, s6
    s_add_u32 m0, s66, 97152
    s_add_u32 s47, s16, 65536
    buffer_load_dwordx4 v16, s[24:27], s47 offen offset:0 sc1 lds
    buffer_load_dwordx4 v17, s[24:27], s47 offen offset:1056 sc1 lds
    s_bfe_u32 s16, s5, 0x40010
    s_lshl_b32 s16, s16, 17
    s_add_u32 s16, s16, s6
    s_add_u32 m0, s66, 101376
    s_add_u32 s47, s16, 0
    buffer_load_dwordx4 v24, s[12:15], s47 offen offset:0 sc1 lds
    buffer_load_dwordx4 v25, s[12:15], s47 offen offset:1056 sc1 lds
    s_add_u32 m0, s66, 105600
    s_add_u32 s47, s16, 65536
    buffer_load_dwordx4 v24, s[12:15], s47 offen offset:0 sc1 lds
    buffer_load_dwordx4 v25, s[12:15], s47 offen offset:1056 sc1 lds
    s_add_u32 m0, s66, 109824
    s_add_u32 s47, s16, 0
    buffer_load_dwordx4 v26, s[24:27], s47 offen offset:0 sc1 lds
    buffer_load_dwordx4 v27, s[24:27], s47 offen offset:1056 sc1 lds
    s_cmp_lt_u32 s38, 2
    s_cbranch_scc1 L_qc_6
    s_call_b64 s[84:85], L_q4
L_qc_6:
    s_waitcnt vmcnt(30)
    s_barrier
    s_bfe_u32 s16, s5, 0x40010
    s_lshl_b32 s16, s16, 17
    s_add_u32 s16, s16, s6
    s_add_u32 m0, s66, 114048
    s_add_u32 s47, s16, 65536
    buffer_load_dwordx4 v26, s[24:27], s47 offen offset:0 sc1 lds
    buffer_load_dwordx4 v27, s[24:27], s47 offen offset:1056 sc1 lds
    s_bfe_u32 s16, s5, 0x40014
    s_lshl_b32 s16, s16, 17
    s_add_u32 s16, s16, s6
    s_add_u32 m0, s66, 118272
    s_add_u32 s47, s16, 0
    buffer_load_dwordx4 v24, s[12:15], s47 offen offset:0 sc1 lds
    buffer_load_dwordx4 v25, s[12:15], s47 offen offset:1056 sc1 lds
    s_add_u32 m0, s66, 122496
    s_add_u32 s47, s16, 65536
    buffer_load_dwordx4 v24, s[12:15], s47 offen offset:0 sc1 lds
    buffer_load_dwordx4 v25, s[12:15], s47 offen offset:1056 sc1 lds
    s_add_u32 m0, s66, 126720
    s_add_u32 s47, s16, 0
    buffer_load_dwordx4 v26, s[24:27], s47 offen offset:0 sc1 lds
    buffer_load_dwordx4 v27, s[24:27], s47 offen offset:1056 sc1 lds
    s_cmp_lt_u32 s38, 2
    s_cbranch_scc1 L_qc_7
    s_call_b64 s[84:85], L_q5
L_qc_7:
    s_waitcnt vmcnt(30)
    s_barrier
    s_cmp_lt_u32 s38, 2
    s_cbranch_scc1 L_qc_8
    s_call_b64 s[84:85], L_q6
L_qc_8:
    s_bfe_u32 s16, s5, 0x40014
    s_lshl_b32 s16, s16, 17
    s_add_u32 s16, s16, s6
    s_add_u32 m0, s66, 130944
    s_add_u32 s47, s16, 65536
    buffer_load_dwordx4 v26, s[24:27], s47 offen offset:0 sc1 lds
    buffer_load_dwordx4 v27, s[24:27], s47 offen offset:1056 sc1 lds
    s_add_u32 m0, s66, 0
    s_add_u32 s47, s7, 1048576
    buffer_load_dwordx4 v14, s[8:11], s47 offen offset:0 sc1 lds
    buffer_load_dwordx4 v15, s[8:11], s47 offen offset:1056 sc1 lds
    s_add_u32 m0, s66, 4224
    s_add_u32 s47, s7, 1114112
    buffer_load_dwordx4 v14, s[8:11], s47 offen offset:0 sc1 lds
    buffer_load_dwordx4 v15, s[8:11], s47 offen offset:1056 sc1 lds
    s_add_u32 m0, s66, 8448
    s_add_u32 s47, s7, 1048576
    buffer_load_dwordx4 v16, s[8:11], s47 offen offset:0 sc1 lds
    buffer_load_dwordx4 v17, s[8:11], s47 offen offset:1056 sc1 lds
    s_add_u32 m0, s66, 12672
    s_add_u32 s47, s7, 1114112
    buffer_load_dwordx4 v16, s[8:11], s47 offen offset:0 sc1 lds
    buffer_load_dwordx4 v17, s[8:11], s47 offen offset:1056 sc1 lds
    s_add_u32 m0, s66, 16896
    s_add_u32 s47, s7, 1179648
    buffer_load_dwordx4 v14, s[8:11], s47 offen offset:0 sc1 lds
    buffer_load_dwordx4 v15, s[8:11], s47 offen offset:1056 sc1 lds
    s_waitcnt vmcnt(34)
    s_barrier
    s_add_u32 m0, s66, 21120
    s_add_u32 s47, s7, 1245184
    buffer_load_dwordx4 v14, s[8:11], s47 offen offset:0 sc1 lds
    buffer_load_dwordx4 v15, s[8:11], s47 offen offset:1056 sc1 lds
    s_add_u32 m0, s66, 25344
    s_add_u32 s47, s7, 1179648
    buffer_load_dwordx4 v16, s[8:11], s47 offen offset:0 sc1 lds
    buffer_load_dwordx4 v17, s[8:11], s47 offen offset:1056 sc1 lds
    s_add_u32 m0, s66, 29568
    s_add_u32 s47, s7, 1245184
    buffer_load_dwordx4 v16, s[8:11], s47 offen offset:0 sc1 lds
    buffer_load_dwordx4 v17, s[8:11], s47 offen offset:1056 sc1 lds
    s_add_u32 m0, s66, 33792
    s_mov_b32 s47, 0
    buffer_load_dwordx4 v14, s[8:11], s47 offen offset:0 sc1 lds
    buffer_load_dwordx4 v15, s[8:11], s47 offen offset:1056 sc1 lds
    s_add_u32 m0, s66, 38016
    s_mov_b32 s47, 65536
    buffer_load_dwordx4 v14, s[8:11], s47 offen offset:0 sc1 lds
    buffer_load_dwordx4 v15, s[8:11], s47 offen offset:1056 sc1 lds
    s_add_u32 m0, s66, 42240
    s_mov_b32 s47, 131072
    buffer_load_dwordx4 v14, s[8:11], s47 offen offset:0 sc1 lds
    buffer_load_dwordx4 v15, s[8:11], s47 offen offset:1056 sc1 lds
    s_waitcnt vmcnt(38)
    s_barrier
    s_add_u32 m0, s66, 46464
    s_mov_b32 s47, 196608
    buffer_load_dwordx4 v14, s[8:11], s47 offen offset:0 sc1 lds
    buffer_load_dwordx4 v15, s[8:11], s47 offen offset:1056 sc1 lds
    s_add_u32 m0, s66, 50688
    s_mov_b32 s47, 262144
    buffer_load_dwordx4 v14, s[8:11], s47 offen offset:0 sc1 lds
    buffer_load_dwordx4 v15, s[8:11], s47 offen offset:1056 sc1 lds
    s_add_u32 m0, s66, 54912
    s_mov_b32 s47, 327680
    buffer_load_dwordx4 v14, s[8:11], s47 offen offset:0 sc1 lds
    buffer_load_dwordx4 v15, s[8:11], s47 offen offset:1056 sc1 lds
    s_add_u32 m0, s66, 59136
    s_mov_b32 s47, 393216
    buffer_load_dwordx4 v14, s[8:11], s47 offen offset:0 sc1 lds
    buffer_load_dwordx4 v15, s[8:11], s47 offen offset:1056 sc1 lds
    s_add_u32 m0, s66, 63360
    s_mov_b32 s47, 458752
    buffer_load_dwordx4 v14, s[8:11], s47 offen offset:0 sc1 lds
    buffer_load_dwordx4 v15, s[8:11], s47 offen offset:1056 sc1 lds
    s_waitcnt vmcnt(16)
    s_barrier
    s_add_u32 m0, s66, 67584
    s_mov_b32 s47, 524288
    buffer_load_dwordx4 v14, s[8:11], s47 offen offset:0 sc1 lds
    buffer_load_dwordx4 v15, s[8:11], s47 offen offset:1056 sc1 lds
    s_add_u32 m0, s66, 71808
    s_mov_b32 s47, 589824
    buffer_load_dwordx4 v14, s[8:11], s47 offen offset:0 sc1 lds
    buffer_load_dwordx4 v15, s[8:11], s47 offen offset:1056 sc1 lds
    s_add_u32 m0, s66, 76032
    s_mov_b32 s47, 655360
    buffer_load_dwordx4 v14, s[8:11], s47 offen offset:0 sc1 lds
    buffer_load_dwordx4 v15, s[8:11], s47 offen offset:1056 sc1 lds
    s_add_u32 m0, s66, 80256
    s_mov_b32 s47, 720896
    buffer_load_dwordx4 v14, s[8:11], s47 offen offset:0 sc1 lds
    buffer_load_dwordx4 v15, s[8:11], s47 offen offset:1056 sc1 lds
    s_barrier
    s_add_u32 m0, s66, 84480
    s_mov_b32 s47, 786432
    buffer_load_dwordx4 v14, s[8:11], s47 offen offset:0 sc1 lds
    buffer_load_dwordx4 v15, s[8:11], s47 offen offset:1056 sc1 lds
    s_add_u32 m0, s66, 88704
    s_mov_b32 s47, 851968
    buffer_load_dwordx4 v14, s[8:11], s47 offen offset:0 sc1 lds
    buffer_load_dwordx4 v15, s[8:11], s47 offen offset:1056 sc1 lds
    s_add_u32 m0, s66, 92928
    s_mov_b32 s47, 917504
    buffer_load_dwordx4 v14, s[8:11], s47 offen offset:0 sc1 lds
    buffer_load_dwordx4 v15, s[8:11], s47 offen offset:1056 sc1 lds
    s_add_u32 m0, s66, 97152
    s_mov_b32 s47, 983040
    buffer_load_dwordx4 v14, s[8:11], s47 offen offset:0 sc1 lds
    buffer_load_dwordx4 v15, s[8:11], s47 offen offset:1056 sc1 lds
L_rx:
    v_lshrrev_b32 v225, 4, v0
    v_and_b32 v227, 15, v0
    v_lshlrev_b32 v227, 4, v227
    v_lshl_add_u32 v225, v225, 9, v227
    v_or_b32 v225, s43, v225
    v_add_u32 v224, 1024, v225
    s_sub_u32 s86, s3, 4
    s_lshr_b32 s82, s2, 6
    s_lshl_b32 s82, s82, 2
    s_bfe_u32 s83, s2, 0x20003
    s_add_u32 s82, s82, s83
    s_lshl_b32 s82, s82, 1
    s_bfe_u32 s83, s2, 0x10005
    s_add_u32 s82, s82, s83
    s_lshl_b32 s82, s82, 2
    s_add_u32 s82, s82, s32
    s_lshl_b32 s82, s82, 4
    s_add_u32 s82, s82, s86
    s_lshl_b32 s82, s82, 14
    s_add_u32 s82, s82, 50331648
    s_lshl_b32 s83, s2, 11
    s_lshl_b32 s47, s86, 7
    s_add_u32 s83, s83, s47
    s_xor_b32 s83, s83, s79
    s_lshl_b32 s84, s86, 12
    s_add_u32 s84, s84, 135168
    s_add_u32 s85, s86, 14
    s_and_b32 s85, s85, 7
    s_mul_i32 s85, s85, 16896
    s_add_u32 s85, s85, 8448
    s_waitcnt vmcnt(0) lgkmcnt(0)
    s_barrier
    s_xor_b32 s47, s83, 6144
    s_add_u32 s47, s47, 46138880
    buffer_load_dword v226, off, s[20:23], s47 sc1
    s_mov_b32 s35, 100000
L_poll_9:
    s_waitcnt vmcnt(0)
    v_cmp_gt_u32 vcc, 1, v226
    s_nop 1
    s_and_b32 s33, vcc_lo, 0x1
    s_cbranch_scc0 L_pollok_10
    s_sub_u32 s35, s35, 1
    s_cbranch_scc1 L_pollok_10
    s_sleep 2
    buffer_load_dword v226, off, s[20:23], s47 sc1
    s_branch L_poll_9
L_pollok_10:
    s_add_u32 m0, s84, 0
    s_add_u32 s47, s82, 131072
    buffer_load_dwordx4 v225, s[20:23], s47 offen sc1 lds
    buffer_load_dwordx4 v224, s[20:23], s47 offen offset:1024 sc1 lds
    s_add_u32 m0, s84, 2048
    s_add_u32 s47, s82, 135168
    buffer_load_dwordx4 v225, s[20:23], s47 offen sc1 lds
    buffer_load_dwordx4 v224, s[20:23], s47 offen offset:1024 sc1 lds
    s_xor_b32 s47, s83, 2048
    s_add_u32 s47, s47, 46138880
    buffer_load_dword v226, off, s[20:23], s47 sc1
    s_mov_b32 s35, 100000
L_poll_11:
    s_waitcnt vmcnt(0)
    v_cmp_gt_u32 vcc, 2, v226
    s_nop 1
    s_and_b32 s33, vcc_lo, 0x1
    s_cbranch_scc0 L_pollok_12
    s_sub_u32 s35, s35, 1
    s_cbranch_scc1 L_pollok_12
    s_sleep 2
    buffer_load_dword v226, off, s[20:23], s47 sc1
    s_branch L_poll_11
L_pollok_12:
    s_add_u32 m0, s85, 0
    s_add_u32 s47, s82, 0
    buffer_load_dwordx4 v225, s[20:23], s47 offen sc1 lds
    buffer_load_dwordx4 v224, s[20:23], s47 offen offset:1024 sc1 lds
    s_add_u32 m0, s85, 2048
    s_add_u32 s47, s82, 4096
    buffer_load_dwordx4 v225, s[20:23], s47 offen sc1 lds
    buffer_load_dwordx4 v224, s[20:23], s47 offen offset:1024 sc1 lds
    s_xor_b32 s47, s83, 4096
    s_add_u32 s47, s47, 46138880
    buffer_load_dword v226, off, s[20:23], s47 sc1
    s_mov_b32 s35, 100000
L_poll_13:
    s_waitcnt vmcnt(0)
    v_cmp_gt_u32 vcc, 3, v226
    s_nop 1
    s_and_b32 s33, vcc_lo, 0x1
    s_cbranch_scc0 L_pollok_14
    s_sub_u32 s35, s35, 1
    s_cbranch_scc1 L_pollok_14
    s_sleep 2
    buffer_load_dword v226, off, s[20:23], s47 sc1
    s_branch L_poll_13
L_pollok_14:
    s_add_u32 m0, s85, 4096
    s_add_u32 s47, s82, 65536
    buffer_load_dwordx4 v225, s[20:23], s47 offen sc1 lds
    buffer_load_dwordx4 v224, s[20:23], s47 offen offset:1024 sc1 lds
    s_add_u32 m0, s85, 6144
    s_add_u32 s47, s82, 69632
    buffer_load_dwordx4 v225, s[20:23], s47 offen sc1 lds
    buffer_load_dwordx4 v224, s[20:23], s47 offen offset:1024 sc1 lds
    s_waitcnt vmcnt(0)
    s_endpgm
L_helper:
    s_sub_u32 s45, s3, 6
    v_lshlrev_b32 v4, 4, v0
    v_lshlrev_b32 v5, 2, v0
    v_mov_b32 v6, 0
    v_mov_b32 v7, 1
    v_lshlrev_b32 v8, 7, v0
    s_lshl_b32 s46, s32, 3
    s_add_u32 s46, s46, s41
    s_lshl_b32 s47, s36, 5
    s_add_u32 s46, s46, s47
    s_waitcnt lgkmcnt(0)
    s_mov_b32 s20, s26
    s_mov_b32 s21, s27
    s_mov_b32 s22, 0x10000000
    s_mov_b32 s23, 0x20000
    s_mov_b32 s28, s4
    s_mov_b32 s29, s5
    s_mov_b32 s30, 0x400000
    s_mov_b32 s31, 0x20000
    s_mov_b32 s92, s24
    s_mov_b32 s93, s25
    s_mov_b32 s94, 0x100
    s_mov_b32 s95, 0x20000
    v_mov_b32 v12, -1
    v_mov_b32 v13, -1
    v_mov_b32 v14, -1
    v_mov_b32 v15, -1
    s_mov_b32 s33, 0x10000000
    s_lshl_b32 s88, s39, 3
    s_add_u32 s88, s88, s36
    s_mul_i32 s88, s88, 9216
    s_add_u32 s88, s88, 41943040
    s_mul_i32 s89, s39, 6144
    s_lshl_b32 s47, s36, 10
    s_add_u32 s89, s89, s47
    s_add_u32 s89, s89, 43515904
    s_cmp_ge_u32 s36, 6
    s_cselect_b32 s89, s33, s89
    s_cmp_ge_u32 s38, 2
    s_cselect_b32 s88, s33, s88
    s_cselect_b32 s89, s33, s89
    s_or_b32 s33, s2, s45
    s_cbranch_scc1 L_z_15
    v_mov_b32 v16, 0
    v_mov_b32 v17, 0
    v_mov_b32 v18, 0
    v_mov_b32 v19, 0
    s_mov_b32 s47, 46727168
    s_mov_b32 s33, 46731264
    buffer_store_dwordx4 v[16:19], v4, s[20:23], s47 offen offset:0 sc1
    buffer_store_dwordx4 v[16:19], v4, s[20:23], s47 offen offset:1024 sc1
    buffer_store_dwordx4 v[16:19], v4, s[20:23], s47 offen offset:2048 sc1
    buffer_store_dwordx4 v[16:19], v4, s[20:23], s47 offen offset:3072 sc1
    buffer_store_dwordx4 v[16:19], v4, s[20:23], s33 offen offset:0 sc1
    buffer_store_dwordx4 v[16:19], v4, s[20:23], s33 offen offset:1024 sc1
    buffer_store_dwordx4 v[16:19], v4, s[20:23], s33 offen offset:2048 sc1
    buffer_store_dwordx4 v[16:19], v4, s[20:23], s33 offen offset:3072 sc1
    s_mov_b32 s47, 46923776
    s_mov_b32 s33, 46931968
    buffer_store_dwordx4 v[16:19], v4, s[20:23], s47 offen sc1
    buffer_store_dwordx4 v[16:19], v4, s[20:23], s33 offen sc1
L_z_15:
    s_mov_b32 s90, -1
    s_mov_b32 s91, -1
    s_mov_b32 s60, s14
    s_mov_b32 s61, s15
    s_mov_b32 s62, 0x700000
    s_mov_b32 s63, 0x20000
    s_mov_b32 s64, s8
    s_mov_b32 s65, s9
    s_mov_b32 s66, 0x200000
    s_mov_b32 s67, 0x20000
    s_cmp_lg_u32 s45, 0
    s_cbranch_scc1 L_h_one
    s_barrier
    s_barrier
    s_waitcnt vmcnt(0)
    s_barrier
    s_cmp_lg_u32 s2, 0
    s_cbranch_scc1 L_w0_16
    s_mov_b32 s47, 46923776
    s_memtime s[48:49]
    s_waitcnt lgkmcnt(0)
    s_load_dword s33, s[26:27], s47
    s_waitcnt lgkmcnt(0)
    s_memtime s[50:51]
    s_waitcnt lgkmcnt(0)
    s_sub_u32 s33, s50, s48
    s_min_u32 s90, s90, s33
L_w0_16:
    s_barrier
    v_mov_b32 v16, 0
    v_mov_b32 v17, 0
    v_mov_b32 v18, 0
    v_mov_b32 v19, 0
    s_lshl_b32 s47, s2, 11
    s_add_u32 s47, s47, 46137344
    buffer_store_dwordx4 v[16:19], v4, s[20:23], s47 offen sc1
    buffer_store_dwordx4 v[16:19], v4, s[20:23], s47 offen offset:1024 sc1
    s_cmp_lg_u32 s2, 0
    s_cbranch_scc1 L_w0_17
    s_mov_b32 s47, 46931968
    s_memtime s[48:49]
    s_waitcnt lgkmcnt(0)
    s_load_dword s33, s[26:27], s47
    s_waitcnt lgkmcnt(0)
    s_memtime s[50:51]
    s_waitcnt lgkmcnt(0)
    s_sub_u32 s33, s50, s48
    s_min_u32 s91, s91, s33
L_w0_17:
    s_barrier
    buffer_store_dwordx4 v[12:15], v4, s[20:23], s89 offen sc1
    s_mov_b64 exec, 0xff
    s_lshl_b32 s47, s46, 7
    s_add_u32 s47, s47, 46661632
    buffer_store_dwordx4 v[12:15], v4, s[20:23], s47 offen sc1
    s_mov_b64 exec, -1
    s_cmp_lg_u32 s2, 0
    s_cbranch_scc1 L_w0_18
    s_mov_b32 s47, 46923904
    s_memtime s[48:49]
    s_waitcnt lgkmcnt(0)
    s_load_dword s33, s[26:27], s47
    s_waitcnt lgkmcnt(0)
    s_memtime s[50:51]
    s_waitcnt lgkmcnt(0)
    s_sub_u32 s33, s50, s48
    s_min_u32 s90, s90, s33
L_w0_18:
    s_barrier
    buffer_store_dwordx4 v[12:15], v4, s[20:23], s88 offen sc1
    s_add_u32 s88, s88, 1024
    s_cmp_lg_u32 s2, 0
    s_cbranch_scc1 L_w0_19
    s_mov_b32 s47, 46932096
    s_memtime s[48:49]
    s_waitcnt lgkmcnt(0)
    s_load_dword s33, s[26:27], s47
    s_waitcnt lgkmcnt(0)
    s_memtime s[50:51]
    s_waitcnt lgkmcnt(0)
    s_sub_u32 s33, s50, s48
    s_min_u32 s91, s91, s33
L_w0_19:
    s_barrier
    buffer_store_dwordx4 v[12:15], v4, s[20:23], s88 offen sc1
    s_add_u32 s88, s88, 1024
    s_cmp_lg_u32 s2, 0
    s_cbranch_scc1 L_w0_20
    s_mov_b32 s47, 46924032
    s_memtime s[48:49]
    s_waitcnt lgkmcnt(0)
    s_load_dword s33, s[26:27], s47
    s_waitcnt lgkmcnt(0)
    s_memtime s[50:51]
    s_waitcnt lgkmcnt(0)
    s_sub_u32 s33, s50, s48
    s_min_u32 s90, s90, s33
L_w0_20:
    s_barrier
    buffer_store_dwordx4 v[12:15], v4, s[20:23], s88 offen sc1
    s_add_u32 s88, s88, 1024
    s_cmp_lg_u32 s2, 0
    s_cbranch_scc1 L_w0_21
    s_mov_b32 s47, 46932224
    s_memtime s[48:49]
    s_waitcnt lgkmcnt(0)
    s_load_dword s33, s[26:27], s47
    s_waitcnt lgkmcnt(0)
    s_memtime s[50:51]
    s_waitcnt lgkmcnt(0)
    s_sub_u32 s33, s50, s48
    s_min_u32 s91, s91, s33
L_w0_21:
    s_barrier
    buffer_store_dwordx4 v[12:15], v4, s[20:23], s88 offen sc1
    s_add_u32 s88, s88, 1024
    s_cmp_lg_u32 s2, 0
    s_cbranch_scc1 L_w0_22
    s_mov_b32 s47, 46924160
    s_memtime s[48:49]
    s_waitcnt lgkmcnt(0)
    s_load_dword s33, s[26:27], s47
    s_waitcnt lgkmcnt(0)
    s_memtime s[50:51]
    s_waitcnt lgkmcnt(0)
    s_sub_u32 s33, s50, s48
    s_min_u32 s90, s90, s33
L_w0_22:
    s_barrier
    buffer_store_dwordx4 v[12:15], v4, s[20:23], s88 offen sc1
    s_add_u32 s88, s88, 1024
    s_cmp_lg_u32 s2, 0
    s_cbranch_scc1 L_w0_23
    s_mov_b32 s47, 46932352
    s_memtime s[48:49]
    s_waitcnt lgkmcnt(0)
    s_load_dword s33, s[26:27], s47
    s_waitcnt lgkmcnt(0)
    s_memtime s[50:51]
    s_waitcnt lgkmcnt(0)
    s_sub_u32 s33, s50, s48
    s_min_u32 s91, s91, s33
L_w0_23:
    s_barrier
    buffer_store_dwordx4 v[12:15], v4, s[20:23], s88 offen sc1
    s_add_u32 s88, s88, 1024
    s_cmp_lg_u32 s2, 0
    s_cbranch_scc1 L_w0_24
    s_mov_b32 s47, 46924288
    s_memtime s[48:49]
    s_waitcnt lgkmcnt(0)
    s_load_dword s33, s[26:27], s47
    s_waitcnt lgkmcnt(0)
    s_memtime s[50:51]
    s_waitcnt lgkmcnt(0)
    s_sub_u32 s33, s50, s48
    s_min_u32 s90, s90, s33
L_w0_24:
    s_barrier
    buffer_store_dwordx4 v[12:15], v4, s[20:23], s88 offen sc1
    s_add_u32 s88, s88, 1024
    s_cmp_lg_u32 s2, 0
    s_cbranch_scc1 L_w0_25
    s_mov_b32 s47, 46932480
    s_memtime s[48:49]
    s_waitcnt lgkmcnt(0)
    s_load_dword s33, s[26:27], s47
    s_waitcnt lgkmcnt(0)
    s_memtime s[50:51]
    s_waitcnt lgkmcnt(0)
    s_sub_u32 s33, s50, s48
    s_min_u32 s91, s91, s33
L_w0_25:
    s_cmp_lg_u32 s2, 0
    s_cbranch_scc1 L_w0_26
    s_cmp_lt_u32 s91, s90
    s_cselect_b32 s33, 0x2001, 1
    v_mov_b32 v23, s33
    s_mov_b64 exec, 1
    buffer_store_dword v23, off, s[92:95], 0 sc1
    s_mov_b64 exec, -1
L_w0_26:
    s_barrier
    buffer_store_dwordx4 v[12:15], v4, s[20:23], s88 offen sc1
    s_add_u32 s88, s88, 1024
    s_barrier
    buffer_store_dwordx4 v[12:15], v4, s[20:23], s88 offen sc1
    s_add_u32 s88, s88, 1024
    s_barrier
    buffer_load_dword v23, off, s[92:95], 0 sc1
    s_barrier
    s_barrier
    s_waitcnt vmcnt(0)
    v_cmp_eq_u32 vcc, 0, v23
    s_cbranch_vccz L_rdy_27
    buffer_load_dword v23, off, s[92:95], 0 sc1
    s_mov_b32 s35, 100000
L_poll_28:
    s_waitcnt vmcnt(0)
    v_cmp_eq_u32 vcc, 0, v23
    s_nop 1
    s_and_b32 s33, vcc_lo, 0x1
    s_cbranch_scc0 L_pollok_29
    s_sub_u32 s35, s35, 1
    s_cbranch_scc1 L_pollok_29
    s_sleep 2
    buffer_load_dword v23, off, s[92:95], 0 sc1
    s_branch L_poll_28
L_pollok_29:
L_rdy_27:
    v_and_b32 v23, 0x2000, v23
    v_mov_b32 v22, 163832
    ds_write_b32 v22, v23
    s_lshr_b32 s47, s2, 2
    s_lshl_b32 s47, s47, 7
    s_and_b32 s33, s2, 3
    s_lshl_b32 s33, s33, 2
    s_add_u32 s47, s47, s33
    s_add_u32 s47, s47, 46727168
    s_mov_b64 exec, 1
    buffer_store_dword v7, off, s[20:23], s47 sc1
    s_mov_b64 exec, -1
    s_waitcnt lgkmcnt(0)
    s_barrier
    s_barrier
    s_barrier
    s_barrier
    s_barrier
    s_barrier
    s_mov_b32 s47, 46727168
    buffer_load_dwordx4 v[16:19], v8, s[20:23], s47 offen sc1
    s_barrier
    s_barrier
    s_mov_b32 s35, 100000
L_poll_30:
    s_waitcnt vmcnt(0)
    v_and_b32 v14, v16, v17
    v_and_b32 v15, v18, v19
    v_and_b32 v14, v14, v15
    v_cmp_ne_u32 vcc, 1, v14
    s_nop 1
    s_cmp_lg_u64 vcc, 0
    s_cbranch_scc0 L_pollok_31
    s_sub_u32 s35, s35, 1
    s_cbranch_scc1 L_pollok_31
    s_sleep 2
    s_mov_b32 s47, 46727168
    buffer_load_dwordx4 v[16:19], v8, s[20:23], s47 offen sc1
    s_branch L_poll_30
L_pollok_31:
    s_mov_b64 exec, 0xffff
    buffer_load_dword v9, v8, s[96:99], s100 offen
    s_mov_b64 exec, -1
    s_barrier
    s_barrier
    s_barrier
    s_barrier
    s_barrier
    s_barrier
    v_mov_b32 v227, 163832
    ds_read_b32 v227, v227
    s_waitcnt lgkmcnt(0)
    v_readfirstlane_b32 s79, v227
    s_nop 1
    s_xor_b32 s43, s43, s79
    v_bfe_u32 v11, v0, 2, 3
    v_and_b32 v12, 3, v0
    v_lshlrev_b32 v12, 7, v12
    v_lshl_add_u32 v11, v11, 16, v12
    s_and_b32 s52, s2, 31
    s_lshl_b32 s52, s52, 11
    s_add_u32 s52, s52, 46137344
    s_xor_b32 s52, s52, s79
    s_add_u32 s54, s52, 512
    v_and_b32 v12, 1, v0
    v_lshlrev_b32 v12, 16, v12
    v_bfe_u32 v16, v0, 1, 1
    v_lshl_add_u32 v12, v16, 18, v12
    v_bfe_u32 v16, v0, 2, 2
    v_lshl_add_u32 v12, v16, 11, v12
    s_andn2_b32 s56, s52, 0x1800
    s_add_u32 s56, s56, 132096
    s_lshl_b32 s57, s36, 12
    s_add_u32 s57, s57, 46661632
    v_lshrrev_b32 v19, 1, v0
    v_and_b32 v16, 1, v0
    v_lshlrev_b32 v16, 4, v16
    v_lshl_add_u32 v19, v19, 7, v16
    v_add_u32 v13, 162816, v4
    s_barrier
    s_barrier
    s_cmp_ge_u32 s38, 2
    s_cbranch_scc1 L_ro_32
    s_mov_b64 exec, 0xffffffff
    buffer_load_dword v14, v11, s[20:23], s52 offen sc1
    s_mov_b64 exec, -1
    s_mov_b32 s35, 100000
L_poll_33:
    s_waitcnt vmcnt(0)
    v_cmp_ne_u32 vcc, 1, v14
    s_nop 1
    s_and_b32 s33, vcc_lo, 0xffffffff
    s_cbranch_scc0 L_pollok_34
    s_sub_u32 s35, s35, 1
    s_cbranch_scc1 L_pollok_34
    s_sleep 2
    s_mov_b64 exec, 0xffffffff
    buffer_load_dword v14, v11, s[20:23], s52 offen sc1
    s_mov_b64 exec, -1
    s_branch L_poll_33
L_pollok_34:
L_ro_32:
    s_barrier
    s_cmp_ge_u32 s38, 2
    s_cbranch_scc0 L_ro_35
    s_mov_b64 exec, 0xffffffff
    buffer_load_dword v14, v11, s[20:23], s52 offen sc1
    s_mov_b64 exec, -1
L_ro_35:
    s_call_b64 s[84:85], L_qp0
    s_cmp_ge_u32 s38, 2
    s_cbranch_scc0 L_ro_37
    s_mov_b32 s35, 100000
L_poll_38:
    s_waitcnt vmcnt(0)
    v_cmp_ne_u32 vcc, 1, v14
    s_nop 1
    s_and_b32 s33, vcc_lo, 0xffffffff
    s_cbranch_scc0 L_pollok_39
    s_sub_u32 s35, s35, 1
    s_cbranch_scc1 L_pollok_39
    s_sleep 2
    s_mov_b64 exec, 0xffffffff
    buffer_load_dword v14, v11, s[20:23], s52 offen sc1
    s_mov_b64 exec, -1
    s_branch L_poll_38
L_pollok_39:
L_ro_37:
    s_barrier
    s_cmp_lt_u32 s38, 2
    s_cbranch_scc1 L_qc_40
    s_call_b64 s[84:85], L_qp1
L_qc_40:
    s_barrier
    s_cmp_lt_u32 s38, 2
    s_cbranch_scc1 L_qc_41
    s_call_b64 s[84:85], L_qp2
L_qc_41:
    s_barrier
    buffer_load_dwordx4 v[24:27], v19, s[20:23], s57 offen sc1
    s_cmp_lt_u32 s38, 2
    s_cbranch_scc1 L_qc_42
    s_call_b64 s[84:85], L_qp3
L_qc_42:
    s_barrier
    s_mov_b32 s35, 100000
L_poll_43:
    s_waitcnt vmcnt(0)
    v_max3_u32 v14, v24, v25, v26
    v_max_u32 v14, v14, v27
    v_cmp_eq_u32 vcc, -1, v14
    s_nop 1
    s_cmp_lg_u64 vcc, 0
    s_cbranch_scc0 L_pollok_44
    s_sub_u32 s35, s35, 1
    s_cbranch_scc1 L_pollok_44
    s_sleep 2
    buffer_load_dwordx4 v[24:27], v19, s[20:23], s57 offen sc1
    s_branch L_poll_43
L_pollok_44:
    ds_write_b128 v13, v[24:27]
    s_mov_b64 exec, 0xffffffff
    buffer_load_dword v14, v11, s[20:23], s54 offen sc1
    s_mov_b64 exec, -1
    s_cmp_lt_u32 s38, 2
    s_cbranch_scc1 L_qc_45
    s_call_b64 s[84:85], L_qp4
L_qc_45:
    s_barrier
    s_mov_b32 s35, 100000
L_poll_46:
    s_waitcnt vmcnt(0)
    v_cmp_ne_u32 vcc, 1, v14
    s_nop 1
    s_and_b32 s33, vcc_lo, 0xffffffff
    s_cbranch_scc0 L_pollok_47
    s_sub_u32 s35, s35, 1
    s_cbranch_scc1 L_pollok_47
    s_sleep 2
    s_mov_b64 exec, 0xffffffff
    buffer_load_dword v14, v11, s[20:23], s54 offen sc1
    s_mov_b64 exec, -1
    s_branch L_poll_46
L_pollok_47:
    s_waitcnt lgkmcnt(0)
    s_barrier
    s_barrier
    s_cmp_lt_u32 s38, 2
    s_cbranch_scc1 L_qc_48
    s_call_b64 s[84:85], L_q4
L_qc_48:
    s_barrier
    s_cmp_lt_u32 s38, 2
    s_cbranch_scc1 L_qc_49
    s_call_b64 s[84:85], L_q5
L_qc_49:
    s_barrier
    s_cmp_lt_u32 s38, 2
    s_cbranch_scc1 L_qc_50
    s_call_b64 s[84:85], L_q6
L_qc_50:
    s_barrier
    s_barrier
    s_mov_b64 exec, 0xffff
    buffer_load_dword v14, v12, s[20:23], s56 offen sc1
    s_mov_b64 exec, -1
    s_mov_b32 s35, 100000
L_poll_51:
    s_waitcnt vmcnt(0)
    v_cmp_ne_u32 vcc, 1, v14
    s_nop 1
    s_and_b32 s33, vcc_lo, 0xffff
    s_cbranch_scc0 L_pollok_52
    s_sub_u32 s35, s35, 1
    s_cbranch_scc1 L_pollok_52
    s_sleep 2
    s_mov_b64 exec, 0xffff
    buffer_load_dword v14, v12, s[20:23], s56 offen sc1
    s_mov_b64 exec, -1
    s_branch L_poll_51
L_pollok_52:
    s_barrier
    s_barrier
    s_branch L_rx
L_h_one:
    s_mov_b32 s34, 0
    s_lshr_b32 s69, s2, 3
    s_mov_b32 s48, 0xb9874210
    s_mov_b32 s49, 0xd6ca53
    s_lshr_b32 s33, s68, 5
    s_lshr_b32 s90, 0x1f0, s33
L_pf_53:
    s_add_u32 s47, s34, 6
    s_mul_i32 s47, s47, 17
    s_lshr_b32 s47, s47, 1
    s_min_u32 s47, s47, 272
    s_cmp_ge_u32 s68, s47
    s_cbranch_scc1 L_pf_54
    s_mul_hi_u32 s47, s68, 252645136
    s_mul_i32 s33, s47, 17
    s_sub_u32 s33, s68, s33
    s_lshl_b32 s50, s47, 1
    s_add_u32 s50, s50, s87
    s_lshl_b32 s50, s50, 5
    s_mul_i32 s51, s32, 7
    s_add_u32 s51, s51, s33
    s_sub_u32 s51, s51, 10
    s_sub_u32 s35, s33, 4
    s_lshr_b32 s54, s35, 1
    s_lshl_b32 s54, s54, 2
    s_add_u32 s54, s54, s32
    s_lshl_b32 s54, s54, 1
    s_and_b32 s35, s35, 1
    s_add_u32 s35, s35, s54
    s_movk_i32 s55, 7168
    s_mov_b32 s54, 0x700000
    s_cmp_lt_u32 s33, 10
    s_cselect_b32 s51, s35, s51
    s_cselect_b32 s35, 6144, s55
    s_cselect_b32 s54, 0x600000, s54
    s_mul_i32 s50, s50, s35
    s_lshl_b32 s51, s51, 8
    s_add_u32 s50, s50, s51
    s_lshl_b32 s51, s44, 2
    s_add_u32 s51, s51, s33
    s_lshl_b32 s51, s51, 17
    s_lshl_b32 s47, s47, 7
    s_add_u32 s47, s47, s51
    s_cmp_lt_u32 s33, 4
    s_cselect_b32 s47, s47, s50
    s_cselect_b32 s35, 4096, s35
    s_cselect_b32 s50, 11, 7
    s_cselect_b32 s54, 0x400000, s54
    s_mov_b32 s55, 0x20000
    v_lshrrev_b32 v10, 1, v0
    v_and_b32 v11, 1, v0
    v_mul_lo_u32 v10, v10, s35
    v_lshl_add_u32 v10, v11, s50, v10
    s_cmp_lt_u32 s33, 10
    s_cselect_b64 s[52:53], s[6:7], s[12:13]
    s_cmp_lt_u32 s33, 4
    s_cselect_b64 s[52:53], s[4:5], s[52:53]
    buffer_load_dword v9, v10, s[52:55], s47 offen
    s_add_u32 s68, s68, 32
L_pf_55:
    s_lshr_b32 s90, s90, 1
    s_bitcmp1_b32 s90, 0
    s_cbranch_scc0 L_pf_53
    s_cmp_ge_u32 s69, 112
    s_cbranch_scc1 L_pw_59
    s_lshr_b32 s47, s69, 3
    s_lshl_b32 s47, s47, 2
    s_lshr_b64 s[50:51], s[48:49], s47
    s_and_b32 s50, s50, 15
    s_mul_i32 s47, s32, 14
    s_add_u32 s47, s47, s50
    s_lshl_b32 s47, s47, 1
    s_add_u32 s47, s47, s87
    s_lshl_b32 s47, s47, 3
    s_and_b32 s50, s69, 7
    s_add_u32 s47, s47, s50
    s_lshl_b32 s47, s47, 13
    buffer_load_dword v9, v8, s[60:63], s47 offen
    s_branch L_pw_58
L_pw_59:
    s_sub_u32 s47, s69, 112
    s_lshl_b32 s47, s47, 3
    s_add_u32 s47, s47, s44
    s_lshl_b32 s47, s47, 13
    buffer_load_dword v9, v8, s[64:67], s47 offen
L_pw_58:
    s_add_u32 s69, s69, 32
    s_branch L_pf_53
L_pf_54:
    s_barrier
    s_add_u32 s34, s34, 1
    s_cmp_lt_u32 s34, 27
    s_cbranch_scc1 L_pf_53
    s_mov_b32 s52, s16
    s_mov_b32 s53, s17
    s_mov_b32 s54, 0x800
    s_mov_b32 s55, 0x20000
    s_lshl_b32 s47, s46, 14
    buffer_load_dwordx4 v[24:27], v4, s[52:55], 0 offen offset:0
    buffer_load_dwordx4 v[28:31], v4, s[52:55], 0 offen offset:1024
    buffer_load_dwordx4 v[40:43], v4, s[28:31], s47 offen offset:0
    buffer_load_dwordx4 v[44:47], v4, s[28:31], s47 offen offset:1024
    buffer_load_dwordx4 v[48:51], v4, s[28:31], s47 offen offset:2048
    buffer_load_dwordx4 v[52:55], v4, s[28:31], s47 offen offset:3072
    s_add_u32 s47, s47, 4096
    buffer_load_dwordx4 v[56:59], v4, s[28:31], s47 offen offset:0
    buffer_load_dwordx4 v[60:63], v4, s[28:31], s47 offen offset:1024
    buffer_load_dwordx4 v[64:67], v4, s[28:31], s47 offen offset:2048
    buffer_load_dwordx4 v[68:71], v4, s[28:31], s47 offen offset:3072
    s_add_u32 s47, s47, 4096
    s_barrier
    buffer_load_dwordx4 v[72:75], v4, s[28:31], s47 offen offset:0
    buffer_load_dwordx4 v[76:79], v4, s[28:31], s47 offen offset:1024
    buffer_load_dwordx4 v[80:83], v4, s[28:31], s47 offen offset:2048
    buffer_load_dwordx4 v[84:87], v4, s[28:31], s47 offen offset:3072
    s_add_u32 s47, s47, 4096
    buffer_load_dwordx4 v[88:91], v4, s[28:31], s47 offen offset:0
    buffer_load_dwordx4 v[92:95], v4, s[28:31], s47 offen offset:1024
    buffer_load_dwordx4 v[96:99], v4, s[28:31], s47 offen offset:2048
    buffer_load_dwordx4 v[100:103], v4, s[28:31], s47 offen offset:3072
    s_add_u32 s47, s47, 4096
    s_barrier
    s_barrier
    s_barrier
    v_mov_b32 v227, 163832
    ds_read_b32 v227, v227
    s_waitcnt lgkmcnt(0)
    v_readfirstlane_b32 s79, v227
    s_nop 1
    s_xor_b32 s43, s43, s79
    v_mov_b32 v32, 0
    v_mov_b32 v33, 0
    v_mov_b32 v34, 0
    v_mov_b32 v35, 0
    v_mov_b32 v36, 0
    v_mov_b32 v37, 0
    v_mov_b32 v38, 0
    v_mov_b32 v39, 0
    s_barrier
    s_barrier
    s_waitcnt vmcnt(0)
    v_dot2_f32_bf16 v32, v40, v24, v32
    v_dot2_f32_bf16 v33, v48, v24, v33
    v_dot2_f32_bf16 v34, v56, v24, v34
    v_dot2_f32_bf16 v35, v64, v24, v35
    v_dot2_f32_bf16 v36, v72, v24, v36
    v_dot2_f32_bf16 v37, v80, v24, v37
    v_dot2_f32_bf16 v38, v88, v24, v38
    v_dot2_f32_bf16 v39, v96, v24, v39
    v_dot2_f32_bf16 v32, v41, v25, v32
    v_dot2_f32_bf16 v33, v49, v25, v33
    v_dot2_f32_bf16 v34, v57, v25, v34
    v_dot2_f32_bf16 v35, v65, v25, v35
    v_dot2_f32_bf16 v36, v73, v25, v36
    v_dot2_f32_bf16 v37, v81, v25, v37
    v_dot2_f32_bf16 v38, v89, v25, v38
    v_dot2_f32_bf16 v39, v97, v25, v39
    v_dot2_f32_bf16 v32, v42, v26, v32
    v_dot2_f32_bf16 v33, v50, v26, v33
    v_dot2_f32_bf16 v34, v58, v26, v34
    v_dot2_f32_bf16 v35, v66, v26, v35
    v_dot2_f32_bf16 v36, v74, v26, v36
    v_dot2_f32_bf16 v37, v82, v26, v37
    v_dot2_f32_bf16 v38, v90, v26, v38
    v_dot2_f32_bf16 v39, v98, v26, v39
    v_dot2_f32_bf16 v32, v43, v27, v32
    v_dot2_f32_bf16 v33, v51, v27, v33
    v_dot2_f32_bf16 v34, v59, v27, v34
    v_dot2_f32_bf16 v35, v67, v27, v35
    v_dot2_f32_bf16 v36, v75, v27, v36
    v_dot2_f32_bf16 v37, v83, v27, v37
    v_dot2_f32_bf16 v38, v91, v27, v38
    v_dot2_f32_bf16 v39, v99, v27, v39
    v_dot2_f32_bf16 v32, v44, v28, v32
    v_dot2_f32_bf16 v33, v52, v28, v33
    v_dot2_f32_bf16 v34, v60, v28, v34
    v_dot2_f32_bf16 v35, v68, v28, v35
    v_dot2_f32_bf16 v36, v76, v28, v36
    v_dot2_f32_bf16 v37, v84, v28, v37
    v_dot2_f32_bf16 v38, v92, v28, v38
    v_dot2_f32_bf16 v39, v100, v28, v39
    v_dot2_f32_bf16 v32, v45, v29, v32
    v_dot2_f32_bf16 v33, v53, v29, v33
    v_dot2_f32_bf16 v34, v61, v29, v34
    v_dot2_f32_bf16 v35, v69, v29, v35
    v_dot2_f32_bf16 v36, v77, v29, v36
    v_dot2_f32_bf16 v37, v85, v29, v37
    v_dot2_f32_bf16 v38, v93, v29, v38
    v_dot2_f32_bf16 v39, v101, v29, v39
    v_dot2_f32_bf16 v32, v46, v30, v32
    v_dot2_f32_bf16 v33, v54, v30, v33
    v_dot2_f32_bf16 v34, v62, v30, v34
    v_dot2_f32_bf16 v35, v70, v30, v35
    v_dot2_f32_bf16 v36, v78, v30, v36
    v_dot2_f32_bf16 v37, v86, v30, v37
    v_dot2_f32_bf16 v38, v94, v30, v38
    v_dot2_f32_bf16 v39, v102, v30, v39
    v_dot2_f32_bf16 v32, v47, v31, v32
    v_dot2_f32_bf16 v33, v55, v31, v33
    v_dot2_f32_bf16 v34, v63, v31, v34
    v_dot2_f32_bf16 v35, v71, v31, v35
    v_dot2_f32_bf16 v36, v79, v31, v36
    v_dot2_f32_bf16 v37, v87, v31, v37
    v_dot2_f32_bf16 v38, v95, v31, v38
    v_dot2_f32_bf16 v39, v103, v31, v39
    s_barrier
    s_nop 0
    v_add_f32_dpp v32, v32, v32 quad_perm:[1,0,3,2] row_mask:0xf bank_mask:0xf
    v_add_f32_dpp v33, v33, v33 quad_perm:[1,0,3,2] row_mask:0xf bank_mask:0xf
    v_add_f32_dpp v34, v34, v34 quad_perm:[1,0,3,2] row_mask:0xf bank_mask:0xf
    v_add_f32_dpp v35, v35, v35 quad_perm:[1,0,3,2] row_mask:0xf bank_mask:0xf
    v_add_f32_dpp v36, v36, v36 quad_perm:[1,0,3,2] row_mask:0xf bank_mask:0xf
    v_add_f32_dpp v37, v37, v37 quad_perm:[1,0,3,2] row_mask:0xf bank_mask:0xf
    v_add_f32_dpp v38, v38, v38 quad_perm:[1,0,3,2] row_mask:0xf bank_mask:0xf
    v_add_f32_dpp v39, v39, v39 quad_perm:[1,0,3,2] row_mask:0xf bank_mask:0xf
    v_add_f32_dpp v32, v32, v32 quad_perm:[2,3,0,1] row_mask:0xf bank_mask:0xf
    v_add_f32_dpp v33, v33, v33 quad_perm:[2,3,0,1] row_mask:0xf bank_mask:0xf
    v_add_f32_dpp v34, v34, v34 quad_perm:[2,3,0,1] row_mask:0xf bank_mask:0xf
    v_add_f32_dpp v35, v35, v35 quad_perm:[2,3,0,1] row_mask:0xf bank_mask:0xf
    v_add_f32_dpp v36, v36, v36 quad_perm:[2,3,0,1] row_mask:0xf bank_mask:0xf
    v_add_f32_dpp v37, v37, v37 quad_perm:[2,3,0,1] row_mask:0xf bank_mask:0xf
    v_add_f32_dpp v38, v38, v38 quad_perm:[2,3,0,1] row_mask:0xf bank_mask:0xf
    v_add_f32_dpp v39, v39, v39 quad_perm:[2,3,0,1] row_mask:0xf bank_mask:0xf
    v_add_f32_dpp v32, v32, v32 row_half_mirror row_mask:0xf bank_mask:0xf
    v_add_f32_dpp v33, v33, v33 row_half_mirror row_mask:0xf bank_mask:0xf
    v_add_f32_dpp v34, v34, v34 row_half_mirror row_mask:0xf bank_mask:0xf
    v_add_f32_dpp v35, v35, v35 row_half_mirror row_mask:0xf bank_mask:0xf
    v_add_f32_dpp v36, v36, v36 row_half_mirror row_mask:0xf bank_mask:0xf
    v_add_f32_dpp v37, v37, v37 row_half_mirror row_mask:0xf bank_mask:0xf
    v_add_f32_dpp v38, v38, v38 row_half_mirror row_mask:0xf bank_mask:0xf
    v_add_f32_dpp v39, v39, v39 row_half_mirror row_mask:0xf bank_mask:0xf
    v_add_f32_dpp v32, v32, v32 row_mirror row_mask:0xf bank_mask:0xf
    v_add_f32_dpp v33, v33, v33 row_mirror row_mask:0xf bank_mask:0xf
    v_add_f32_dpp v34, v34, v34 row_mirror row_mask:0xf bank_mask:0xf
    v_add_f32_dpp v35, v35, v35 row_mirror row_mask:0xf bank_mask:0xf
    v_add_f32_dpp v36, v36, v36 row_mirror row_mask:0xf bank_mask:0xf
    v_add_f32_dpp v37, v37, v37 row_mirror row_mask:0xf bank_mask:0xf
    v_add_f32_dpp v38, v38, v38 row_mirror row_mask:0xf bank_mask:0xf
    v_add_f32_dpp v39, v39, v39 row_mirror row_mask:0xf bank_mask:0xf
    v_add_f32_dpp v32, v32, v32 row_bcast:15 row_mask:0xa bank_mask:0xf
    v_add_f32_dpp v33, v33, v33 row_bcast:15 row_mask:0xa bank_mask:0xf
    v_add_f32_dpp v34, v34, v34 row_bcast:15 row_mask:0xa bank_mask:0xf
    v_add_f32_dpp v35, v35, v35 row_bcast:15 row_mask:0xa bank_mask:0xf
    v_add_f32_dpp v36, v36, v36 row_bcast:15 row_mask:0xa bank_mask:0xf
    v_add_f32_dpp v37, v37, v37 row_bcast:15 row_mask:0xa bank_mask:0xf
    v_add_f32_dpp v38, v38, v38 row_bcast:15 row_mask:0xa bank_mask:0xf
    v_add_f32_dpp v39, v39, v39 row_bcast:15 row_mask:0xa bank_mask:0xf
    v_add_f32_dpp v32, v32, v32 row_bcast:31 row_mask:0xc bank_mask:0xf
    v_add_f32_dpp v33, v33, v33 row_bcast:31 row_mask:0xc bank_mask:0xf
    v_add_f32_dpp v34, v34, v34 row_bcast:31 row_mask:0xc bank_mask:0xf
    v_add_f32_dpp v35, v35, v35 row_bcast:31 row_mask:0xc bank_mask:0xf
    v_add_f32_dpp v36, v36, v36 row_bcast:31 row_mask:0xc bank_mask:0xf
    v_add_f32_dpp v37, v37, v37 row_bcast:31 row_mask:0xc bank_mask:0xf
    v_add_f32_dpp v38, v38, v38 row_bcast:31 row_mask:0xc bank_mask:0xf
    v_add_f32_dpp v39, v39, v39 row_bcast:31 row_mask:0xc bank_mask:0xf
    v_readlane_b32 s52, v32, 63
    v_readlane_b32 s53, v33, 63
    v_readlane_b32 s54, v34, 63
    v_readlane_b32 s55, v35, 63
    v_readlane_b32 s56, v36, 63
    v_readlane_b32 s57, v37, 63
    v_readlane_b32 s58, v38, 63
    v_readlane_b32 s59, v39, 63
    s_nop 1
    v_writelane_b32 v16, s52, 0
    v_writelane_b32 v16, s53, 1
    v_writelane_b32 v16, s54, 2
    v_writelane_b32 v16, s55, 3
    v_writelane_b32 v16, s56, 4
    v_writelane_b32 v16, s57, 5
    v_writelane_b32 v16, s58, 6
    v_writelane_b32 v16, s59, 7
    s_nop 0
    v_min_f32 v16, 0x41f00000, v16
    v_mul_f32 v16, 0x3fb8aa3b, v16
    v_exp_f32 v16, v16
    s_lshl_b32 s47, s46, 7
    s_add_u32 s47, s47, 46661632
    s_mov_b64 exec, 0xff
    buffer_store_dword v16, v5, s[20:23], s47 offen sc1
    s_mov_b64 exec, -1
    s_call_b64 s[84:85], L_qp0
    s_mov_b32 s34, 1
    s_cmp_ge_u32 s38, 2
    s_cbranch_scc1 L_h1_q
    s_cmp_ge_u32 s36, 6
    s_cbranch_scc1 L_h1_end
    s_cmp_ge_u32 s36, 3
    s_cselect_b32 s55, 1, 0
    s_sub_u32 s56, s36, s55
    s_lshl_b32 s56, s56, 11
    v_add_u32 v10, s56, v4
    v_add_u32 v11, 1024, v10
    s_cmp_eq_u32 s36, 2
    s_cbranch_scc1 L_h1_z
    s_cmp_eq_u32 s36, 5
    s_cbranch_scc0 L_h1_nz
L_h1_z:
    s_lshl_b32 s55, s55, 5
    s_add_u32 s55, s55, 8192
    v_and_b32 v10, 0x300, v4
    v_add_u32 v10, s55, v10
    v_add_u32 v11, 16, v10
L_h1_nz:
    s_barrier
    s_setprio 2
    s_mov_b32 s34, 2
L_try_61:
    s_mul_i32 s47, s39, 73728
    s_add_u32 s47, s47, 41943040
    buffer_load_dwordx4 v[32:35], v10, s[20:23], s47 offen sc1
    buffer_load_dwordx4 v[36:39], v11, s[20:23], s47 offen sc1
    s_add_u32 s47, s47, 9216
    buffer_load_dwordx4 v[40:43], v10, s[20:23], s47 offen sc1
    buffer_load_dwordx4 v[44:47], v11, s[20:23], s47 offen sc1
    s_add_u32 s47, s47, 9216
    buffer_load_dwordx4 v[48:51], v10, s[20:23], s47 offen sc1
    buffer_load_dwordx4 v[52:55], v11, s[20:23], s47 offen sc1
    s_add_u32 s47, s47, 9216
    buffer_load_dwordx4 v[56:59], v10, s[20:23], s47 offen sc1
    buffer_load_dwordx4 v[60:63], v11, s[20:23], s47 offen sc1
    s_add_u32 s47, s47, 9216
    buffer_load_dwordx4 v[64:67], v10, s[20:23], s47 offen sc1
    buffer_load_dwordx4 v[68:71], v11, s[20:23], s47 offen sc1
    s_add_u32 s47, s47, 9216
    buffer_load_dwordx4 v[72:75], v10, s[20:23], s47 offen sc1
    buffer_load_dwordx4 v[76:79], v11, s[20:23], s47 offen sc1
    s_add_u32 s47, s47, 9216
    buffer_load_dwordx4 v[80:83], v10, s[20:23], s47 offen sc1
    buffer_load_dwordx4 v[84:87], v11, s[20:23], s47 offen sc1
    s_add_u32 s47, s47, 9216
    buffer_load_dwordx4 v[88:91], v10, s[20:23], s47 offen sc1
    buffer_load_dwordx4 v[92:95], v11, s[20:23], s47 offen sc1
    s_barrier
    s_add_u32 s34, s34, 1
    s_waitcnt vmcnt(0)
    v_max_u32 v14, v32, v33
    v_max3_u32 v14, v14, v34, v35
    v_max3_u32 v14, v14, v36, v37
    v_max3_u32 v14, v14, v38, v39
    v_max3_u32 v14, v14, v40, v41
    v_max3_u32 v14, v14, v42, v43
    v_max3_u32 v14, v14, v44, v45
    v_max3_u32 v14, v14, v46, v47
    v_max3_u32 v14, v14, v48, v49
    v_max3_u32 v14, v14, v50, v51
    v_max3_u32 v14, v14, v52, v53
    v_max3_u32 v14, v14, v54, v55
    v_max3_u32 v14, v14, v56, v57
    v_max3_u32 v14, v14, v58, v59
    v_max3_u32 v14, v14, v60, v61
    v_max3_u32 v14, v14, v62, v63
    v_max3_u32 v14, v14, v64, v65
    v_max3_u32 v14, v14, v66, v67
    v_max3_u32 v14, v14, v68, v69
    v_max3_u32 v14, v14, v70, v71
    v_max3_u32 v14, v14, v72, v73
    v_max3_u32 v14, v14, v74, v75
    v_max3_u32 v14, v14, v76, v77
    v_max3_u32 v14, v14, v78, v79
    v_max3_u32 v14, v14, v80, v81
    v_max3_u32 v14, v14, v82, v83
    v_max3_u32 v14, v14, v84, v85
    v_max3_u32 v14, v14, v86, v87
    v_max3_u32 v14, v14, v88, v89
    v_max3_u32 v14, v14, v90, v91
    v_max3_u32 v14, v14, v92, v93
    v_max3_u32 v14, v14, v94, v95
    v_cmp_eq_u32 vcc, -1, v14
    s_nop 1
    s_cmp_lg_u64 vcc, 0
    s_cbranch_scc0 L_try_62
    s_cmp_le_u32 s34, 8
    s_cbranch_scc1 L_try_61
    s_mul_i32 s47, s39, 73728
    s_add_u32 s47, s47, 41943040
    buffer_load_dwordx4 v[32:35], v10, s[20:23], s47 offen sc1
    buffer_load_dwordx4 v[36:39], v11, s[20:23], s47 offen sc1
    s_add_u32 s47, s47, 9216
    buffer_load_dwordx4 v[40:43], v10, s[20:23], s47 offen sc1
    buffer_load_dwordx4 v[44:47], v11, s[20:23], s47 offen sc1
    s_add_u32 s47, s47, 9216
    buffer_load_dwordx4 v[48:51], v10, s[20:23], s47 offen sc1
    buffer_load_dwordx4 v[52:55], v11, s[20:23], s47 offen sc1
    s_add_u32 s47, s47, 9216
    buffer_load_dwordx4 v[56:59], v10, s[20:23], s47 offen sc1
    buffer_load_dwordx4 v[60:63], v11, s[20:23], s47 offen sc1
    s_add_u32 s47, s47, 9216
    buffer_load_dwordx4 v[64:67], v10, s[20:23], s47 offen sc1
    buffer_load_dwordx4 v[68:71], v11, s[20:23], s47 offen sc1
    s_add_u32 s47, s47, 9216
    buffer_load_dwordx4 v[72:75], v10, s[20:23], s47 offen sc1
    buffer_load_dwordx4 v[76:79], v11, s[20:23], s47 offen sc1
    s_add_u32 s47, s47, 9216
    buffer_load_dwordx4 v[80:83], v10, s[20:23], s47 offen sc1
    buffer_load_dwordx4 v[84:87], v11, s[20:23], s47 offen sc1
    s_add_u32 s47, s47, 9216
    buffer_load_dwordx4 v[88:91], v10, s[20:23], s47 offen sc1
    buffer_load_dwordx4 v[92:95], v11, s[20:23], s47 offen sc1
    s_mov_b32 s35, 100000
L_poll_63:
    s_waitcnt vmcnt(0)
    v_max_u32 v14, v32, v33
    v_max3_u32 v14, v14, v34, v35
    v_max3_u32 v14, v14, v36, v37
    v_max3_u32 v14, v14, v38, v39
    v_max3_u32 v14, v14, v40, v41
    v_max3_u32 v14, v14, v42, v43
    v_max3_u32 v14, v14, v44, v45
    v_max3_u32 v14, v14, v46, v47
    v_max3_u32 v14, v14, v48, v49
    v_max3_u32 v14, v14, v50, v51
    v_max3_u32 v14, v14, v52, v53
    v_max3_u32 v14, v14, v54, v55
    v_max3_u32 v14, v14, v56, v57
    v_max3_u32 v14, v14, v58, v59
    v_max3_u32 v14, v14, v60, v61
    v_max3_u32 v14, v14, v62, v63
    v_max3_u32 v14, v14, v64, v65
    v_max3_u32 v14, v14, v66, v67
    v_max3_u32 v14, v14, v68, v69
    v_max3_u32 v14, v14, v70, v71
    v_max3_u32 v14, v14, v72, v73
    v_max3_u32 v14, v14, v74, v75
    v_max3_u32 v14, v14, v76, v77
    v_max3_u32 v14, v14, v78, v79
    v_max3_u32 v14, v14, v80, v81
    v_max3_u32 v14, v14, v82, v83
    v_max3_u32 v14, v14, v84, v85
    v_max3_u32 v14, v14, v86, v87
    v_max3_u32 v14, v14, v88, v89
    v_max3_u32 v14, v14, v90, v91
    v_max3_u32 v14, v14, v92, v93
    v_max3_u32 v14, v14, v94, v95
    v_cmp_eq_u32 vcc, -1, v14
    s_nop 1
    s_cmp_lg_u64 vcc, 0
    s_cbranch_scc0 L_pollok_64
    s_sub_u32 s35, s35, 1
    s_cbranch_scc1 L_pollok_64
    s_sleep 2
    s_mul_i32 s47, s39, 73728
    s_add_u32 s47, s47, 41943040
    buffer_load_dwordx4 v[32:35], v10, s[20:23], s47 offen sc1
    buffer_load_dwordx4 v[36:39], v11, s[20:23], s47 offen sc1
    s_add_u32 s47, s47, 9216
    buffer_load_dwordx4 v[40:43], v10, s[20:23], s47 offen sc1
    buffer_load_dwordx4 v[44:47], v11, s[20:23], s47 offen sc1
    s_add_u32 s47, s47, 9216
    buffer_load_dwordx4 v[48:51], v10, s[20:23], s47 offen sc1
    buffer_load_dwordx4 v[52:55], v11, s[20:23], s47 offen sc1
    s_add_u32 s47, s47, 9216
    buffer_load_dwordx4 v[56:59], v10, s[20:23], s47 offen sc1
    buffer_load_dwordx4 v[60:63], v11, s[20:23], s47 offen sc1
    s_add_u32 s47, s47, 9216
    buffer_load_dwordx4 v[64:67], v10, s[20:23], s47 offen sc1
    buffer_load_dwordx4 v[68:71], v11, s[20:23], s47 offen sc1
    s_add_u32 s47, s47, 9216
    buffer_load_dwordx4 v[72:75], v10, s[20:23], s47 offen sc1
    buffer_load_dwordx4 v[76:79], v11, s[20:23], s47 offen sc1
    s_add_u32 s47, s47, 9216
    buffer_load_dwordx4 v[80:83], v10, s[20:23], s47 offen sc1
    buffer_load_dwordx4 v[84:87], v11, s[20:23], s47 offen sc1
    s_add_u32 s47, s47, 9216
    buffer_load_dwordx4 v[88:91], v10, s[20:23], s47 offen sc1
    buffer_load_dwordx4 v[92:95], v11, s[20:23], s47 offen sc1
    s_branch L_poll_63
L_pollok_64:
L_try_62:
    v_add_f32 v32, v32, v64
    v_add_f32 v33, v33, v65
    v_add_f32 v34, v34, v66
    v_add_f32 v35, v35, v67
    v_add_f32 v36, v36, v68
    v_add_f32 v37, v37, v69
    v_add_f32 v38, v38, v70
    v_add_f32 v39, v39, v71
    v_add_f32 v40, v40, v72
    v_add_f32 v41, v41, v73
    v_add_f32 v42, v42, v74
    v_add_f32 v43, v43, v75
    v_add_f32 v44, v44, v76
    v_add_f32 v45, v45, v77
    v_add_f32 v46, v46, v78
    v_add_f32 v47, v47, v79
    v_add_f32 v48, v48, v80
    v_add_f32 v49, v49, v81
    v_add_f32 v50, v50, v82
    v_add_f32 v51, v51, v83
    v_add_f32 v52, v52, v84
    v_add_f32 v53, v53, v85
    v_add_f32 v54, v54, v86
    v_add_f32 v55, v55, v87
    v_add_f32 v56, v56, v88
    v_add_f32 v57, v57, v89
    v_add_f32 v58, v58, v90
    v_add_f32 v59, v59, v91
    v_add_f32 v60, v60, v92
    v_add_f32 v61, v61, v93
    v_add_f32 v62, v62, v94
    v_add_f32 v63, v63, v95
    v_add_f32 v32, v32, v48
    v_add_f32 v33, v33, v49
    v_add_f32 v34, v34, v50
    v_add_f32 v35, v35, v51
    v_add_f32 v36, v36, v52
    v_add_f32 v37, v37, v53
    v_add_f32 v38, v38, v54
    v_add_f32 v39, v39, v55
    v_add_f32 v40, v40, v56
    v_add_f32 v41, v41, v57
    v_add_f32 v42, v42, v58
    v_add_f32 v43, v43, v59
    v_add_f32 v44, v44, v60
    v_add_f32 v45, v45, v61
    v_add_f32 v46, v46, v62
    v_add_f32 v47, v47, v63
    v_add_f32 v32, v32, v40
    v_add_f32 v33, v33, v41
    v_add_f32 v34, v34, v42
    v_add_f32 v35, v35, v43
    v_add_f32 v36, v36, v44
    v_add_f32 v37, v37, v45
    v_add_f32 v38, v38, v46
    v_add_f32 v39, v39, v47
    v_cvt_pk_bf16_f32 v32, v32, v33
    v_cvt_pk_bf16_f32 v33, v34, v35
    v_cvt_pk_bf16_f32 v34, v36, v37
    v_cvt_pk_bf16_f32 v35, v38, v39
    s_mul_i32 s47, s39, 6144
    s_lshl_b32 s46, s36, 10
    s_add_u32 s47, s47, s46
    s_add_u32 s47, s47, 43515904
    buffer_store_dwordx4 v[32:35], v4, s[20:23], s47 offen sc1
L_h1_end:
L_up_65:
    s_cmp_ge_u32 s34, 14
    s_cbranch_scc1 L_up_66
    s_barrier
    s_add_u32 s34, s34, 1
    s_branch L_up_65
L_up_66:
    s_branch L_rx
L_h1_q:
    s_mul_i32 s55, s39, 6144
    s_add_u32 s55, s55, 43515904
    s_add_u32 s56, s55, 4096
    v_add_u32 v12, 135168, v4
    s_barrier
    s_cmp_lt_u32 s38, 2
    s_cbranch_scc1 L_qc_69
    s_call_b64 s[84:85], L_qp1
L_qc_69:
    s_barrier
    s_cmp_lt_u32 s38, 2
    s_cbranch_scc1 L_qc_70
    s_call_b64 s[84:85], L_qp2
L_qc_70:
    s_barrier
    s_cmp_lt_u32 s38, 2
    s_cbranch_scc1 L_qc_71
    s_call_b64 s[84:85], L_qp3
L_qc_71:
    s_barrier
    s_cmp_lt_u32 s38, 2
    s_cbranch_scc1 L_qc_72
    s_call_b64 s[84:85], L_qp4
L_qc_72:
    s_barrier
    s_setprio 2
    s_mov_b32 s34, 6
L_try_67:
    buffer_load_dwordx4 v[32:35], v4, s[20:23], s55 offen offset:0 sc1
    buffer_load_dwordx4 v[36:39], v4, s[20:23], s55 offen offset:1024 sc1
    buffer_load_dwordx4 v[40:43], v4, s[20:23], s55 offen offset:2048 sc1
    buffer_load_dwordx4 v[44:47], v4, s[20:23], s55 offen offset:3072 sc1
    buffer_load_dwordx4 v[48:51], v4, s[20:23], s56 offen offset:0 sc1
    buffer_load_dwordx4 v[52:55], v4, s[20:23], s56 offen offset:1024 sc1
    s_waitcnt vmcnt(0)
    v_max_u32 v14, v32, v33
    v_max3_u32 v14, v14, v34, v35
    v_max3_u32 v14, v14, v36, v37
    v_max3_u32 v14, v14, v38, v39
    v_max3_u32 v14, v14, v40, v41
    v_max3_u32 v14, v14, v42, v43
    v_max3_u32 v14, v14, v44, v45
    v_max3_u32 v14, v14, v46, v47
    v_max3_u32 v14, v14, v48, v49
    v_max3_u32 v14, v14, v50, v51
    v_max3_u32 v14, v14, v52, v53
    v_max3_u32 v14, v14, v54, v55
    v_cmp_eq_u32 vcc, -1, v14
    s_cbranch_vccz L_try_68
    s_cmp_ge_u32 s34, 7
    s_cbranch_scc1 L_try_73
    s_barrier
    s_add_u32 s34, s34, 1
    s_branch L_try_67
L_try_73:
    buffer_load_dwordx4 v[32:35], v4, s[20:23], s55 offen offset:0 sc1
    buffer_load_dwordx4 v[36:39], v4, s[20:23], s55 offen offset:1024 sc1
    buffer_load_dwordx4 v[40:43], v4, s[20:23], s55 offen offset:2048 sc1
    buffer_load_dwordx4 v[44:47], v4, s[20:23], s55 offen offset:3072 sc1
    buffer_load_dwordx4 v[48:51], v4, s[20:23], s56 offen offset:0 sc1
    buffer_load_dwordx4 v[52:55], v4, s[20:23], s56 offen offset:1024 sc1
    s_mov_b32 s35, 100000
L_poll_74:
    s_waitcnt vmcnt(0)
    v_max_u32 v14, v32, v33
    v_max3_u32 v14, v14, v34, v35
    v_max3_u32 v14, v14, v36, v37
    v_max3_u32 v14, v14, v38, v39
    v_max3_u32 v14, v14, v40, v41
    v_max3_u32 v14, v14, v42, v43
    v_max3_u32 v14, v14, v44, v45
    v_max3_u32 v14, v14, v46, v47
    v_max3_u32 v14, v14, v48, v49
    v_max3_u32 v14, v14, v50, v51
    v_max3_u32 v14, v14, v52, v53
    v_max3_u32 v14, v14, v54, v55
    v_cmp_eq_u32 vcc, -1, v14
    s_nop 1
    s_cmp_lg_u64 vcc, 0
    s_cbranch_scc0 L_pollok_75
    s_sub_u32 s35, s35, 1
    s_cbranch_scc1 L_pollok_75
    s_sleep 2
    buffer_load_dwordx4 v[32:35], v4, s[20:23], s55 offen offset:0 sc1
    buffer_load_dwordx4 v[36:39], v4, s[20:23], s55 offen offset:1024 sc1
    buffer_load_dwordx4 v[40:43], v4, s[20:23], s55 offen offset:2048 sc1
    buffer_load_dwordx4 v[44:47], v4, s[20:23], s55 offen offset:3072 sc1
    buffer_load_dwordx4 v[48:51], v4, s[20:23], s56 offen offset:0 sc1
    buffer_load_dwordx4 v[52:55], v4, s[20:23], s56 offen offset:1024 sc1
    s_branch L_poll_74
L_pollok_75:
L_try_68:
    ds_write_b128 v12, v[32:35] offset:0
    ds_write_b128 v12, v[36:39] offset:1024
    ds_write_b128 v12, v[40:43] offset:2048
    ds_write_b128 v12, v[44:47] offset:3072
    ds_write_b128 v12, v[48:51] offset:4096
    ds_write_b128 v12, v[52:55] offset:5120
L_up_76:
    s_cmp_ge_u32 s34, 7
    s_cbranch_scc1 L_up_77
    s_barrier
    s_add_u32 s34, s34, 1
    s_branch L_up_76
L_up_77:
    s_waitcnt lgkmcnt(0)
    s_barrier
    s_cmp_lt_u32 s38, 2
    s_cbranch_scc1 L_qc_78
    s_call_b64 s[84:85], L_q4
L_qc_78:
    s_barrier
    s_cmp_lt_u32 s38, 2
    s_cbranch_scc1 L_qc_79
    s_call_b64 s[84:85], L_q5
L_qc_79:
    s_barrier
    s_cmp_lt_u32 s38, 2
    s_cbranch_scc1 L_qc_80
    s_call_b64 s[84:85], L_q6
L_qc_80:
    s_mov_b32 s34, 10
    s_branch L_h1_end
L_k0:
    s_setprio 2
    s_lshl_b32 s82, s86, 11
    v_lshl_add_u32 v224, v0, 4, s82
    v_lshlrev_b32 v225, 4, v0
    v_add_u32 v226, 135168, v225
    ds_read_b128 v[128:131], v224 offset:0
    ds_read_b128 v[132:135], v224 offset:1024
    ds_read_b128 v[136:139], v224 offset:8192
    ds_read_b128 v[140:143], v224 offset:9216
    ds_read_b128 v[144:147], v224 offset:16384
    ds_read_b128 v[148:151], v224 offset:17408
    ds_read_b128 v[152:155], v224 offset:24576
    ds_read_b128 v[156:159], v224 offset:25600
    ds_read_b128 v[160:163], v226 offset:0
    ds_read_b128 v[164:167], v226 offset:1024
    ds_read_b128 v[168:171], v226 offset:2048
    ds_read_b128 v[172:175], v226 offset:3072
    s_lshl_b32 s83, s39, 3
    s_add_u32 s83, s83, s36
    s_mul_i32 s83, s83, 9216
    s_add_u32 s83, s83, 41943040
    s_add_u32 s82, s82, s83
    s_add_u32 s83, s83, 8192
    s_cmp_eq_u32 s86, 0
    s_cselect_b32 s83, s83, 0x10000000
    s_waitcnt lgkmcnt(4)
    v_add_f32 v128, v128, v144
    v_add_f32 v129, v129, v145
    v_add_f32 v130, v130, v146
    v_add_f32 v131, v131, v147
    v_add_f32 v132, v132, v148
    v_add_f32 v133, v133, v149
    v_add_f32 v134, v134, v150
    v_add_f32 v135, v135, v151
    v_add_f32 v136, v136, v152
    v_add_f32 v137, v137, v153
    v_add_f32 v138, v138, v154
    v_add_f32 v139, v139, v155
    v_add_f32 v140, v140, v156
    v_add_f32 v141, v141, v157
    v_add_f32 v142, v142, v158
    v_add_f32 v143, v143, v159
    v_add_f32 v128, v128, v136
    v_add_f32 v129, v129, v137
    v_add_f32 v130, v130, v138
    v_add_f32 v131, v131, v139
    v_add_f32 v132, v132, v140
    v_add_f32 v133, v133, v141
    v_add_f32 v134, v134, v142
    v_add_f32 v135, v135, v143
    buffer_store_dwordx4 v[128:131], v225, s[20:23], s82 offen offset:0 sc1
    buffer_store_dwordx4 v[132:135], v225, s[20:23], s82 offen offset:1024 sc1
    s_waitcnt lgkmcnt(0)
    v_add_f32 v160, v160, v168
    v_add_f32 v161, v161, v169
    v_add_f32 v162, v162, v170
    v_add_f32 v163, v163, v171
    v_add_f32 v164, v164, v172
    v_add_f32 v165, v165, v173
    v_add_f32 v166, v166, v174
    v_add_f32 v167, v167, v175
    v_add_f32 v160, v160, v164
    v_add_f32 v161, v161, v165
    v_add_f32 v162, v162, v166
    v_add_f32 v163, v163, v167
    buffer_store_dwordx4 v[160:163], v225, s[20:23], s83 offen sc1
    s_setprio 0
    s_setpc_b64 s[84:85]
L_qp0:
    s_sub_u32 s86, s3, 4
    s_cmp_lt_u32 s38, 2
    s_cbranch_scc1 L_k0
    s_sub_u32 s86, s3, 4
    s_lshl_b32 s82, s86, 13
    v_lshl_add_u32 v224, v0, 4, s82
    ds_read_b128 v[128:131], v224 offset:0
    ds_read_b128 v[132:135], v224 offset:1024
    ds_read_b128 v[136:139], v224 offset:2048
    ds_read_b128 v[140:143], v224 offset:3072
    ds_read_b128 v[144:147], v224 offset:4096
    ds_read_b128 v[148:151], v224 offset:5120
    ds_read_b128 v[152:155], v224 offset:6144
    ds_read_b128 v[156:159], v224 offset:7168
    s_lshl_b32 s83, s2, 11
    s_add_u32 s83, s83, 46138368
    s_xor_b32 s83, s83, s79
    s_and_b32 s82, s36, 3
    s_lshl_b32 s82, s82, 4
    s_add_u32 s82, s82, s39
    s_lshl_b32 s82, s82, 2
    s_add_u32 s82, s82, s86
    s_lshl_b32 s82, s82, 15
    s_add_u32 s82, s82, 33554432
    v_lshlrev_b32 v224, 4, v0
    v_add_u32 v224, 135168, v224
    v_mov_b32 v226, 0
    ds_write_b32 v224, v226 offset:8192
    v_mov_b32 v226, 1
    s_waitcnt lgkmcnt(0)
    v_lshlrev_b32 v160, 16, v128
    v_and_b32 v161, 0xffff0000, v128
    v_lshlrev_b32 v162, 16, v129
    v_and_b32 v163, 0xffff0000, v129
    v_lshlrev_b32 v164, 16, v130
    v_and_b32 v165, 0xffff0000, v130
    v_lshlrev_b32 v166, 16, v131
    v_and_b32 v167, 0xffff0000, v131
    v_mul_f32 v168, 0x3fb8aa3b, v160
    v_mul_f32 v169, 0x3fb8aa3b, v161
    v_mul_f32 v170, 0x3fb8aa3b, v162
    v_mul_f32 v171, 0x3fb8aa3b, v163
    v_mul_f32 v172, 0x3fb8aa3b, v164
    v_mul_f32 v173, 0x3fb8aa3b, v165
    v_mul_f32 v174, 0x3fb8aa3b, v166
    v_mul_f32 v175, 0x3fb8aa3b, v167
    v_exp_f32 v168, v168 clamp
    v_max_f32 v160, 0x358637bd, v160
    v_exp_f32 v169, v169 clamp
    v_max_f32 v161, 0x358637bd, v161
    v_exp_f32 v170, v170 clamp
    v_max_f32 v162, 0x358637bd, v162
    v_exp_f32 v171, v171 clamp
    v_max_f32 v163, 0x358637bd, v163
    v_exp_f32 v172, v172 clamp
    v_max_f32 v164, 0x358637bd, v164
    v_exp_f32 v173, v173 clamp
    v_max_f32 v165, 0x358637bd, v165
    v_exp_f32 v174, v174 clamp
    v_max_f32 v166, 0x358637bd, v166
    v_exp_f32 v175, v175 clamp
    v_max_f32 v167, 0x358637bd, v167
    v_add_f32 v160, v160, v168
    v_add_f32 v161, v161, v169
    v_add_f32 v162, v162, v170
    v_add_f32 v163, v163, v171
    v_add_f32 v164, v164, v172
    v_add_f32 v165, v165, v173
    v_add_f32 v166, v166, v174
    v_add_f32 v167, v167, v175
    v_cvt_pk_bf16_f32 v128, v160, v161
    v_cvt_pk_bf16_f32 v129, v162, v163
    v_cvt_pk_bf16_f32 v130, v164, v165
    v_cvt_pk_bf16_f32 v131, v166, v167
    s_setpc_b64 s[84:85]
L_qp1:
    v_lshlrev_b32 v160, 16, v132
    v_and_b32 v161, 0xffff0000, v132
    v_lshlrev_b32 v162, 16, v133
    v_and_b32 v163, 0xffff0000, v133
    v_lshlrev_b32 v164, 16, v134
    v_and_b32 v165, 0xffff0000, v134
    v_lshlrev_b32 v166, 16, v135
    v_and_b32 v167, 0xffff0000, v135
    v_mul_f32 v168, 0x3fb8aa3b, v160
    v_mul_f32 v169, 0x3fb8aa3b, v161
    v_mul_f32 v170, 0x3fb8aa3b, v162
    v_mul_f32 v171, 0x3fb8aa3b, v163
    v_mul_f32 v172, 0x3fb8aa3b, v164
    v_mul_f32 v173, 0x3fb8aa3b, v165
    v_mul_f32 v174, 0x3fb8aa3b, v166
    v_mul_f32 v175, 0x3fb8aa3b, v167
    v_exp_f32 v168, v168 clamp
    v_max_f32 v160, 0x358637bd, v160
    v_exp_f32 v169, v169 clamp
    v_max_f32 v161, 0x358637bd, v161
    v_exp_f32 v170, v170 clamp
    v_max_f32 v162, 0x358637bd, v162
    v_exp_f32 v171, v171 clamp
    v_max_f32 v163, 0x358637bd, v163
    v_exp_f32 v172, v172 clamp
    v_max_f32 v164, 0x358637bd, v164
    v_exp_f32 v173, v173 clamp
    v_max_f32 v165, 0x358637bd, v165
    v_exp_f32 v174, v174 clamp
    v_max_f32 v166, 0x358637bd, v166
    v_exp_f32 v175, v175 clamp
    v_max_f32 v167, 0x358637bd, v167
    v_add_f32 v160, v160, v168
    v_add_f32 v161, v161, v169
    v_add_f32 v162, v162, v170
    v_add_f32 v163, v163, v171
    v_add_f32 v164, v164, v172
    v_add_f32 v165, v165, v173
    v_add_f32 v166, v166, v174
    v_add_f32 v167, v167, v175
    v_cvt_pk_bf16_f32 v132, v160, v161
    v_cvt_pk_bf16_f32 v133, v162, v163
    v_cvt_pk_bf16_f32 v134, v164, v165
    v_cvt_pk_bf16_f32 v135, v166, v167
    v_lshlrev_b32 v160, 16, v136
    v_and_b32 v161, 0xffff0000, v136
    v_lshlrev_b32 v162, 16, v137
    v_and_b32 v163, 0xffff0000, v137
    v_lshlrev_b32 v164, 16, v138
    v_and_b32 v165, 0xffff0000, v138
    v_lshlrev_b32 v166, 16, v139
    v_and_b32 v167, 0xffff0000, v139
    v_mul_f32 v168, 0x3fb8aa3b, v160
    v_mul_f32 v169, 0x3fb8aa3b, v161
    v_mul_f32 v170, 0x3fb8aa3b, v162
    v_mul_f32 v171, 0x3fb8aa3b, v163
    v_mul_f32 v172, 0x3fb8aa3b, v164
    v_mul_f32 v173, 0x3fb8aa3b, v165
    v_mul_f32 v174, 0x3fb8aa3b, v166
    v_mul_f32 v175, 0x3fb8aa3b, v167
    v_exp_f32 v168, v168 clamp
    v_max_f32 v160, 0x358637bd, v160
    v_exp_f32 v169, v169 clamp
    v_max_f32 v161, 0x358637bd, v161
    v_exp_f32 v170, v170 clamp
    v_max_f32 v162, 0x358637bd, v162
    v_exp_f32 v171, v171 clamp
    v_max_f32 v163, 0x358637bd, v163
    v_exp_f32 v172, v172 clamp
    v_max_f32 v164, 0x358637bd, v164
    v_exp_f32 v173, v173 clamp
    v_max_f32 v165, 0x358637bd, v165
    v_exp_f32 v174, v174 clamp
    v_max_f32 v166, 0x358637bd, v166
    v_exp_f32 v175, v175 clamp
    v_max_f32 v167, 0x358637bd, v167
    v_add_f32 v160, v160, v168
    v_add_f32 v161, v161, v169
    v_add_f32 v162, v162, v170
    v_add_f32 v163, v163, v171
    v_add_f32 v164, v164, v172
    v_add_f32 v165, v165, v173
    v_add_f32 v166, v166, v174
    v_add_f32 v167, v167, v175
    v_cvt_pk_bf16_f32 v136, v160, v161
    v_cvt_pk_bf16_f32 v137, v162, v163
    v_cvt_pk_bf16_f32 v138, v164, v165
    v_cvt_pk_bf16_f32 v139, v166, v167
    s_setpc_b64 s[84:85]
L_qp2:
    v_lshlrev_b32 v160, 16, v140
    v_and_b32 v161, 0xffff0000, v140
    v_lshlrev_b32 v162, 16, v141
    v_and_b32 v163, 0xffff0000, v141
    v_lshlrev_b32 v164, 16, v142
    v_and_b32 v165, 0xffff0000, v142
    v_lshlrev_b32 v166, 16, v143
    v_and_b32 v167, 0xffff0000, v143
    v_mul_f32 v168, 0x3fb8aa3b, v160
    v_mul_f32 v169, 0x3fb8aa3b, v161
    v_mul_f32 v170, 0x3fb8aa3b, v162
    v_mul_f32 v171, 0x3fb8aa3b, v163
    v_mul_f32 v172, 0x3fb8aa3b, v164
    v_mul_f32 v173, 0x3fb8aa3b, v165
    v_mul_f32 v174, 0x3fb8aa3b, v166
    v_mul_f32 v175, 0x3fb8aa3b, v167
    v_exp_f32 v168, v168 clamp
    v_max_f32 v160, 0x358637bd, v160
    v_exp_f32 v169, v169 clamp
    v_max_f32 v161, 0x358637bd, v161
    v_exp_f32 v170, v170 clamp
    v_max_f32 v162, 0x358637bd, v162
    v_exp_f32 v171, v171 clamp
    v_max_f32 v163, 0x358637bd, v163
    v_exp_f32 v172, v172 clamp
    v_max_f32 v164, 0x358637bd, v164
    v_exp_f32 v173, v173 clamp
    v_max_f32 v165, 0x358637bd, v165
    v_exp_f32 v174, v174 clamp
    v_max_f32 v166, 0x358637bd, v166
    v_exp_f32 v175, v175 clamp
    v_max_f32 v167, 0x358637bd, v167
    v_add_f32 v160, v160, v168
    v_add_f32 v161, v161, v169
    v_add_f32 v162, v162, v170
    v_add_f32 v163, v163, v171
    v_add_f32 v164, v164, v172
    v_add_f32 v165, v165, v173
    v_add_f32 v166, v166, v174
    v_add_f32 v167, v167, v175
    v_cvt_pk_bf16_f32 v140, v160, v161
    v_cvt_pk_bf16_f32 v141, v162, v163
    v_cvt_pk_bf16_f32 v142, v164, v165
    v_cvt_pk_bf16_f32 v143, v166, v167
    v_lshlrev_b32 v160, 16, v144
    v_and_b32 v161, 0xffff0000, v144
    v_lshlrev_b32 v162, 16, v145
    v_and_b32 v163, 0xffff0000, v145
    v_lshlrev_b32 v164, 16, v146
    v_and_b32 v165, 0xffff0000, v146
    v_lshlrev_b32 v166, 16, v147
    v_and_b32 v167, 0xffff0000, v147
    v_mul_f32 v168, 0x3fb8aa3b, v160
    v_mul_f32 v169, 0x3fb8aa3b, v161
    v_mul_f32 v170, 0x3fb8aa3b, v162
    v_mul_f32 v171, 0x3fb8aa3b, v163
    v_mul_f32 v172, 0x3fb8aa3b, v164
    v_mul_f32 v173, 0x3fb8aa3b, v165
    v_mul_f32 v174, 0x3fb8aa3b, v166
    v_mul_f32 v175, 0x3fb8aa3b, v167
    v_exp_f32 v168, v168 clamp
    v_max_f32 v160, 0x358637bd, v160
    v_exp_f32 v169, v169 clamp
    v_max_f32 v161, 0x358637bd, v161
    v_exp_f32 v170, v170 clamp
    v_max_f32 v162, 0x358637bd, v162
    v_exp_f32 v171, v171 clamp
    v_max_f32 v163, 0x358637bd, v163
    v_exp_f32 v172, v172 clamp
    v_max_f32 v164, 0x358637bd, v164
    v_exp_f32 v173, v173 clamp
    v_max_f32 v165, 0x358637bd, v165
    v_exp_f32 v174, v174 clamp
    v_max_f32 v166, 0x358637bd, v166
    v_exp_f32 v175, v175 clamp
    v_max_f32 v167, 0x358637bd, v167
    v_add_f32 v160, v160, v168
    v_add_f32 v161, v161, v169
    v_add_f32 v162, v162, v170
    v_add_f32 v163, v163, v171
    v_add_f32 v164, v164, v172
    v_add_f32 v165, v165, v173
    v_add_f32 v166, v166, v174
    v_add_f32 v167, v167, v175
    v_cvt_pk_bf16_f32 v144, v160, v161
    v_cvt_pk_bf16_f32 v145, v162, v163
    v_cvt_pk_bf16_f32 v146, v164, v165
    v_cvt_pk_bf16_f32 v147, v166, v167
    s_setpc_b64 s[84:85]
L_qp3:
    v_lshlrev_b32 v160, 16, v148
    v_and_b32 v161, 0xffff0000, v148
    v_lshlrev_b32 v162, 16, v149
    v_and_b32 v163, 0xffff0000, v149
    v_lshlrev_b32 v164, 16, v150
    v_and_b32 v165, 0xffff0000, v150
    v_lshlrev_b32 v166, 16, v151
    v_and_b32 v167, 0xffff0000, v151
    v_mul_f32 v168, 0x3fb8aa3b, v160
    v_mul_f32 v169, 0x3fb8aa3b, v161
    v_mul_f32 v170, 0x3fb8aa3b, v162
    v_mul_f32 v171, 0x3fb8aa3b, v163
    v_mul_f32 v172, 0x3fb8aa3b, v164
    v_mul_f32 v173, 0x3fb8aa3b, v165
    v_mul_f32 v174, 0x3fb8aa3b, v166
    v_mul_f32 v175, 0x3fb8aa3b, v167
    v_exp_f32 v168, v168 clamp
    v_max_f32 v160, 0x358637bd, v160
    v_exp_f32 v169, v169 clamp
    v_max_f32 v161, 0x358637bd, v161
    v_exp_f32 v170, v170 clamp
    v_max_f32 v162, 0x358637bd, v162
    v_exp_f32 v171, v171 clamp
    v_max_f32 v163, 0x358637bd, v163
    v_exp_f32 v172, v172 clamp
    v_max_f32 v164, 0x358637bd, v164
    v_exp_f32 v173, v173 clamp
    v_max_f32 v165, 0x358637bd, v165
    v_exp_f32 v174, v174 clamp
    v_max_f32 v166, 0x358637bd, v166
    v_exp_f32 v175, v175 clamp
    v_max_f32 v167, 0x358637bd, v167
    v_add_f32 v160, v160, v168
    v_add_f32 v161, v161, v169
    v_add_f32 v162, v162, v170
    v_add_f32 v163, v163, v171
    v_add_f32 v164, v164, v172
    v_add_f32 v165, v165, v173
    v_add_f32 v166, v166, v174
    v_add_f32 v167, v167, v175
    v_cvt_pk_bf16_f32 v148, v160, v161
    v_cvt_pk_bf16_f32 v149, v162, v163
    v_cvt_pk_bf16_f32 v150, v164, v165
    v_cvt_pk_bf16_f32 v151, v166, v167
    v_lshlrev_b32 v160, 16, v152
    v_and_b32 v161, 0xffff0000, v152
    v_lshlrev_b32 v162, 16, v153
    v_and_b32 v163, 0xffff0000, v153
    v_lshlrev_b32 v164, 16, v154
    v_and_b32 v165, 0xffff0000, v154
    v_lshlrev_b32 v166, 16, v155
    v_and_b32 v167, 0xffff0000, v155
    v_mul_f32 v168, 0x3fb8aa3b, v160
    v_mul_f32 v169, 0x3fb8aa3b, v161
    v_mul_f32 v170, 0x3fb8aa3b, v162
    v_mul_f32 v171, 0x3fb8aa3b, v163
    v_mul_f32 v172, 0x3fb8aa3b, v164
    v_mul_f32 v173, 0x3fb8aa3b, v165
    v_mul_f32 v174, 0x3fb8aa3b, v166
    v_mul_f32 v175, 0x3fb8aa3b, v167
    v_exp_f32 v168, v168 clamp
    v_max_f32 v160, 0x358637bd, v160
    v_exp_f32 v169, v169 clamp
    v_max_f32 v161, 0x358637bd, v161
    v_exp_f32 v170, v170 clamp
    v_max_f32 v162, 0x358637bd, v162
    v_exp_f32 v171, v171 clamp
    v_max_f32 v163, 0x358637bd, v163
    v_exp_f32 v172, v172 clamp
    v_max_f32 v164, 0x358637bd, v164
    v_exp_f32 v173, v173 clamp
    v_max_f32 v165, 0x358637bd, v165
    v_exp_f32 v174, v174 clamp
    v_max_f32 v166, 0x358637bd, v166
    v_exp_f32 v175, v175 clamp
    v_max_f32 v167, 0x358637bd, v167
    v_add_f32 v160, v160, v168
    v_add_f32 v161, v161, v169
    v_add_f32 v162, v162, v170
    v_add_f32 v163, v163, v171
    v_add_f32 v164, v164, v172
    v_add_f32 v165, v165, v173
    v_add_f32 v166, v166, v174
    v_add_f32 v167, v167, v175
    v_cvt_pk_bf16_f32 v152, v160, v161
    v_cvt_pk_bf16_f32 v153, v162, v163
    v_cvt_pk_bf16_f32 v154, v164, v165
    v_cvt_pk_bf16_f32 v155, v166, v167
    s_setpc_b64 s[84:85]
L_qp4:
    v_lshlrev_b32 v160, 16, v156
    v_and_b32 v161, 0xffff0000, v156
    v_lshlrev_b32 v162, 16, v157
    v_and_b32 v163, 0xffff0000, v157
    v_lshlrev_b32 v164, 16, v158
    v_and_b32 v165, 0xffff0000, v158
    v_lshlrev_b32 v166, 16, v159
    v_and_b32 v167, 0xffff0000, v159
    v_mul_f32 v168, 0x3fb8aa3b, v160
    v_mul_f32 v169, 0x3fb8aa3b, v161
    v_mul_f32 v170, 0x3fb8aa3b, v162
    v_mul_f32 v171, 0x3fb8aa3b, v163
    v_mul_f32 v172, 0x3fb8aa3b, v164
    v_mul_f32 v173, 0x3fb8aa3b, v165
    v_mul_f32 v174, 0x3fb8aa3b, v166
    v_mul_f32 v175, 0x3fb8aa3b, v167
    v_exp_f32 v168, v168 clamp
    v_max_f32 v160, 0x358637bd, v160
    v_exp_f32 v169, v169 clamp
    v_max_f32 v161, 0x358637bd, v161
    v_exp_f32 v170, v170 clamp
    v_max_f32 v162, 0x358637bd, v162
    v_exp_f32 v171, v171 clamp
    v_max_f32 v163, 0x358637bd, v163
    v_exp_f32 v172, v172 clamp
    v_max_f32 v164, 0x358637bd, v164
    v_exp_f32 v173, v173 clamp
    v_max_f32 v165, 0x358637bd, v165
    v_exp_f32 v174, v174 clamp
    v_max_f32 v166, 0x358637bd, v166
    v_exp_f32 v175, v175 clamp
    v_max_f32 v167, 0x358637bd, v167
    v_add_f32 v160, v160, v168
    v_add_f32 v161, v161, v169
    v_add_f32 v162, v162, v170
    v_add_f32 v163, v163, v171
    v_add_f32 v164, v164, v172
    v_add_f32 v165, v165, v173
    v_add_f32 v166, v166, v174
    v_add_f32 v167, v167, v175
    v_cvt_pk_bf16_f32 v156, v160, v161
    v_cvt_pk_bf16_f32 v157, v162, v163
    v_cvt_pk_bf16_f32 v158, v164, v165
    v_cvt_pk_bf16_f32 v159, v166, v167
    s_setpc_b64 s[84:85]
L_q4:
    s_setprio 2
    v_lshrrev_b32 v225, 4, v0
    v_and_b32 v227, 15, v0
    v_lshlrev_b32 v227, 4, v227
    v_lshl_add_u32 v225, v225, 9, v227
    v_or_b32 v225, s43, v225
    ds_read_b128 v[176:179], v224 offset:0
    ds_read_b128 v[180:183], v224 offset:1024
    ds_read_b128 v[184:187], v224 offset:2048
    ds_read_b128 v[188:191], v224 offset:3072
    ds_read_b128 v[192:195], v224 offset:4096
    ds_read_b128 v[196:199], v224 offset:5120
    s_lshl_b32 s86, s3, 8
    s_add_u32 s86, s86, 161792
    v_and_b32 v227, 15, v0
    v_lshl_add_u32 v227, v227, 2, s86
    ds_read_b32 v228, v227 offset:0
    ds_read_b32 v229, v227 offset:64
    ds_read_b32 v230, v227 offset:128
    ds_read_b32 v231, v227 offset:192
    s_waitcnt lgkmcnt(0)
    v_mfma_f32_16x16x32_bf16 v[208:211], v[184:187], v[128:131], 0
    v_mfma_f32_16x16x32_bf16 v[200:203], v[176:179], v[128:131], 0
    v_mfma_f32_16x16x32_bf16 v[204:207], v[180:183], v[128:131], 0
    v_mfma_f32_16x16x32_bf16 v[220:223], v[196:199], v[132:135], 0
    v_mfma_f32_16x16x32_bf16 v[212:215], v[188:191], v[132:135], 0
    v_mfma_f32_16x16x32_bf16 v[216:219], v[192:195], v[132:135], 0
    s_add_u32 s86, s82, 0
    s_nop 3
    v_add_f32 v208, 0x358637bd, v208
    v_rcp_f32 v208, v208
    s_nop 0
    v_mul_f32 v208, v228, v208
    v_mul_f32 v200, v200, v208
    v_mul_f32 v201, v201, v208
    v_mul_f32 v202, v202, v208
    v_mul_f32 v203, v203, v208
    v_mul_f32 v204, v204, v208
    v_mul_f32 v205, v205, v208
    v_mul_f32 v206, v206, v208
    v_mul_f32 v207, v207, v208
    v_cvt_pk_bf16_f32 v128, v200, v201
    v_cvt_pk_bf16_f32 v129, v202, v203
    v_cvt_pk_bf16_f32 v130, v204, v205
    v_cvt_pk_bf16_f32 v131, v206, v207
    buffer_store_dwordx4 v[128:131], v225, s[20:23], s86 offen offset:0 sc1
    v_add_f32 v220, 0x358637bd, v220
    v_rcp_f32 v220, v220
    s_nop 0
    v_mul_f32 v220, v228, v220
    v_mul_f32 v212, v212, v220
    v_mul_f32 v213, v213, v220
    v_mul_f32 v214, v214, v220
    v_mul_f32 v215, v215, v220
    v_mul_f32 v216, v216, v220
    v_mul_f32 v217, v217, v220
    v_mul_f32 v218, v218, v220
    v_mul_f32 v219, v219, v220
    v_cvt_pk_bf16_f32 v132, v212, v213
    v_cvt_pk_bf16_f32 v133, v214, v215
    v_cvt_pk_bf16_f32 v134, v216, v217
    v_cvt_pk_bf16_f32 v135, v218, v219
    buffer_store_dwordx4 v[132:135], v225, s[20:23], s86 offen offset:2048 sc1
    v_mfma_f32_16x16x32_bf16 v[208:211], v[184:187], v[136:139], 0
    v_mfma_f32_16x16x32_bf16 v[200:203], v[176:179], v[136:139], 0
    v_mfma_f32_16x16x32_bf16 v[204:207], v[180:183], v[136:139], 0
    v_mfma_f32_16x16x32_bf16 v[220:223], v[196:199], v[140:143], 0
    v_mfma_f32_16x16x32_bf16 v[212:215], v[188:191], v[140:143], 0
    v_mfma_f32_16x16x32_bf16 v[216:219], v[192:195], v[140:143], 0
    s_add_u32 s86, s82, 4096
    s_nop 3
    v_add_f32 v208, 0x358637bd, v208
    v_rcp_f32 v208, v208
    s_nop 0
    v_mul_f32 v208, v229, v208
    v_mul_f32 v200, v200, v208
    v_mul_f32 v201, v201, v208
    v_mul_f32 v202, v202, v208
    v_mul_f32 v203, v203, v208
    v_mul_f32 v204, v204, v208
    v_mul_f32 v205, v205, v208
    v_mul_f32 v206, v206, v208
    v_mul_f32 v207, v207, v208
    v_cvt_pk_bf16_f32 v136, v200, v201
    v_cvt_pk_bf16_f32 v137, v202, v203
    v_cvt_pk_bf16_f32 v138, v204, v205
    v_cvt_pk_bf16_f32 v139, v206, v207
    buffer_store_dwordx4 v[136:139], v225, s[20:23], s86 offen offset:0 sc1
    v_add_f32 v220, 0x358637bd, v220
    v_rcp_f32 v220, v220
    s_nop 0
    v_mul_f32 v220, v229, v220
    v_mul_f32 v212, v212, v220
    v_mul_f32 v213, v213, v220
    v_mul_f32 v214, v214, v220
    v_mul_f32 v215, v215, v220
    v_mul_f32 v216, v216, v220
    v_mul_f32 v217, v217, v220
    v_mul_f32 v218, v218, v220
    v_mul_f32 v219, v219, v220
    v_cvt_pk_bf16_f32 v140, v212, v213
    v_cvt_pk_bf16_f32 v141, v214, v215
    v_cvt_pk_bf16_f32 v142, v216, v217
    v_cvt_pk_bf16_f32 v143, v218, v219
    buffer_store_dwordx4 v[140:143], v225, s[20:23], s86 offen offset:2048 sc1
    s_setprio 0
    s_setpc_b64 s[84:85]
L_q5:
    s_setprio 2
    v_lshrrev_b32 v225, 4, v0
    v_and_b32 v227, 15, v0
    v_lshlrev_b32 v227, 4, v227
    v_lshl_add_u32 v225, v225, 9, v227
    v_or_b32 v225, s43, v225
    v_mfma_f32_16x16x32_bf16 v[208:211], v[184:187], v[144:147], 0
    v_mfma_f32_16x16x32_bf16 v[200:203], v[176:179], v[144:147], 0
    v_mfma_f32_16x16x32_bf16 v[204:207], v[180:183], v[144:147], 0
    v_mfma_f32_16x16x32_bf16 v[220:223], v[196:199], v[148:151], 0
    v_mfma_f32_16x16x32_bf16 v[212:215], v[188:191], v[148:151], 0
    v_mfma_f32_16x16x32_bf16 v[216:219], v[192:195], v[148:151], 0
    s_add_u32 s86, s82, 16384
    s_nop 3
    v_add_f32 v208, 0x358637bd, v208
    v_rcp_f32 v208, v208
    s_nop 0
    v_mul_f32 v208, v230, v208
    v_mul_f32 v200, v200, v208
    v_mul_f32 v201, v201, v208
    v_mul_f32 v202, v202, v208
    v_mul_f32 v203, v203, v208
    v_mul_f32 v204, v204, v208
    v_mul_f32 v205, v205, v208
    v_mul_f32 v206, v206, v208
    v_mul_f32 v207, v207, v208
    v_cvt_pk_bf16_f32 v144, v200, v201
    v_cvt_pk_bf16_f32 v145, v202, v203
    v_cvt_pk_bf16_f32 v146, v204, v205
    v_cvt_pk_bf16_f32 v147, v206, v207
    buffer_store_dwordx4 v[144:147], v225, s[20:23], s86 offen offset:0 sc1
    v_add_f32 v220, 0x358637bd, v220
    v_rcp_f32 v220, v220
    s_nop 0
    v_mul_f32 v220, v230, v220
    v_mul_f32 v212, v212, v220
    v_mul_f32 v213, v213, v220
    v_mul_f32 v214, v214, v220
    v_mul_f32 v215, v215, v220
    v_mul_f32 v216, v216, v220
    v_mul_f32 v217, v217, v220
    v_mul_f32 v218, v218, v220
    v_mul_f32 v219, v219, v220
    v_cvt_pk_bf16_f32 v148, v212, v213
    v_cvt_pk_bf16_f32 v149, v214, v215
    v_cvt_pk_bf16_f32 v150, v216, v217
    v_cvt_pk_bf16_f32 v151, v218, v219
    buffer_store_dwordx4 v[148:151], v225, s[20:23], s86 offen offset:2048 sc1
    v_mfma_f32_16x16x32_bf16 v[208:211], v[184:187], v[152:155], 0
    v_mfma_f32_16x16x32_bf16 v[200:203], v[176:179], v[152:155], 0
    v_mfma_f32_16x16x32_bf16 v[204:207], v[180:183], v[152:155], 0
    v_mfma_f32_16x16x32_bf16 v[220:223], v[196:199], v[156:159], 0
    v_mfma_f32_16x16x32_bf16 v[212:215], v[188:191], v[156:159], 0
    v_mfma_f32_16x16x32_bf16 v[216:219], v[192:195], v[156:159], 0
    s_add_u32 s86, s82, 20480
    s_nop 3
    v_add_f32 v208, 0x358637bd, v208
    v_rcp_f32 v208, v208
    s_nop 0
    v_mul_f32 v208, v231, v208
    v_mul_f32 v200, v200, v208
    v_mul_f32 v201, v201, v208
    v_mul_f32 v202, v202, v208
    v_mul_f32 v203, v203, v208
    v_mul_f32 v204, v204, v208
    v_mul_f32 v205, v205, v208
    v_mul_f32 v206, v206, v208
    v_mul_f32 v207, v207, v208
    v_cvt_pk_bf16_f32 v152, v200, v201
    v_cvt_pk_bf16_f32 v153, v202, v203
    v_cvt_pk_bf16_f32 v154, v204, v205
    v_cvt_pk_bf16_f32 v155, v206, v207
    buffer_store_dwordx4 v[152:155], v225, s[20:23], s86 offen offset:0 sc1
    v_add_f32 v220, 0x358637bd, v220
    v_rcp_f32 v220, v220
    s_nop 0
    v_mul_f32 v220, v231, v220
    v_mul_f32 v212, v212, v220
    v_mul_f32 v213, v213, v220
    v_mul_f32 v214, v214, v220
    v_mul_f32 v215, v215, v220
    v_mul_f32 v216, v216, v220
    v_mul_f32 v217, v217, v220
    v_mul_f32 v218, v218, v220
    v_mul_f32 v219, v219, v220
    v_cvt_pk_bf16_f32 v156, v212, v213
    v_cvt_pk_bf16_f32 v157, v214, v215
    v_cvt_pk_bf16_f32 v158, v216, v217
    v_cvt_pk_bf16_f32 v159, v218, v219
    buffer_store_dwordx4 v[156:159], v225, s[20:23], s86 offen offset:2048 sc1
    s_setprio 0
    s_setpc_b64 s[84:85]
L_q6:
    s_waitcnt vmcnt(0)
    ds_add_rtn_u32 v227, v224, v226 offset:8192
    s_waitcnt lgkmcnt(0)
    v_cmp_eq_u32 vcc, 3, v227
    s_cbranch_vccz L_qret
    s_mov_b64 exec, 1
    buffer_store_dword v226, off, s[20:23], s83 sc1
    s_mov_b64 exec, -1
L_qret:
    s_mov_b64 vcc, -1
    s_setpc_b64 s[84:85]
L_compute:
    v_and_b32 v4, 15, v0
    v_lshrrev_b32 v5, 4, v0
    v_bfe_u32 v6, v4, 3, 1
    v_bfe_u32 v7, v4, 1, 1
    v_lshl_add_u32 v6, v6, 1, v7
    v_mul_u32_u24 v1, 1056, v6
    v_bfe_u32 v6, v4, 2, 1
    v_and_b32 v7, 1, v4
    v_lshl_add_u32 v6, v6, 1, v7
    v_lshl_add_u32 v1, v6, 7, v1
    v_lshl_add_u32 v1, v5, 4, v1
    s_mul_i32 s45, s3, 8448
    v_add_u32 v1, s45, v1
    v_and_b32 v6, 1, v5
    v_bfe_u32 v7, v4, 3, 1
    v_lshl_add_u32 v6, v6, 1, v7
    v_mul_u32_u24 v2, 1056, v6
    v_lshrrev_b32 v6, 1, v5
    v_bfe_u32 v7, v4, 2, 1
    v_lshl_add_u32 v6, v6, 2, v7
    v_lshl_add_u32 v2, v6, 7, v2
    v_and_b32 v6, 3, v4
    v_lshl_add_u32 v2, v6, 3, v2
    v_add_u32 v2, 101376, v2
    v_lshrrev_b32 v6, 5, v0
    v_and_b32 v7, 31, v0
    v_lshlrev_b32 v7, 3, v7
    v_lshl_add_u32 v3, v6, 9, v7
    v_add_u32 v3, 114048, v3
    v_mov_b64 v[48:49], 0
    v_mov_b64 v[50:51], 0
    v_mov_b64 v[52:53], 0
    v_mov_b64 v[54:55], 0
    v_mov_b64 v[56:57], 0
    v_mov_b64 v[58:59], 0
    v_mov_b64 v[60:61], 0
    v_mov_b64 v[62:63], 0
    v_mov_b64 v[64:65], 0
    v_mov_b64 v[66:67], 0
    v_mov_b64 v[68:69], 0
    v_mov_b64 v[70:71], 0
    v_mov_b64 v[72:73], 0
    v_mov_b64 v[74:75], 0
    v_mov_b64 v[76:77], 0
    v_mov_b64 v[78:79], 0
    v_mov_b64 v[80:81], 0
    v_mov_b64 v[82:83], 0
    v_mov_b64 v[84:85], 0
    v_mov_b64 v[86:87], 0
    v_mov_b64 v[88:89], 0
    v_mov_b64 v[90:91], 0
    v_mov_b64 v[92:93], 0
    v_mov_b64 v[94:95], 0
    v_mov_b64 v[96:97], 0
    v_mov_b64 v[98:99], 0
    v_mov_b64 v[100:101], 0
    v_mov_b64 v[102:103], 0
    v_mov_b64 v[104:105], 0
    v_mov_b64 v[106:107], 0
    v_mov_b64 v[108:109], 0
    v_mov_b64 v[110:111], 0
    v_mov_b64 v[112:113], 0
    v_mov_b64 v[114:115], 0
    v_mov_b64 v[116:117], 0
    v_mov_b64 v[118:119], 0
    v_mov_b64 v[120:121], 0
    v_mov_b64 v[122:123], 0
    v_mov_b64 v[124:125], 0
    v_mov_b64 v[126:127], 0
    v_mov_b64 v[128:129], 0
    v_mov_b64 v[130:131], 0
    v_mov_b64 v[132:133], 0
    v_mov_b64 v[134:135], 0
    v_mov_b64 v[136:137], 0
    v_mov_b64 v[138:139], 0
    v_mov_b64 v[140:141], 0
    v_mov_b64 v[142:143], 0
    v_mov_b64 v[144:145], 0
    v_mov_b64 v[146:147], 0
    v_mov_b64 v[148:149], 0
    v_mov_b64 v[150:151], 0
    v_mov_b64 v[152:153], 0
    v_mov_b64 v[154:155], 0
    v_mov_b64 v[156:157], 0
    v_mov_b64 v[158:159], 0
    v_mov_b64 v[160:161], 0
    v_mov_b64 v[162:163], 0
    v_mov_b64 v[164:165], 0
    v_mov_b64 v[166:167], 0
    v_mov_b64 v[168:169], 0
    v_mov_b64 v[170:171], 0
    v_mov_b64 v[172:173], 0
    v_mov_b64 v[174:175], 0
    v_mov_b64 v[176:177], 0
    v_mov_b64 v[178:179], 0
    v_mov_b64 v[180:181], 0
    v_mov_b64 v[182:183], 0
    v_mov_b64 v[184:185], 0
    v_mov_b64 v[186:187], 0
    v_mov_b64 v[188:189], 0
    v_mov_b64 v[190:191], 0
    v_mov_b64 v[192:193], 0
    v_mov_b64 v[194:195], 0
    v_mov_b64 v[196:197], 0
    v_mov_b64 v[198:199], 0
    v_mov_b64 v[200:201], 0
    v_mov_b64 v[202:203], 0
    v_mov_b64 v[204:205], 0
    v_mov_b64 v[206:207], 0
    v_mov_b64 v[208:209], 0
    v_mov_b64 v[210:211], 0
    v_mov_b64 v[212:213], 0
    v_mov_b64 v[214:215], 0
    v_mov_b64 v[216:217], 0
    v_mov_b64 v[218:219], 0
    v_mov_b64 v[220:221], 0
    v_mov_b64 v[222:223], 0
    v_mov_b64 v[224:225], 0
    v_mov_b64 v[226:227], 0
    v_mov_b64 v[228:229], 0
    v_mov_b64 v[230:231], 0
    v_mov_b64 v[232:233], 0
    v_mov_b64 v[234:235], 0
    v_mov_b64 v[236:237], 0
    v_mov_b64 v[238:239], 0
    v_mov_b64 v[240:241], 0
    v_mov_b64 v[242:243], 0
    v_mov_b64 v[244:245], 0
    v_mov_b64 v[246:247], 0
    v_mov_b64 v[248:249], 0
    v_mov_b64 v[250:251], 0
    v_mov_b64 v[252:253], 0
    v_mov_b64 v[254:255], 0
    s_mov_b32 s45, 7
    s_mov_b32 s46, 0
    s_mov_b32 s48, 4294899712
    s_mov_b32 s49, 33792
    s_mov_b32 s50, 0x3fb8aa3b
    s_mov_b32 s51, 0x358637bd
    s_and_b32 s52, s36, 3
    s_lshl_b32 s52, s52, 21
    s_lshl_b32 s53, s3, 15
    s_add_u32 s52, s52, s53
    s_and_b32 s53, s37, 1
    s_mul_i32 s53, s53, 7
    s_lshl_b32 s55, s32, 6
    s_add_u32 s53, s53, s55
    s_add_u32 s66, s53, 6
    s_lshl_b32 s66, s66, 17
    s_add_u32 s66, s66, s52
    s_lshr_b32 s55, s38, 1
    s_lshl_b32 s55, s55, 11
    s_add_u32 s66, s66, s55
    s_and_b32 s55, s38, 1
    s_lshl_b32 s55, s55, 10
    s_add_u32 s66, s66, s55
    s_add_u32 s67, s66, 16384
    s_lshr_b32 s57, s3, 1
    s_and_b32 s58, s3, 1
    s_lshl_b32 s59, s2, 11
    s_lshl_b32 s55, s3, 7
    s_add_u32 s59, s59, s55
    s_add_u32 s59, s59, 46137344
    s_add_u32 s60, s59, 512
    s_add_u32 s61, s59, 1024
    v_lshlrev_b32 v4, 4, v0
    v_mov_b32 v6, 1
    v_lshrrev_b32 v7, 4, v0
    v_and_b32 v5, 15, v0
    v_lshlrev_b32 v5, 4, v5
    v_lshl_add_u32 v7, v7, 9, v5
    v_or_b32 v7, s43, v7
    s_waitcnt lgkmcnt(0)
    s_mov_b32 s20, s26
    s_mov_b32 s21, s27
    s_mov_b32 s22, 0x10000000
    s_mov_b32 s23, 0x20000
    s_mov_b32 s4, 0xb9874210
    s_mov_b32 s5, 0xd6ca53
    s_cmp_eq_u32 s41, 3
    s_cselect_b32 s4, 0xb9874201, s4
    s_cselect_b32 s5, 0xd6ca53, s5
    s_cmp_eq_u32 s41, 0
    s_cselect_b32 s4, 0x98741032, s4
    s_cselect_b32 s5, 0xd6ca5b, s5
    s_cmp_eq_u32 s41, 1
    s_cselect_b32 s4, 0x98721054, s4
    s_cselect_b32 s5, 0xd6ca3b, s5
    s_cmp_eq_u32 s41, 6
    s_cselect_b32 s4, 0xb9842107, s4
    s_cselect_b32 s5, 0xd6ca53, s5
    s_cmp_eq_u32 s41, 7
    s_cselect_b32 s4, 0xb9742108, s4
    s_cselect_b32 s5, 0xd6ca53, s5
    s_cmp_eq_u32 s41, 4
    s_cselect_b32 s4, 0x874210a9, s4
    s_cselect_b32 s5, 0xd6c53b, s5
    s_cmp_eq_u32 s41, 5
    s_cselect_b32 s4, 0x874210cb, s4
    s_cselect_b32 s5, 0xd6a539, s5
    s_lshl_b32 s6, s40, 14
    s_xor_b32 s7, s6, 16384
    s_add_u32 s6, s6, s52
    s_add_u32 s7, s7, s52
    s_lshl_b32 s8, s32, 23
    s_mul_i32 s9, s32, 262144
    s_add_u32 s9, s9, 33554432
    s_lshl_b32 s16, s3, 13
    s_lshl_b32 s17, s3, 10
    s_add_u32 s17, s17, 135168
    s_setprio 1
    s_waitcnt vmcnt(0)
    s_barrier
    s_cmp_ge_u32 s38, 2
    s_cbranch_scc1 L_cq
    s_add_u32 s55, s53, s38
    s_lshl_b32 s55, s55, 17
    s_add_u32 s55, s55, s52
    ds_read_b64_tr_b16 v[8:9], v2 offset:8448
    ds_read_b64_tr_b16 v[10:11], v2 offset:8704
    ds_read_b128 v[24:27], v1 offset:0
    ds_read_b128 v[28:31], v1 offset:512
    ds_read_b64_tr_b16 v[12:13], v2 offset:8480
    ds_read_b64_tr_b16 v[14:15], v2 offset:8736
    ds_read_b128 v[40:43], v1 offset:4224
    ds_read_b128 v[44:47], v1 offset:4736
.p2align 6
L_p1_81:
    s_waitcnt lgkmcnt(5)
    v_mfma_f32_16x16x32_bf16 v[176:179], v[8:11], v[24:27], v[176:179]
    ds_read_b64_tr_b16 v[16:17], v2 offset:8512
    s_waitcnt lgkmcnt(5)
    v_mfma_f32_16x16x32_bf16 v[180:183], v[8:11], v[28:31], v[180:183]
    ds_read_b64_tr_b16 v[18:19], v2 offset:8768
    s_waitcnt lgkmcnt(4)
    v_mfma_f32_16x16x32_bf16 v[196:199], v[12:15], v[28:31], v[196:199]
    ds_read_b64_tr_b16 v[20:21], v2 offset:8544
    v_mfma_f32_16x16x32_bf16 v[192:195], v[12:15], v[24:27], v[192:195]
    ds_read_b64_tr_b16 v[22:23], v2 offset:8800
    s_waitcnt lgkmcnt(5)
    v_mfma_f32_16x16x32_bf16 v[200:203], v[12:15], v[40:43], v[200:203]
    s_waitcnt lgkmcnt(4)
    v_mfma_f32_16x16x32_bf16 v[204:207], v[12:15], v[44:47], v[204:207]
    v_mfma_f32_16x16x32_bf16 v[188:191], v[8:11], v[44:47], v[188:191]
    v_mfma_f32_16x16x32_bf16 v[184:187], v[8:11], v[40:43], v[184:187]
    s_waitcnt lgkmcnt(2)
    v_mfma_f32_16x16x32_bf16 v[216:219], v[16:19], v[40:43], v[216:219]
    ds_read_b64_tr_b16 v[8:9], v2 offset:0
    v_mfma_f32_16x16x32_bf16 v[220:223], v[16:19], v[44:47], v[220:223]
    ds_read_b64_tr_b16 v[10:11], v2 offset:256
    v_mfma_f32_16x16x32_bf16 v[208:211], v[16:19], v[24:27], v[208:211]
    ds_read_b64_tr_b16 v[12:13], v2 offset:32
    v_mfma_f32_16x16x32_bf16 v[212:215], v[16:19], v[28:31], v[212:215]
    ds_read_b64_tr_b16 v[14:15], v2 offset:288
    s_waitcnt lgkmcnt(4)
    v_mfma_f32_16x16x32_bf16 v[228:231], v[20:23], v[28:31], v[228:231]
    ds_read_b64_tr_b16 v[16:17], v2 offset:64
    v_mfma_f32_16x16x32_bf16 v[224:227], v[20:23], v[24:27], v[224:227]
    ds_read_b64_tr_b16 v[18:19], v2 offset:320
    v_mfma_f32_16x16x32_bf16 v[236:239], v[20:23], v[44:47], v[236:239]
    v_mfma_f32_16x16x32_bf16 v[232:235], v[20:23], v[40:43], v[232:235]
    s_waitcnt lgkmcnt(4)
    v_mfma_f32_16x16x32_bf16 v[56:59], v[40:43], v[8:11], v[56:59]
    ds_read_b64_tr_b16 v[20:21], v2 offset:96
    v_mfma_f32_16x16x32_bf16 v[60:63], v[44:47], v[8:11], v[60:63]
    ds_read_b64_tr_b16 v[22:23], v2 offset:352
    v_mfma_f32_16x16x32_bf16 v[48:51], v[24:27], v[8:11], v[48:51]
    v_mfma_f32_16x16x32_bf16 v[52:55], v[28:31], v[8:11], v[52:55]
    s_waitcnt lgkmcnt(4)
    v_mfma_f32_16x16x32_bf16 v[68:71], v[28:31], v[12:15], v[68:71]
    ds_read_b64_tr_b16 v[8:9], v3 offset:0
    v_mfma_f32_16x16x32_bf16 v[64:67], v[24:27], v[12:15], v[64:67]
    ds_read_b64_tr_b16 v[10:11], v3 offset:256
    v_mfma_f32_16x16x32_bf16 v[76:79], v[44:47], v[12:15], v[76:79]
    v_mfma_f32_16x16x32_bf16 v[72:75], v[40:43], v[12:15], v[72:75]
    s_waitcnt lgkmcnt(4)
    v_mfma_f32_16x16x32_bf16 v[88:91], v[40:43], v[16:19], v[88:91]
    ds_read_b64_tr_b16 v[12:13], v2 offset:4224
    v_mfma_f32_16x16x32_bf16 v[92:95], v[44:47], v[16:19], v[92:95]
    ds_read_b64_tr_b16 v[14:15], v2 offset:4480
    v_mfma_f32_16x16x32_bf16 v[80:83], v[24:27], v[16:19], v[80:83]
    v_mfma_f32_16x16x32_bf16 v[84:87], v[28:31], v[16:19], v[84:87]
    s_waitcnt lgkmcnt(4)
    v_mfma_f32_16x16x32_bf16 v[100:103], v[28:31], v[20:23], v[100:103]
    ds_read_b64_tr_b16 v[16:17], v2 offset:4256
    v_mfma_f32_16x16x32_bf16 v[96:99], v[24:27], v[20:23], v[96:99]
    ds_read_b64_tr_b16 v[18:19], v2 offset:4512
    v_mfma_f32_16x16x32_bf16 v[108:111], v[44:47], v[20:23], v[108:111]
    v_mfma_f32_16x16x32_bf16 v[104:107], v[40:43], v[20:23], v[104:107]
    s_waitcnt lgkmcnt(4)
    v_mfma_f32_16x16x32_bf16 v[248:251], v[8:11], v[40:43], v[248:251]
    ds_read_b64_tr_b16 v[20:21], v2 offset:4288
    v_mfma_f32_16x16x32_bf16 v[252:255], v[8:11], v[44:47], v[252:255]
    ds_read_b64_tr_b16 v[22:23], v2 offset:4544
    v_mfma_f32_16x16x32_bf16 v[240:243], v[8:11], v[24:27], v[240:243]
    v_mfma_f32_16x16x32_bf16 v[244:247], v[8:11], v[28:31], v[244:247]
    s_waitcnt lgkmcnt(4)
    v_mfma_f32_16x16x32_bf16 v[116:119], v[28:31], v[12:15], v[116:119]
    ds_read_b64_tr_b16 v[8:9], v2 offset:4320
    v_mfma_f32_16x16x32_bf16 v[112:115], v[24:27], v[12:15], v[112:115]
    ds_read_b64_tr_b16 v[10:11], v2 offset:4576
    v_mfma_f32_16x16x32_bf16 v[124:127], v[44:47], v[12:15], v[124:127]
    v_mfma_f32_16x16x32_bf16 v[120:123], v[40:43], v[12:15], v[120:123]
    s_waitcnt lgkmcnt(4)
    v_mfma_f32_16x16x32_bf16 v[136:139], v[40:43], v[16:19], v[136:139]
    v_mfma_f32_16x16x32_bf16 v[140:143], v[44:47], v[16:19], v[140:143]
    v_mfma_f32_16x16x32_bf16 v[128:131], v[24:27], v[16:19], v[128:131]
    s_waitcnt lgkmcnt(0)
    s_barrier
    v_mfma_f32_16x16x32_bf16 v[132:135], v[28:31], v[16:19], v[132:135]
    ds_read_b64_tr_b16 v[12:13], v2 offset:22144
    ds_read_b64_tr_b16 v[14:15], v2 offset:22400
    v_mfma_f32_16x16x32_bf16 v[152:155], v[40:43], v[20:23], v[152:155]
    ds_read_b128 v[32:35], v1 offset:64
    ds_read_b128 v[36:39], v1 offset:576
    v_mfma_f32_16x16x32_bf16 v[156:159], v[44:47], v[20:23], v[156:159]
    ds_read_b64_tr_b16 v[16:17], v2 offset:22176
    v_mfma_f32_16x16x32_bf16 v[172:175], v[44:47], v[8:11], v[172:175]
    ds_read_b64_tr_b16 v[18:19], v2 offset:22432
    v_mfma_f32_16x16x32_bf16 v[168:171], v[40:43], v[8:11], v[168:171]
    ds_read_b128 v[40:43], v1 offset:4288
    v_mfma_f32_16x16x32_bf16 v[164:167], v[28:31], v[8:11], v[164:167]
    ds_read_b128 v[44:47], v1 offset:4800
    v_mfma_f32_16x16x32_bf16 v[160:163], v[24:27], v[8:11], v[160:163]
    v_mfma_f32_16x16x32_bf16 v[144:147], v[24:27], v[20:23], v[144:147]
    v_mfma_f32_16x16x32_bf16 v[148:151], v[28:31], v[20:23], v[148:151]
    s_waitcnt lgkmcnt(5)
    v_mfma_f32_16x16x32_bf16 v[176:179], v[12:15], v[32:35], v[176:179]
    ds_read_b64_tr_b16 v[20:21], v2 offset:22208
    s_waitcnt lgkmcnt(5)
    v_mfma_f32_16x16x32_bf16 v[180:183], v[12:15], v[36:39], v[180:183]
    ds_read_b64_tr_b16 v[22:23], v2 offset:22464
    s_waitcnt lgkmcnt(4)
    v_mfma_f32_16x16x32_bf16 v[196:199], v[16:19], v[36:39], v[196:199]
    ds_read_b64_tr_b16 v[8:9], v2 offset:22240
    v_mfma_f32_16x16x32_bf16 v[192:195], v[16:19], v[32:35], v[192:195]
    ds_read_b64_tr_b16 v[10:11], v2 offset:22496
    s_waitcnt lgkmcnt(5)
    v_mfma_f32_16x16x32_bf16 v[200:203], v[16:19], v[40:43], v[200:203]
    s_waitcnt lgkmcnt(4)
    v_mfma_f32_16x16x32_bf16 v[204:207], v[16:19], v[44:47], v[204:207]
    v_mfma_f32_16x16x32_bf16 v[188:191], v[12:15], v[44:47], v[188:191]
    v_mfma_f32_16x16x32_bf16 v[184:187], v[12:15], v[40:43], v[184:187]
    s_waitcnt lgkmcnt(2)
    v_mfma_f32_16x16x32_bf16 v[216:219], v[20:23], v[40:43], v[216:219]
    ds_read_b64_tr_b16 v[12:13], v2 offset:13696
    v_mfma_f32_16x16x32_bf16 v[220:223], v[20:23], v[44:47], v[220:223]
    ds_read_b64_tr_b16 v[14:15], v2 offset:13952
    v_mfma_f32_16x16x32_bf16 v[208:211], v[20:23], v[32:35], v[208:211]
    ds_read_b64_tr_b16 v[16:17], v2 offset:13728
    v_mfma_f32_16x16x32_bf16 v[212:215], v[20:23], v[36:39], v[212:215]
    ds_read_b64_tr_b16 v[18:19], v2 offset:13984
    s_waitcnt lgkmcnt(4)
    v_mfma_f32_16x16x32_bf16 v[228:231], v[8:11], v[36:39], v[228:231]
    ds_read_b64_tr_b16 v[20:21], v2 offset:13760
    v_mfma_f32_16x16x32_bf16 v[224:227], v[8:11], v[32:35], v[224:227]
    ds_read_b64_tr_b16 v[22:23], v2 offset:14016
    v_mfma_f32_16x16x32_bf16 v[236:239], v[8:11], v[44:47], v[236:239]
    v_mfma_f32_16x16x32_bf16 v[232:235], v[8:11], v[40:43], v[232:235]
    s_waitcnt lgkmcnt(4)
    v_mfma_f32_16x16x32_bf16 v[56:59], v[40:43], v[12:15], v[56:59]
    ds_read_b64_tr_b16 v[8:9], v2 offset:13792
    v_mfma_f32_16x16x32_bf16 v[60:63], v[44:47], v[12:15], v[60:63]
    ds_read_b64_tr_b16 v[10:11], v2 offset:14048
    v_mfma_f32_16x16x32_bf16 v[48:51], v[32:35], v[12:15], v[48:51]
    v_mfma_f32_16x16x32_bf16 v[52:55], v[36:39], v[12:15], v[52:55]
    s_waitcnt lgkmcnt(4)
    v_mfma_f32_16x16x32_bf16 v[68:71], v[36:39], v[16:19], v[68:71]
    ds_read_b64_tr_b16 v[12:13], v3 offset:13696
    v_mfma_f32_16x16x32_bf16 v[64:67], v[32:35], v[16:19], v[64:67]
    ds_read_b64_tr_b16 v[14:15], v3 offset:13952
    v_mfma_f32_16x16x32_bf16 v[76:79], v[44:47], v[16:19], v[76:79]
    v_mfma_f32_16x16x32_bf16 v[72:75], v[40:43], v[16:19], v[72:75]
    s_waitcnt lgkmcnt(4)
    v_mfma_f32_16x16x32_bf16 v[88:91], v[40:43], v[20:23], v[88:91]
    ds_read_b64_tr_b16 v[16:17], v2 offset:17920
    v_mfma_f32_16x16x32_bf16 v[92:95], v[44:47], v[20:23], v[92:95]
    ds_read_b64_tr_b16 v[18:19], v2 offset:18176
    v_mfma_f32_16x16x32_bf16 v[80:83], v[32:35], v[20:23], v[80:83]
    v_mfma_f32_16x16x32_bf16 v[84:87], v[36:39], v[20:23], v[84:87]
    s_waitcnt lgkmcnt(4)
    v_mfma_f32_16x16x32_bf16 v[100:103], v[36:39], v[8:11], v[100:103]
    ds_read_b64_tr_b16 v[20:21], v2 offset:17952
    v_mfma_f32_16x16x32_bf16 v[96:99], v[32:35], v[8:11], v[96:99]
    ds_read_b64_tr_b16 v[22:23], v2 offset:18208
    v_mfma_f32_16x16x32_bf16 v[108:111], v[44:47], v[8:11], v[108:111]
    v_mfma_f32_16x16x32_bf16 v[104:107], v[40:43], v[8:11], v[104:107]
    s_waitcnt lgkmcnt(4)
    v_mfma_f32_16x16x32_bf16 v[248:251], v[12:15], v[40:43], v[248:251]
    ds_read_b64_tr_b16 v[8:9], v2 offset:17984
    v_mfma_f32_16x16x32_bf16 v[252:255], v[12:15], v[44:47], v[252:255]
    ds_read_b64_tr_b16 v[10:11], v2 offset:18240
    v_mfma_f32_16x16x32_bf16 v[240:243], v[12:15], v[32:35], v[240:243]
    v_mfma_f32_16x16x32_bf16 v[244:247], v[12:15], v[36:39], v[244:247]
    s_waitcnt lgkmcnt(4)
    v_mfma_f32_16x16x32_bf16 v[116:119], v[36:39], v[16:19], v[116:119]
    ds_read_b64_tr_b16 v[12:13], v2 offset:18016
    v_mfma_f32_16x16x32_bf16 v[112:115], v[32:35], v[16:19], v[112:115]
    ds_read_b64_tr_b16 v[14:15], v2 offset:18272
    v_mfma_f32_16x16x32_bf16 v[124:127], v[44:47], v[16:19], v[124:127]
    s_add_u32 s46, s46, 33792
    s_cmp_eq_u32 s46, 101376
    v_mfma_f32_16x16x32_bf16 v[120:123], v[40:43], v[16:19], v[120:123]
    s_cselect_b32 s47, s48, s49
    s_cselect_b32 s46, 0, s46
    s_waitcnt lgkmcnt(4)
    v_mfma_f32_16x16x32_bf16 v[136:139], v[40:43], v[20:23], v[136:139]
    v_add_u32 v1, s47, v1
    v_mfma_f32_16x16x32_bf16 v[140:143], v[44:47], v[20:23], v[140:143]
    v_mfma_f32_16x16x32_bf16 v[128:131], v[32:35], v[20:23], v[128:131]
    s_waitcnt lgkmcnt(0)
    s_barrier
    v_mfma_f32_16x16x32_bf16 v[132:135], v[36:39], v[20:23], v[132:135]
    ds_read_b64_tr_b16 v[16:17], v2 offset:35840
    ds_read_b64_tr_b16 v[18:19], v2 offset:36096
    v_mfma_f32_16x16x32_bf16 v[152:155], v[40:43], v[8:11], v[152:155]
    ds_read_b128 v[24:27], v1 offset:0
    ds_read_b128 v[28:31], v1 offset:512
    v_mfma_f32_16x16x32_bf16 v[156:159], v[44:47], v[8:11], v[156:159]
    ds_read_b64_tr_b16 v[20:21], v2 offset:35872
    v_mfma_f32_16x16x32_bf16 v[172:175], v[44:47], v[12:15], v[172:175]
    ds_read_b64_tr_b16 v[22:23], v2 offset:36128
    v_mfma_f32_16x16x32_bf16 v[168:171], v[40:43], v[12:15], v[168:171]
    ds_read_b128 v[40:43], v1 offset:4224
    v_mfma_f32_16x16x32_bf16 v[164:167], v[36:39], v[12:15], v[164:167]
    ds_read_b128 v[44:47], v1 offset:4736
    v_mfma_f32_16x16x32_bf16 v[160:163], v[32:35], v[12:15], v[160:163]
    v_mfma_f32_16x16x32_bf16 v[144:147], v[32:35], v[8:11], v[144:147]
    v_mfma_f32_16x16x32_bf16 v[148:151], v[36:39], v[8:11], v[148:151]
    s_waitcnt lgkmcnt(5)
    v_mfma_f32_16x16x32_bf16 v[176:179], v[16:19], v[24:27], v[176:179]
    ds_read_b64_tr_b16 v[8:9], v2 offset:35904
    s_waitcnt lgkmcnt(5)
    v_mfma_f32_16x16x32_bf16 v[180:183], v[16:19], v[28:31], v[180:183]
    ds_read_b64_tr_b16 v[10:11], v2 offset:36160
    s_waitcnt lgkmcnt(4)
    v_mfma_f32_16x16x32_bf16 v[196:199], v[20:23], v[28:31], v[196:199]
    ds_read_b64_tr_b16 v[12:13], v2 offset:35936
    v_mfma_f32_16x16x32_bf16 v[192:195], v[20:23], v[24:27], v[192:195]
    ds_read_b64_tr_b16 v[14:15], v2 offset:36192
    s_waitcnt lgkmcnt(5)
    v_mfma_f32_16x16x32_bf16 v[200:203], v[20:23], v[40:43], v[200:203]
    s_waitcnt lgkmcnt(4)
    v_mfma_f32_16x16x32_bf16 v[204:207], v[20:23], v[44:47], v[204:207]
    v_mfma_f32_16x16x32_bf16 v[188:191], v[16:19], v[44:47], v[188:191]
    v_mfma_f32_16x16x32_bf16 v[184:187], v[16:19], v[40:43], v[184:187]
    s_waitcnt lgkmcnt(2)
    v_mfma_f32_16x16x32_bf16 v[216:219], v[8:11], v[40:43], v[216:219]
    ds_read_b64_tr_b16 v[16:17], v2 offset:27392
    v_mfma_f32_16x16x32_bf16 v[220:223], v[8:11], v[44:47], v[220:223]
    ds_read_b64_tr_b16 v[18:19], v2 offset:27648
    v_mfma_f32_16x16x32_bf16 v[208:211], v[8:11], v[24:27], v[208:211]
    ds_read_b64_tr_b16 v[20:21], v2 offset:27424
    v_mfma_f32_16x16x32_bf16 v[212:215], v[8:11], v[28:31], v[212:215]
    ds_read_b64_tr_b16 v[22:23], v2 offset:27680
    s_waitcnt lgkmcnt(4)
    v_mfma_f32_16x16x32_bf16 v[228:231], v[12:15], v[28:31], v[228:231]
    ds_read_b64_tr_b16 v[8:9], v2 offset:27456
    v_mfma_f32_16x16x32_bf16 v[224:227], v[12:15], v[24:27], v[224:227]
    ds_read_b64_tr_b16 v[10:11], v2 offset:27712
    v_mfma_f32_16x16x32_bf16 v[236:239], v[12:15], v[44:47], v[236:239]
    v_mfma_f32_16x16x32_bf16 v[232:235], v[12:15], v[40:43], v[232:235]
    s_waitcnt lgkmcnt(4)
    v_mfma_f32_16x16x32_bf16 v[56:59], v[40:43], v[16:19], v[56:59]
    ds_read_b64_tr_b16 v[12:13], v2 offset:27488
    v_mfma_f32_16x16x32_bf16 v[60:63], v[44:47], v[16:19], v[60:63]
    ds_read_b64_tr_b16 v[14:15], v2 offset:27744
    v_mfma_f32_16x16x32_bf16 v[48:51], v[24:27], v[16:19], v[48:51]
    v_mfma_f32_16x16x32_bf16 v[52:55], v[28:31], v[16:19], v[52:55]
    s_waitcnt lgkmcnt(4)
    v_mfma_f32_16x16x32_bf16 v[68:71], v[28:31], v[20:23], v[68:71]
    ds_read_b64_tr_b16 v[16:17], v3 offset:27392
    v_mfma_f32_16x16x32_bf16 v[64:67], v[24:27], v[20:23], v[64:67]
    ds_read_b64_tr_b16 v[18:19], v3 offset:27648
    v_mfma_f32_16x16x32_bf16 v[76:79], v[44:47], v[20:23], v[76:79]
    v_mfma_f32_16x16x32_bf16 v[72:75], v[40:43], v[20:23], v[72:75]
    s_waitcnt lgkmcnt(4)
    v_mfma_f32_16x16x32_bf16 v[88:91], v[40:43], v[8:11], v[88:91]
    ds_read_b64_tr_b16 v[20:21], v2 offset:31616
    v_mfma_f32_16x16x32_bf16 v[92:95], v[44:47], v[8:11], v[92:95]
    ds_read_b64_tr_b16 v[22:23], v2 offset:31872
    v_mfma_f32_16x16x32_bf16 v[80:83], v[24:27], v[8:11], v[80:83]
    v_mfma_f32_16x16x32_bf16 v[84:87], v[28:31], v[8:11], v[84:87]
    s_waitcnt lgkmcnt(4)
    v_mfma_f32_16x16x32_bf16 v[100:103], v[28:31], v[12:15], v[100:103]
    ds_read_b64_tr_b16 v[8:9], v2 offset:31648
    v_mfma_f32_16x16x32_bf16 v[96:99], v[24:27], v[12:15], v[96:99]
    ds_read_b64_tr_b16 v[10:11], v2 offset:31904
    v_mfma_f32_16x16x32_bf16 v[108:111], v[44:47], v[12:15], v[108:111]
    v_mfma_f32_16x16x32_bf16 v[104:107], v[40:43], v[12:15], v[104:107]
    s_waitcnt lgkmcnt(4)
    v_mfma_f32_16x16x32_bf16 v[248:251], v[16:19], v[40:43], v[248:251]
    ds_read_b64_tr_b16 v[12:13], v2 offset:31680
    v_mfma_f32_16x16x32_bf16 v[252:255], v[16:19], v[44:47], v[252:255]
    ds_read_b64_tr_b16 v[14:15], v2 offset:31936
    v_mfma_f32_16x16x32_bf16 v[240:243], v[16:19], v[24:27], v[240:243]
    v_mfma_f32_16x16x32_bf16 v[244:247], v[16:19], v[28:31], v[244:247]
    s_waitcnt lgkmcnt(4)
    v_mfma_f32_16x16x32_bf16 v[116:119], v[28:31], v[20:23], v[116:119]
    ds_read_b64_tr_b16 v[16:17], v2 offset:31712
    v_mfma_f32_16x16x32_bf16 v[112:115], v[24:27], v[20:23], v[112:115]
    ds_read_b64_tr_b16 v[18:19], v2 offset:31968
    v_mfma_f32_16x16x32_bf16 v[124:127], v[44:47], v[20:23], v[124:127]
    v_mfma_f32_16x16x32_bf16 v[120:123], v[40:43], v[20:23], v[120:123]
    s_waitcnt lgkmcnt(4)
    v_mfma_f32_16x16x32_bf16 v[136:139], v[40:43], v[8:11], v[136:139]
    v_mfma_f32_16x16x32_bf16 v[140:143], v[44:47], v[8:11], v[140:143]
    v_mfma_f32_16x16x32_bf16 v[128:131], v[24:27], v[8:11], v[128:131]
    s_waitcnt lgkmcnt(0)
    s_barrier
    v_mfma_f32_16x16x32_bf16 v[132:135], v[28:31], v[8:11], v[132:135]
    ds_read_b64_tr_b16 v[20:21], v2 offset:49536
    ds_read_b64_tr_b16 v[22:23], v2 offset:49792
    v_mfma_f32_16x16x32_bf16 v[152:155], v[40:43], v[12:15], v[152:155]
    ds_read_b128 v[32:35], v1 offset:64
    ds_read_b128 v[36:39], v1 offset:576
    v_mfma_f32_16x16x32_bf16 v[156:159], v[44:47], v[12:15], v[156:159]
    ds_read_b64_tr_b16 v[8:9], v2 offset:49568
    v_mfma_f32_16x16x32_bf16 v[172:175], v[44:47], v[16:19], v[172:175]
    ds_read_b64_tr_b16 v[10:11], v2 offset:49824
    v_mfma_f32_16x16x32_bf16 v[168:171], v[40:43], v[16:19], v[168:171]
    ds_read_b128 v[40:43], v1 offset:4288
    v_mfma_f32_16x16x32_bf16 v[164:167], v[28:31], v[16:19], v[164:167]
    ds_read_b128 v[44:47], v1 offset:4800
    v_mfma_f32_16x16x32_bf16 v[160:163], v[24:27], v[16:19], v[160:163]
    v_mfma_f32_16x16x32_bf16 v[144:147], v[24:27], v[12:15], v[144:147]
    v_mfma_f32_16x16x32_bf16 v[148:151], v[28:31], v[12:15], v[148:151]
    s_waitcnt lgkmcnt(5)
    v_mfma_f32_16x16x32_bf16 v[176:179], v[20:23], v[32:35], v[176:179]
    ds_read_b64_tr_b16 v[12:13], v2 offset:49600
    s_waitcnt lgkmcnt(5)
    v_mfma_f32_16x16x32_bf16 v[180:183], v[20:23], v[36:39], v[180:183]
    ds_read_b64_tr_b16 v[14:15], v2 offset:49856
    s_waitcnt lgkmcnt(4)
    v_mfma_f32_16x16x32_bf16 v[196:199], v[8:11], v[36:39], v[196:199]
    ds_read_b64_tr_b16 v[16:17], v2 offset:49632
    v_mfma_f32_16x16x32_bf16 v[192:195], v[8:11], v[32:35], v[192:195]
    ds_read_b64_tr_b16 v[18:19], v2 offset:49888
    s_waitcnt lgkmcnt(5)
    v_mfma_f32_16x16x32_bf16 v[200:203], v[8:11], v[40:43], v[200:203]
    s_waitcnt lgkmcnt(4)
    v_mfma_f32_16x16x32_bf16 v[204:207], v[8:11], v[44:47], v[204:207]
    v_mfma_f32_16x16x32_bf16 v[188:191], v[20:23], v[44:47], v[188:191]
    v_mfma_f32_16x16x32_bf16 v[184:187], v[20:23], v[40:43], v[184:187]
    s_waitcnt lgkmcnt(2)
    v_mfma_f32_16x16x32_bf16 v[216:219], v[12:15], v[40:43], v[216:219]
    ds_read_b64_tr_b16 v[20:21], v2 offset:41088
    v_mfma_f32_16x16x32_bf16 v[220:223], v[12:15], v[44:47], v[220:223]
    ds_read_b64_tr_b16 v[22:23], v2 offset:41344
    v_mfma_f32_16x16x32_bf16 v[208:211], v[12:15], v[32:35], v[208:211]
    ds_read_b64_tr_b16 v[8:9], v2 offset:41120
    v_mfma_f32_16x16x32_bf16 v[212:215], v[12:15], v[36:39], v[212:215]
    ds_read_b64_tr_b16 v[10:11], v2 offset:41376
    s_waitcnt lgkmcnt(4)
    v_mfma_f32_16x16x32_bf16 v[228:231], v[16:19], v[36:39], v[228:231]
    ds_read_b64_tr_b16 v[12:13], v2 offset:41152
    v_mfma_f32_16x16x32_bf16 v[224:227], v[16:19], v[32:35], v[224:227]
    ds_read_b64_tr_b16 v[14:15], v2 offset:41408
    v_mfma_f32_16x16x32_bf16 v[236:239], v[16:19], v[44:47], v[236:239]
    v_mfma_f32_16x16x32_bf16 v[232:235], v[16:19], v[40:43], v[232:235]
    s_waitcnt lgkmcnt(4)
    v_mfma_f32_16x16x32_bf16 v[56:59], v[40:43], v[20:23], v[56:59]
    ds_read_b64_tr_b16 v[16:17], v2 offset:41184
    v_mfma_f32_16x16x32_bf16 v[60:63], v[44:47], v[20:23], v[60:63]
    ds_read_b64_tr_b16 v[18:19], v2 offset:41440
    v_mfma_f32_16x16x32_bf16 v[48:51], v[32:35], v[20:23], v[48:51]
    v_mfma_f32_16x16x32_bf16 v[52:55], v[36:39], v[20:23], v[52:55]
    s_waitcnt lgkmcnt(4)
    v_mfma_f32_16x16x32_bf16 v[68:71], v[36:39], v[8:11], v[68:71]
    ds_read_b64_tr_b16 v[20:21], v3 offset:41088
    v_mfma_f32_16x16x32_bf16 v[64:67], v[32:35], v[8:11], v[64:67]
    ds_read_b64_tr_b16 v[22:23], v3 offset:41344
    v_mfma_f32_16x16x32_bf16 v[76:79], v[44:47], v[8:11], v[76:79]
    v_mfma_f32_16x16x32_bf16 v[72:75], v[40:43], v[8:11], v[72:75]
    s_waitcnt lgkmcnt(4)
    v_mfma_f32_16x16x32_bf16 v[88:91], v[40:43], v[12:15], v[88:91]
    ds_read_b64_tr_b16 v[8:9], v2 offset:45312
    v_mfma_f32_16x16x32_bf16 v[92:95], v[44:47], v[12:15], v[92:95]
    ds_read_b64_tr_b16 v[10:11], v2 offset:45568
    v_mfma_f32_16x16x32_bf16 v[80:83], v[32:35], v[12:15], v[80:83]
    v_mfma_f32_16x16x32_bf16 v[84:87], v[36:39], v[12:15], v[84:87]
    s_waitcnt lgkmcnt(4)
    v_mfma_f32_16x16x32_bf16 v[100:103], v[36:39], v[16:19], v[100:103]
    ds_read_b64_tr_b16 v[12:13], v2 offset:45344
    v_mfma_f32_16x16x32_bf16 v[96:99], v[32:35], v[16:19], v[96:99]
    ds_read_b64_tr_b16 v[14:15], v2 offset:45600
    v_mfma_f32_16x16x32_bf16 v[108:111], v[44:47], v[16:19], v[108:111]
    v_mfma_f32_16x16x32_bf16 v[104:107], v[40:43], v[16:19], v[104:107]
    s_waitcnt lgkmcnt(4)
    v_mfma_f32_16x16x32_bf16 v[248:251], v[20:23], v[40:43], v[248:251]
    ds_read_b64_tr_b16 v[16:17], v2 offset:45376
    v_mfma_f32_16x16x32_bf16 v[252:255], v[20:23], v[44:47], v[252:255]
    ds_read_b64_tr_b16 v[18:19], v2 offset:45632
    v_mfma_f32_16x16x32_bf16 v[240:243], v[20:23], v[32:35], v[240:243]
    v_mfma_f32_16x16x32_bf16 v[244:247], v[20:23], v[36:39], v[244:247]
    s_waitcnt lgkmcnt(4)
    v_mfma_f32_16x16x32_bf16 v[116:119], v[36:39], v[8:11], v[116:119]
    ds_read_b64_tr_b16 v[20:21], v2 offset:45408
    v_mfma_f32_16x16x32_bf16 v[112:115], v[32:35], v[8:11], v[112:115]
    ds_read_b64_tr_b16 v[22:23], v2 offset:45664
    v_mfma_f32_16x16x32_bf16 v[124:127], v[44:47], v[8:11], v[124:127]
    s_add_u32 s46, s46, 33792
    s_cmp_eq_u32 s46, 101376
    v_mfma_f32_16x16x32_bf16 v[120:123], v[40:43], v[8:11], v[120:123]
    s_cselect_b32 s47, s48, s49
    s_cselect_b32 s46, 0, s46
    s_waitcnt lgkmcnt(4)
    v_mfma_f32_16x16x32_bf16 v[136:139], v[40:43], v[12:15], v[136:139]
    v_add_u32 v1, s47, v1
    v_mfma_f32_16x16x32_bf16 v[140:143], v[44:47], v[12:15], v[140:143]
    v_mfma_f32_16x16x32_bf16 v[128:131], v[32:35], v[12:15], v[128:131]
    s_waitcnt lgkmcnt(0)
    s_barrier
    v_mfma_f32_16x16x32_bf16 v[132:135], v[36:39], v[12:15], v[132:135]
    ds_read_b64_tr_b16 v[8:9], v2 offset:8448
    ds_read_b64_tr_b16 v[10:11], v2 offset:8704
    v_mfma_f32_16x16x32_bf16 v[152:155], v[40:43], v[16:19], v[152:155]
    ds_read_b128 v[24:27], v1 offset:0
    ds_read_b128 v[28:31], v1 offset:512
    v_mfma_f32_16x16x32_bf16 v[156:159], v[44:47], v[16:19], v[156:159]
    ds_read_b64_tr_b16 v[12:13], v2 offset:8480
    v_mfma_f32_16x16x32_bf16 v[172:175], v[44:47], v[20:23], v[172:175]
    ds_read_b64_tr_b16 v[14:15], v2 offset:8736
    v_mfma_f32_16x16x32_bf16 v[168:171], v[40:43], v[20:23], v[168:171]
    ds_read_b128 v[40:43], v1 offset:4224
    v_mfma_f32_16x16x32_bf16 v[164:167], v[36:39], v[20:23], v[164:167]
    ds_read_b128 v[44:47], v1 offset:4736
    v_mfma_f32_16x16x32_bf16 v[160:163], v[32:35], v[20:23], v[160:163]
    s_sub_u32 s45, s45, 1
    v_mfma_f32_16x16x32_bf16 v[144:147], v[32:35], v[16:19], v[144:147]
    s_cmp_lg_u32 s45, 0
    v_mfma_f32_16x16x32_bf16 v[148:151], v[36:39], v[16:19], v[148:151]
    s_cbranch_scc1 L_p1_81
    v_mov_b32 v5, 163832
    ds_read_b32 v6, v5
    v_add_u32 v5, 4294899712, v1
    s_waitcnt lgkmcnt(6)
    v_mfma_f32_16x16x32_bf16 v[176:179], v[8:11], v[24:27], v[176:179]
    ds_read_b64_tr_b16 v[16:17], v2 offset:8512
    ds_read_b64_tr_b16 v[18:19], v2 offset:8768
    s_waitcnt lgkmcnt(7)
    v_mfma_f32_16x16x32_bf16 v[180:183], v[8:11], v[28:31], v[180:183]
    ds_read_b64_tr_b16 v[20:21], v2 offset:8544
    ds_read_b64_tr_b16 v[22:23], v2 offset:8800
    s_waitcnt lgkmcnt(7)
    v_mfma_f32_16x16x32_bf16 v[196:199], v[12:15], v[28:31], v[196:199]
    ds_read_b128 v[32:35], v1 offset:64
    v_mfma_f32_16x16x32_bf16 v[192:195], v[12:15], v[24:27], v[192:195]
    ds_read_b128 v[36:39], v1 offset:576
    s_waitcnt lgkmcnt(8)
    v_mfma_f32_16x16x32_bf16 v[200:203], v[12:15], v[40:43], v[200:203]
    s_waitcnt lgkmcnt(7)
    v_mfma_f32_16x16x32_bf16 v[204:207], v[12:15], v[44:47], v[204:207]
    ds_read_b64_tr_b16 v[12:13], v2 offset:22176
    v_mfma_f32_16x16x32_bf16 v[188:191], v[8:11], v[44:47], v[188:191]
    ds_read_b64_tr_b16 v[14:15], v2 offset:22432
    v_mfma_f32_16x16x32_bf16 v[184:187], v[8:11], v[40:43], v[184:187]
    ds_read_b64_tr_b16 v[8:9], v2 offset:22144
    ds_read_b64_tr_b16 v[10:11], v2 offset:22400
    s_waitcnt lgkmcnt(8)
    v_mfma_f32_16x16x32_bf16 v[216:219], v[16:19], v[40:43], v[216:219]
    v_mfma_f32_16x16x32_bf16 v[220:223], v[16:19], v[44:47], v[220:223]
    s_waitcnt lgkmcnt(6)
    v_mfma_f32_16x16x32_bf16 v[236:239], v[20:23], v[44:47], v[236:239]
    ds_read_b128 v[44:47], v1 offset:4800
    v_mfma_f32_16x16x32_bf16 v[232:235], v[20:23], v[40:43], v[232:235]
    ds_read_b128 v[40:43], v1 offset:4288
    v_mfma_f32_16x16x32_bf16 v[228:231], v[20:23], v[28:31], v[228:231]
    v_mfma_f32_16x16x32_bf16 v[224:227], v[20:23], v[24:27], v[224:227]
    ds_read_b64_tr_b16 v[20:21], v2 offset:22240
    v_mfma_f32_16x16x32_bf16 v[208:211], v[16:19], v[24:27], v[208:211]
    ds_read_b64_tr_b16 v[22:23], v2 offset:22496
    v_mfma_f32_16x16x32_bf16 v[212:215], v[16:19], v[28:31], v[212:215]
    ds_read_b64_tr_b16 v[16:17], v2 offset:22208
    ds_read_b64_tr_b16 v[18:19], v2 offset:22464
    s_waitcnt lgkmcnt(6)
    v_mfma_f32_16x16x32_bf16 v[176:179], v[8:11], v[32:35], v[176:179]
    v_mfma_f32_16x16x32_bf16 v[180:183], v[8:11], v[36:39], v[180:183]
    v_mfma_f32_16x16x32_bf16 v[196:199], v[12:15], v[36:39], v[196:199]
    v_mfma_f32_16x16x32_bf16 v[192:195], v[12:15], v[32:35], v[192:195]
    s_barrier
    ds_read_b128 v[24:27], v5 offset:0
    s_waitcnt lgkmcnt(5)
    v_mfma_f32_16x16x32_bf16 v[200:203], v[12:15], v[40:43], v[200:203]
    ds_read_b128 v[28:31], v5 offset:512
    v_mfma_f32_16x16x32_bf16 v[204:207], v[12:15], v[44:47], v[204:207]
    ds_read_b64_tr_b16 v[12:13], v2 offset:35872
    v_mfma_f32_16x16x32_bf16 v[188:191], v[8:11], v[44:47], v[188:191]
    ds_read_b64_tr_b16 v[14:15], v2 offset:36128
    v_mfma_f32_16x16x32_bf16 v[184:187], v[8:11], v[40:43], v[184:187]
    ds_read_b64_tr_b16 v[8:9], v2 offset:35840
    ds_read_b64_tr_b16 v[10:11], v2 offset:36096
    s_waitcnt lgkmcnt(6)
    v_mfma_f32_16x16x32_bf16 v[216:219], v[16:19], v[40:43], v[216:219]
    v_mfma_f32_16x16x32_bf16 v[220:223], v[16:19], v[44:47], v[220:223]
    v_mfma_f32_16x16x32_bf16 v[236:239], v[20:23], v[44:47], v[236:239]
    ds_read_b128 v[44:47], v5 offset:4736
    v_mfma_f32_16x16x32_bf16 v[232:235], v[20:23], v[40:43], v[232:235]
    ds_read_b128 v[40:43], v5 offset:4224
    v_mfma_f32_16x16x32_bf16 v[228:231], v[20:23], v[36:39], v[228:231]
    v_mfma_f32_16x16x32_bf16 v[224:227], v[20:23], v[32:35], v[224:227]
    ds_read_b64_tr_b16 v[20:21], v2 offset:35936
    v_mfma_f32_16x16x32_bf16 v[208:211], v[16:19], v[32:35], v[208:211]
    ds_read_b64_tr_b16 v[22:23], v2 offset:36192
    v_mfma_f32_16x16x32_bf16 v[212:215], v[16:19], v[36:39], v[212:215]
    ds_read_b64_tr_b16 v[16:17], v2 offset:35904
    ds_read_b64_tr_b16 v[18:19], v2 offset:36160
    s_waitcnt lgkmcnt(6)
    v_mfma_f32_16x16x32_bf16 v[176:179], v[8:11], v[24:27], v[176:179]
    v_mfma_f32_16x16x32_bf16 v[180:183], v[8:11], v[28:31], v[180:183]
    v_mfma_f32_16x16x32_bf16 v[196:199], v[12:15], v[28:31], v[196:199]
    v_mfma_f32_16x16x32_bf16 v[192:195], v[12:15], v[24:27], v[192:195]
    s_waitcnt lgkmcnt(4)
    v_mfma_f32_16x16x32_bf16 v[200:203], v[12:15], v[40:43], v[200:203]
    v_mfma_f32_16x16x32_bf16 v[204:207], v[12:15], v[44:47], v[204:207]
    s_barrier
    ds_read_b128 v[32:35], v5 offset:64
    v_mfma_f32_16x16x32_bf16 v[188:191], v[8:11], v[44:47], v[188:191]
    ds_read_b128 v[36:39], v5 offset:576
    v_mfma_f32_16x16x32_bf16 v[184:187], v[8:11], v[40:43], v[184:187]
    ds_read_b64_tr_b16 v[8:9], v2 offset:49536
    ds_read_b64_tr_b16 v[10:11], v2 offset:49792
    s_waitcnt lgkmcnt(4)
    v_mfma_f32_16x16x32_bf16 v[216:219], v[16:19], v[40:43], v[216:219]
    ds_read_b64_tr_b16 v[12:13], v2 offset:49568
    v_mfma_f32_16x16x32_bf16 v[220:223], v[16:19], v[44:47], v[220:223]
    ds_read_b64_tr_b16 v[14:15], v2 offset:49824
    v_mfma_f32_16x16x32_bf16 v[236:239], v[20:23], v[44:47], v[236:239]
    ds_read_b128 v[44:47], v5 offset:4800
    v_mfma_f32_16x16x32_bf16 v[232:235], v[20:23], v[40:43], v[232:235]
    ds_read_b128 v[40:43], v5 offset:4288
    v_mfma_f32_16x16x32_bf16 v[228:231], v[20:23], v[28:31], v[228:231]
    v_mfma_f32_16x16x32_bf16 v[224:227], v[20:23], v[24:27], v[224:227]
    ds_read_b64_tr_b16 v[20:21], v2 offset:49632
    v_mfma_f32_16x16x32_bf16 v[208:211], v[16:19], v[24:27], v[208:211]
    ds_read_b64_tr_b16 v[22:23], v2 offset:49888
    v_mfma_f32_16x16x32_bf16 v[212:215], v[16:19], v[28:31], v[212:215]
    ds_read_b64_tr_b16 v[16:17], v2 offset:49600
    ds_read_b64_tr_b16 v[18:19], v2 offset:49856
    s_waitcnt lgkmcnt(8)
    v_mfma_f32_16x16x32_bf16 v[176:179], v[8:11], v[32:35], v[176:179]
    v_mfma_f32_16x16x32_bf16 v[180:183], v[8:11], v[36:39], v[180:183]
    s_waitcnt lgkmcnt(6)
    v_mfma_f32_16x16x32_bf16 v[196:199], v[12:15], v[36:39], v[196:199]
    ds_read_b128 v[24:27], v1 offset:0
    v_mfma_f32_16x16x32_bf16 v[192:195], v[12:15], v[32:35], v[192:195]
    ds_read_b128 v[28:31], v1 offset:512
    s_waitcnt lgkmcnt(6)
    v_mfma_f32_16x16x32_bf16 v[200:203], v[12:15], v[40:43], v[200:203]
    v_mfma_f32_16x16x32_bf16 v[204:207], v[12:15], v[44:47], v[204:207]
    ds_read_b64_tr_b16 v[12:13], v2 offset:32
    v_mfma_f32_16x16x32_bf16 v[188:191], v[8:11], v[44:47], v[188:191]
    ds_read_b64_tr_b16 v[14:15], v2 offset:288
    v_mfma_f32_16x16x32_bf16 v[184:187], v[8:11], v[40:43], v[184:187]
    ds_read_b64_tr_b16 v[8:9], v2 offset:0
    ds_read_b64_tr_b16 v[10:11], v2 offset:256
    s_waitcnt lgkmcnt(6)
    v_mfma_f32_16x16x32_bf16 v[216:219], v[16:19], v[40:43], v[216:219]
    v_mfma_f32_16x16x32_bf16 v[220:223], v[16:19], v[44:47], v[220:223]
    v_mfma_f32_16x16x32_bf16 v[236:239], v[20:23], v[44:47], v[236:239]
    ds_read_b128 v[44:47], v1 offset:4736
    v_mfma_f32_16x16x32_bf16 v[232:235], v[20:23], v[40:43], v[232:235]
    ds_read_b128 v[40:43], v1 offset:4224
    v_mfma_f32_16x16x32_bf16 v[228:231], v[20:23], v[36:39], v[228:231]
    v_mfma_f32_16x16x32_bf16 v[224:227], v[20:23], v[32:35], v[224:227]
    ds_read_b64_tr_b16 v[20:21], v2 offset:96
    v_mfma_f32_16x16x32_bf16 v[208:211], v[16:19], v[32:35], v[208:211]
    ds_read_b64_tr_b16 v[22:23], v2 offset:352
    v_mfma_f32_16x16x32_bf16 v[212:215], v[16:19], v[36:39], v[212:215]
    ds_read_b64_tr_b16 v[16:17], v2 offset:64
    ds_read_b64_tr_b16 v[18:19], v2 offset:320
    s_waitcnt lgkmcnt(6)
    v_mfma_f32_16x16x32_bf16 v[48:51], v[24:27], v[8:11], v[48:51]
    v_mfma_f32_16x16x32_bf16 v[52:55], v[28:31], v[8:11], v[52:55]
    v_mfma_f32_16x16x32_bf16 v[68:71], v[28:31], v[12:15], v[68:71]
    v_mfma_f32_16x16x32_bf16 v[64:67], v[24:27], v[12:15], v[64:67]
    v_xor_b32 v7, v6, v7
    v_readfirstlane_b32 s33, v6
    s_waitcnt lgkmcnt(4)
    v_mfma_f32_16x16x32_bf16 v[72:75], v[40:43], v[12:15], v[72:75]
    v_mov_b32 v6, 1
    s_xor_b32 s59, s59, s33
    v_mfma_f32_16x16x32_bf16 v[76:79], v[44:47], v[12:15], v[76:79]
    ds_read_b64_tr_b16 v[12:13], v2 offset:13696
    s_xor_b32 s60, s60, s33
    v_mfma_f32_16x16x32_bf16 v[60:63], v[44:47], v[8:11], v[60:63]
    ds_read_b64_tr_b16 v[14:15], v2 offset:13952
    v_cvt_pk_bf16_f32 v184, v184, v185
    v_mfma_f32_16x16x32_bf16 v[56:59], v[40:43], v[8:11], v[56:59]
    ds_read_b64_tr_b16 v[8:9], v3 offset:0
    ds_read_b64_tr_b16 v[10:11], v3 offset:256
    s_waitcnt lgkmcnt(4)
    v_mfma_f32_16x16x32_bf16 v[88:91], v[40:43], v[16:19], v[88:91]
    ds_read_b128 v[32:35], v1 offset:64
    v_cvt_pk_bf16_f32 v185, v186, v187
    v_mfma_f32_16x16x32_bf16 v[92:95], v[44:47], v[16:19], v[92:95]
    ds_read_b128 v[36:39], v1 offset:576
    v_cvt_pk_bf16_f32 v186, v200, v201
    v_mfma_f32_16x16x32_bf16 v[80:83], v[24:27], v[16:19], v[80:83]
    v_cvt_pk_bf16_f32 v187, v202, v203
    v_pk_max_i16 v184, v184, 0
    v_mfma_f32_16x16x32_bf16 v[84:87], v[28:31], v[16:19], v[84:87]
    ds_read_b64_tr_b16 v[16:17], v2 offset:13728
    v_pk_max_i16 v185, v185, 0
    v_mfma_f32_16x16x32_bf16 v[104:107], v[40:43], v[20:23], v[104:107]
    ds_read_b64_tr_b16 v[18:19], v2 offset:13984
    v_pk_max_i16 v186, v186, 0
    v_mfma_f32_16x16x32_bf16 v[108:111], v[44:47], v[20:23], v[108:111]
    v_pk_max_i16 v187, v187, 0
    v_cvt_pk_bf16_f32 v216, v216, v217
    s_waitcnt lgkmcnt(4)
    v_mfma_f32_16x16x32_bf16 v[252:255], v[8:11], v[44:47], v[252:255]
    ds_read_b128 v[44:47], v1 offset:4800
    s_add_u32 s56, s55, 16384
    buffer_store_dwordx4 v[184:187], v7, s[20:23], s56 offen offset:0 sc1
    v_mfma_f32_16x16x32_bf16 v[248:251], v[8:11], v[40:43], v[248:251]
    ds_read_b128 v[40:43], v1 offset:4288
    v_cvt_pk_bf16_f32 v217, v218, v219
    v_mfma_f32_16x16x32_bf16 v[244:247], v[8:11], v[28:31], v[244:247]
    v_cvt_pk_bf16_f32 v218, v232, v233
    v_cvt_pk_bf16_f32 v219, v234, v235
    v_mfma_f32_16x16x32_bf16 v[240:243], v[8:11], v[24:27], v[240:243]
    ds_read_b64_tr_b16 v[8:9], v2 offset:13792
    v_pk_max_i16 v216, v216, 0
    v_mfma_f32_16x16x32_bf16 v[96:99], v[24:27], v[20:23], v[96:99]
    ds_read_b64_tr_b16 v[10:11], v2 offset:14048
    v_pk_max_i16 v217, v217, 0
    v_mfma_f32_16x16x32_bf16 v[100:103], v[28:31], v[20:23], v[100:103]
    ds_read_b64_tr_b16 v[20:21], v2 offset:13760
    ds_read_b64_tr_b16 v[22:23], v2 offset:14016
    s_waitcnt lgkmcnt(9)
    v_mfma_f32_16x16x32_bf16 v[48:51], v[32:35], v[12:15], v[48:51]
    v_pk_max_i16 v218, v218, 0
    v_pk_max_i16 v219, v219, 0
    s_waitcnt lgkmcnt(8)
    v_mfma_f32_16x16x32_bf16 v[52:55], v[36:39], v[12:15], v[52:55]
    v_cvt_pk_bf16_f32 v188, v188, v189
    v_cvt_pk_bf16_f32 v189, v190, v191
    s_waitcnt lgkmcnt(6)
    v_mfma_f32_16x16x32_bf16 v[68:71], v[36:39], v[16:19], v[68:71]
    v_cvt_pk_bf16_f32 v190, v204, v205
    v_cvt_pk_bf16_f32 v191, v206, v207
    v_mfma_f32_16x16x32_bf16 v[64:67], v[32:35], v[16:19], v[64:67]
    v_pk_max_i16 v188, v188, 0
    v_pk_max_i16 v189, v189, 0
    s_waitcnt lgkmcnt(4)
    v_mfma_f32_16x16x32_bf16 v[72:75], v[40:43], v[16:19], v[72:75]
    v_pk_max_i16 v190, v190, 0
    v_pk_max_i16 v191, v191, 0
    v_mfma_f32_16x16x32_bf16 v[76:79], v[44:47], v[16:19], v[76:79]
    ds_read_b64_tr_b16 v[16:17], v2 offset:27392
    v_cvt_pk_bf16_f32 v220, v220, v221
    v_mfma_f32_16x16x32_bf16 v[60:63], v[44:47], v[12:15], v[60:63]
    ds_read_b64_tr_b16 v[18:19], v2 offset:27648
    s_add_u32 s56, s55, 16384
    buffer_store_dwordx4 v[216:219], v7, s[20:23], s56 offen offset:2048 sc1
    v_mfma_f32_16x16x32_bf16 v[56:59], v[40:43], v[12:15], v[56:59]
    ds_read_b64_tr_b16 v[12:13], v3 offset:13696
    ds_read_b64_tr_b16 v[14:15], v3 offset:13952
    s_waitcnt lgkmcnt(4)
    v_mfma_f32_16x16x32_bf16 v[88:91], v[40:43], v[20:23], v[88:91]
    ds_read_b128 v[24:27], v5 offset:0
    v_cvt_pk_bf16_f32 v221, v222, v223
    v_mfma_f32_16x16x32_bf16 v[92:95], v[44:47], v[20:23], v[92:95]
    ds_read_b128 v[28:31], v5 offset:512
    v_cvt_pk_bf16_f32 v222, v236, v237
    v_mfma_f32_16x16x32_bf16 v[80:83], v[32:35], v[20:23], v[80:83]
    v_cvt_pk_bf16_f32 v223, v238, v239
    v_pk_max_i16 v220, v220, 0
    v_mfma_f32_16x16x32_bf16 v[84:87], v[36:39], v[20:23], v[84:87]
    ds_read_b64_tr_b16 v[20:21], v2 offset:27424
    v_pk_max_i16 v221, v221, 0
    v_mfma_f32_16x16x32_bf16 v[104:107], v[40:43], v[8:11], v[104:107]
    ds_read_b64_tr_b16 v[22:23], v2 offset:27680
    v_pk_max_i16 v222, v222, 0
    v_mfma_f32_16x16x32_bf16 v[108:111], v[44:47], v[8:11], v[108:111]
    v_pk_max_i16 v223, v223, 0
    v_cvt_pk_bf16_f32 v176, v176, v177
    s_waitcnt lgkmcnt(4)
    v_mfma_f32_16x16x32_bf16 v[252:255], v[12:15], v[44:47], v[252:255]
    ds_read_b128 v[44:47], v5 offset:4736
    v_cvt_pk_bf16_f32 v177, v178, v179
    v_mfma_f32_16x16x32_bf16 v[248:251], v[12:15], v[40:43], v[248:251]
    ds_read_b128 v[40:43], v5 offset:4224
    v_cvt_pk_bf16_f32 v178, v192, v193
    v_mfma_f32_16x16x32_bf16 v[244:247], v[12:15], v[36:39], v[244:247]
    v_cvt_pk_bf16_f32 v179, v194, v195
    v_pk_max_i16 v176, v176, 0
    v_mfma_f32_16x16x32_bf16 v[240:243], v[12:15], v[32:35], v[240:243]
    ds_read_b64_tr_b16 v[12:13], v2 offset:27488
    v_pk_max_i16 v177, v177, 0
    v_mfma_f32_16x16x32_bf16 v[96:99], v[32:35], v[8:11], v[96:99]
    ds_read_b64_tr_b16 v[14:15], v2 offset:27744
    s_add_u32 s56, s55, 20480
    buffer_store_dwordx4 v[188:191], v7, s[20:23], s56 offen offset:0 sc1
    v_mfma_f32_16x16x32_bf16 v[100:103], v[36:39], v[8:11], v[100:103]
    ds_read_b64_tr_b16 v[8:9], v2 offset:27456
    ds_read_b64_tr_b16 v[10:11], v2 offset:27712
    s_waitcnt lgkmcnt(9)
    v_mfma_f32_16x16x32_bf16 v[48:51], v[24:27], v[16:19], v[48:51]
    v_pk_max_i16 v178, v178, 0
    v_pk_max_i16 v179, v179, 0
    s_waitcnt lgkmcnt(8)
    v_mfma_f32_16x16x32_bf16 v[52:55], v[28:31], v[16:19], v[52:55]
    v_cvt_pk_bf16_f32 v208, v208, v209
    v_cvt_pk_bf16_f32 v209, v210, v211
    s_waitcnt lgkmcnt(6)
    v_mfma_f32_16x16x32_bf16 v[68:71], v[28:31], v[20:23], v[68:71]
    v_cvt_pk_bf16_f32 v210, v224, v225
    v_cvt_pk_bf16_f32 v211, v226, v227
    v_mfma_f32_16x16x32_bf16 v[64:67], v[24:27], v[20:23], v[64:67]
    v_pk_max_i16 v208, v208, 0
    v_pk_max_i16 v209, v209, 0
    s_waitcnt lgkmcnt(4)
    v_mfma_f32_16x16x32_bf16 v[72:75], v[40:43], v[20:23], v[72:75]
    v_pk_max_i16 v210, v210, 0
    v_pk_max_i16 v211, v211, 0
    v_mfma_f32_16x16x32_bf16 v[76:79], v[44:47], v[20:23], v[76:79]
    ds_read_b64_tr_b16 v[20:21], v2 offset:41088
    v_cvt_pk_bf16_f32 v180, v180, v181
    v_mfma_f32_16x16x32_bf16 v[60:63], v[44:47], v[16:19], v[60:63]
    ds_read_b64_tr_b16 v[22:23], v2 offset:41344
    v_cvt_pk_bf16_f32 v181, v182, v183
    v_mfma_f32_16x16x32_bf16 v[56:59], v[40:43], v[16:19], v[56:59]
    ds_read_b64_tr_b16 v[16:17], v3 offset:27392
    ds_read_b64_tr_b16 v[18:19], v3 offset:27648
    s_waitcnt lgkmcnt(4)
    v_mfma_f32_16x16x32_bf16 v[88:91], v[40:43], v[8:11], v[88:91]
    ds_read_b128 v[32:35], v5 offset:64
    v_cvt_pk_bf16_f32 v182, v196, v197
    v_mfma_f32_16x16x32_bf16 v[92:95], v[44:47], v[8:11], v[92:95]
    ds_read_b128 v[36:39], v5 offset:576
    v_cvt_pk_bf16_f32 v183, v198, v199
    v_mfma_f32_16x16x32_bf16 v[80:83], v[24:27], v[8:11], v[80:83]
    s_add_u32 s56, s55, 20480
    buffer_store_dwordx4 v[220:223], v7, s[20:23], s56 offen offset:2048 sc1
    v_mfma_f32_16x16x32_bf16 v[84:87], v[28:31], v[8:11], v[84:87]
    ds_read_b64_tr_b16 v[8:9], v2 offset:41120
    v_pk_max_i16 v180, v180, 0
    v_mfma_f32_16x16x32_bf16 v[104:107], v[40:43], v[12:15], v[104:107]
    ds_read_b64_tr_b16 v[10:11], v2 offset:41376
    v_pk_max_i16 v181, v181, 0
    v_mfma_f32_16x16x32_bf16 v[108:111], v[44:47], v[12:15], v[108:111]
    v_pk_max_i16 v182, v182, 0
    v_pk_max_i16 v183, v183, 0
    s_waitcnt lgkmcnt(4)
    v_mfma_f32_16x16x32_bf16 v[252:255], v[16:19], v[44:47], v[252:255]
    ds_read_b128 v[44:47], v5 offset:4800
    v_cvt_pk_bf16_f32 v212, v212, v213
    v_mfma_f32_16x16x32_bf16 v[248:251], v[16:19], v[40:43], v[248:251]
    ds_read_b128 v[40:43], v5 offset:4288
    v_cvt_pk_bf16_f32 v213, v214, v215
    v_mfma_f32_16x16x32_bf16 v[244:247], v[16:19], v[28:31], v[244:247]
    v_cvt_pk_bf16_f32 v214, v228, v229
    v_cvt_pk_bf16_f32 v215, v230, v231
    v_mfma_f32_16x16x32_bf16 v[240:243], v[16:19], v[24:27], v[240:243]
    ds_read_b64_tr_b16 v[16:17], v2 offset:41184
    v_pk_max_i16 v212, v212, 0
    v_mfma_f32_16x16x32_bf16 v[96:99], v[24:27], v[12:15], v[96:99]
    ds_read_b64_tr_b16 v[18:19], v2 offset:41440
    v_pk_max_i16 v213, v213, 0
    v_mfma_f32_16x16x32_bf16 v[100:103], v[28:31], v[12:15], v[100:103]
    ds_read_b64_tr_b16 v[12:13], v2 offset:41152
    ds_read_b64_tr_b16 v[14:15], v2 offset:41408
    s_waitcnt lgkmcnt(9)
    v_mfma_f32_16x16x32_bf16 v[48:51], v[32:35], v[20:23], v[48:51]
    v_pk_max_i16 v214, v214, 0
    v_pk_max_i16 v215, v215, 0
    s_waitcnt lgkmcnt(8)
    v_mfma_f32_16x16x32_bf16 v[52:55], v[36:39], v[20:23], v[52:55]
    s_waitcnt lgkmcnt(6)
    v_mfma_f32_16x16x32_bf16 v[68:71], v[36:39], v[8:11], v[68:71]
    s_add_u32 s56, s55, 0
    buffer_store_dwordx4 v[176:179], v7, s[20:23], s56 offen offset:0 sc1
    v_mfma_f32_16x16x32_bf16 v[64:67], v[32:35], v[8:11], v[64:67]
    s_waitcnt lgkmcnt(4)
    v_mfma_f32_16x16x32_bf16 v[72:75], v[40:43], v[8:11], v[72:75]
    v_mfma_f32_16x16x32_bf16 v[76:79], v[44:47], v[8:11], v[76:79]
    ds_read_b64_tr_b16 v[8:9], v2 offset:4224
    v_mfma_f32_16x16x32_bf16 v[60:63], v[44:47], v[20:23], v[60:63]
    ds_read_b64_tr_b16 v[10:11], v2 offset:4480
    v_mfma_f32_16x16x32_bf16 v[56:59], v[40:43], v[20:23], v[56:59]
    ds_read_b64_tr_b16 v[20:21], v3 offset:41088
    ds_read_b64_tr_b16 v[22:23], v3 offset:41344
    s_waitcnt lgkmcnt(4)
    v_mfma_f32_16x16x32_bf16 v[88:91], v[40:43], v[12:15], v[88:91]
    ds_read_b128 v[24:27], v1 offset:0
    v_mfma_f32_16x16x32_bf16 v[92:95], v[44:47], v[12:15], v[92:95]
    ds_read_b128 v[28:31], v1 offset:512
    v_mfma_f32_16x16x32_bf16 v[80:83], v[32:35], v[12:15], v[80:83]
    v_mfma_f32_16x16x32_bf16 v[84:87], v[36:39], v[12:15], v[84:87]
    ds_read_b64_tr_b16 v[12:13], v2 offset:4256
    v_mfma_f32_16x16x32_bf16 v[104:107], v[40:43], v[16:19], v[104:107]
    ds_read_b64_tr_b16 v[14:15], v2 offset:4512
    v_mfma_f32_16x16x32_bf16 v[108:111], v[44:47], v[16:19], v[108:111]
    s_waitcnt lgkmcnt(4)
    v_mfma_f32_16x16x32_bf16 v[252:255], v[20:23], v[44:47], v[252:255]
    ds_read_b128 v[44:47], v1 offset:4736
    s_add_u32 s56, s55, 0
    buffer_store_dwordx4 v[208:211], v7, s[20:23], s56 offen offset:2048 sc1
    v_mfma_f32_16x16x32_bf16 v[248:251], v[20:23], v[40:43], v[248:251]
    ds_read_b128 v[40:43], v1 offset:4224
    v_mfma_f32_16x16x32_bf16 v[244:247], v[20:23], v[36:39], v[244:247]
    v_mfma_f32_16x16x32_bf16 v[240:243], v[20:23], v[32:35], v[240:243]
    ds_read_b64_tr_b16 v[20:21], v2 offset:4320
    v_mfma_f32_16x16x32_bf16 v[96:99], v[32:35], v[16:19], v[96:99]
    ds_read_b64_tr_b16 v[22:23], v2 offset:4576
    v_mfma_f32_16x16x32_bf16 v[100:103], v[36:39], v[16:19], v[100:103]
    ds_read_b64_tr_b16 v[16:17], v2 offset:4288
    ds_read_b64_tr_b16 v[18:19], v2 offset:4544
    s_waitcnt lgkmcnt(9)
    v_mfma_f32_16x16x32_bf16 v[112:115], v[24:27], v[8:11], v[112:115]
    s_waitcnt lgkmcnt(8)
    v_mfma_f32_16x16x32_bf16 v[116:119], v[28:31], v[8:11], v[116:119]
    s_waitcnt lgkmcnt(6)
    v_mfma_f32_16x16x32_bf16 v[132:135], v[28:31], v[12:15], v[132:135]
    ds_read_b128 v[32:35], v1 offset:64
    v_mfma_f32_16x16x32_bf16 v[128:131], v[24:27], v[12:15], v[128:131]
    ds_read_b128 v[36:39], v1 offset:576
    v_and_b32 v201, 3, v0
    v_mov_b32 v202, 0x3f803f80
    s_waitcnt lgkmcnt(6)
    v_mfma_f32_16x16x32_bf16 v[136:139], v[40:43], v[12:15], v[136:139]
    v_cmp_eq_u32 vcc, 0, v201
    s_nop 1
    v_cndmask_b32 v224, 0, v202, vcc
    v_mov_b32 v225, v224
    v_mov_b32 v226, v224
    v_mfma_f32_16x16x32_bf16 v[140:143], v[44:47], v[12:15], v[140:143]
    ds_read_b64_tr_b16 v[12:13], v2 offset:17952
    v_mov_b32 v227, v224
    v_cmp_eq_u32 vcc, 1, v201
    s_nop 1
    v_cndmask_b32 v228, 0, v202, vcc
    v_mfma_f32_16x16x32_bf16 v[124:127], v[44:47], v[8:11], v[124:127]
    ds_read_b64_tr_b16 v[14:15], v2 offset:18208
    s_add_u32 s56, s55, 4096
    buffer_store_dwordx4 v[180:183], v7, s[20:23], s56 offen offset:0 sc1
    v_mfma_f32_16x16x32_bf16 v[120:123], v[40:43], v[8:11], v[120:123]
    ds_read_b64_tr_b16 v[8:9], v2 offset:17920
    ds_read_b64_tr_b16 v[10:11], v2 offset:18176
    v_mov_b32 v229, v228
    s_waitcnt lgkmcnt(6)
    v_mfma_f32_16x16x32_bf16 v[152:155], v[40:43], v[16:19], v[152:155]
    v_mov_b32 v230, v228
    v_mov_b32 v231, v228
    v_cmp_eq_u32 vcc, 2, v201
    s_nop 1
    v_cndmask_b32 v232, 0, v202, vcc
    v_mfma_f32_16x16x32_bf16 v[156:159], v[44:47], v[16:19], v[156:159]
    v_mov_b32 v233, v232
    v_mov_b32 v234, v232
    v_mov_b32 v235, v232
    v_mfma_f32_16x16x32_bf16 v[172:175], v[44:47], v[20:23], v[172:175]
    ds_read_b128 v[44:47], v1 offset:4800
    v_cmp_eq_u32 vcc, 3, v201
    s_nop 1
    v_cndmask_b32 v236, 0, v202, vcc
    v_mov_b32 v237, v236
    v_mfma_f32_16x16x32_bf16 v[168:171], v[40:43], v[20:23], v[168:171]
    ds_read_b128 v[40:43], v1 offset:4288
    v_mov_b32 v238, v236
    v_mov_b32 v239, v236
    v_mfma_f32_16x16x32_bf16 v[164:167], v[28:31], v[20:23], v[164:167]
    v_bfe_u32 v3, v0, 4, 1
    v_mul_u32_u24 v3, 3584, v3
    v_lshrrev_b32 v200, 5, v0
    v_mfma_f32_16x16x32_bf16 v[160:163], v[24:27], v[20:23], v[160:163]
    ds_read_b64_tr_b16 v[20:21], v2 offset:18016
    v_lshlrev_b32 v200, 9, v200
    v_sub_u32 v3, v3, v200
    v_mfma_f32_16x16x32_bf16 v[144:147], v[24:27], v[16:19], v[144:147]
    ds_read_b64_tr_b16 v[22:23], v2 offset:18272
    v_add_u32 v3, v3, v7
    v_cvt_pk_bf16_f32 v248, v248, v249
    v_mfma_f32_16x16x32_bf16 v[148:151], v[28:31], v[16:19], v[148:151]
    ds_read_b64_tr_b16 v[16:17], v2 offset:17984
    ds_read_b64_tr_b16 v[18:19], v2 offset:18240
    v_cvt_pk_bf16_f32 v249, v250, v251
    s_waitcnt lgkmcnt(6)
    v_mfma_f32_16x16x32_bf16 v[112:115], v[32:35], v[8:11], v[112:115]
    v_cvt_pk_bf16_f32 v250, v252, v253
    v_cvt_pk_bf16_f32 v251, v254, v255
    v_pk_max_i16 v248, v248, 0
    v_mfma_f32_16x16x32_bf16 v[116:119], v[36:39], v[8:11], v[116:119]
    v_pk_max_i16 v249, v249, 0
    v_pk_max_i16 v250, v250, 0
    v_pk_max_i16 v251, v251, 0
    v_mfma_f32_16x16x32_bf16 v[132:135], v[36:39], v[12:15], v[132:135]
    ds_read_b128 v[24:27], v5 offset:0
    s_add_u32 s56, s55, 4096
    buffer_store_dwordx4 v[212:215], v7, s[20:23], s56 offen offset:2048 sc1
    v_mfma_f32_16x16x32_bf16 v[128:131], v[32:35], v[12:15], v[128:131]
    ds_read_b128 v[28:31], v5 offset:512
    v_cvt_pk_bf16_f32 v240, v240, v241
    v_cvt_pk_bf16_f32 v241, v242, v243
    s_waitcnt lgkmcnt(6)
    v_mfma_f32_16x16x32_bf16 v[136:139], v[40:43], v[12:15], v[136:139]
    v_cvt_pk_bf16_f32 v242, v244, v245
    v_cvt_pk_bf16_f32 v243, v246, v247
    v_pk_max_i16 v240, v240, 0
    v_mfma_f32_16x16x32_bf16 v[140:143], v[44:47], v[12:15], v[140:143]
    ds_read_b64_tr_b16 v[12:13], v2 offset:31648
    v_pk_max_i16 v241, v241, 0
    v_pk_max_i16 v242, v242, 0
    v_mfma_f32_16x16x32_bf16 v[124:127], v[44:47], v[8:11], v[124:127]
    ds_read_b64_tr_b16 v[14:15], v2 offset:31904
    v_pk_max_i16 v243, v243, 0
    s_nop 1
    v_permlane16_swap_b32 v248, v250
    v_mfma_f32_16x16x32_bf16 v[120:123], v[40:43], v[8:11], v[120:123]
    ds_read_b64_tr_b16 v[8:9], v2 offset:31616
    ds_read_b64_tr_b16 v[10:11], v2 offset:31872
    v_permlane16_swap_b32 v249, v251
    s_waitcnt lgkmcnt(6)
    v_mfma_f32_16x16x32_bf16 v[152:155], v[40:43], v[16:19], v[152:155]
    buffer_store_dwordx4 v[248:251], v3, s[20:23], s67 offen sc1
    s_nop 1
    v_permlane16_swap_b32 v240, v242
    v_permlane16_swap_b32 v241, v243
    v_mfma_f32_16x16x32_bf16 v[156:159], v[44:47], v[16:19], v[156:159]
    buffer_store_dwordx4 v[240:243], v3, s[20:23], s66 offen sc1
    v_mul_f32 v192, s50, v48
    v_mul_f32 v193, s50, v49
    v_mfma_f32_16x16x32_bf16 v[172:175], v[44:47], v[20:23], v[172:175]
    ds_read_b128 v[44:47], v5 offset:4736
    v_mul_f32 v194, s50, v50
    v_mul_f32 v195, s50, v51
    v_mfma_f32_16x16x32_bf16 v[168:171], v[40:43], v[20:23], v[168:171]
    ds_read_b128 v[40:43], v5 offset:4224
    v_mul_f32 v196, s50, v52
    v_mul_f32 v197, s50, v53
    v_mfma_f32_16x16x32_bf16 v[164:167], v[36:39], v[20:23], v[164:167]
    v_mul_f32 v198, s50, v54
    v_mul_f32 v199, s50, v55
    v_exp_f32 v192, v192 clamp
    v_mfma_f32_16x16x32_bf16 v[160:163], v[32:35], v[20:23], v[160:163]
    s_barrier
    ds_read_b64_tr_b16 v[20:21], v2 offset:31712
    v_max_f32 v48, s51, v48
    v_mfma_f32_16x16x32_bf16 v[144:147], v[32:35], v[16:19], v[144:147]
    ds_read_b64_tr_b16 v[22:23], v2 offset:31968
    v_exp_f32 v193, v193 clamp
    v_mfma_f32_16x16x32_bf16 v[148:151], v[36:39], v[16:19], v[148:151]
    ds_read_b64_tr_b16 v[16:17], v2 offset:31680
    ds_read_b64_tr_b16 v[18:19], v2 offset:31936
    v_max_f32 v49, s51, v49
    s_waitcnt lgkmcnt(6)
    v_mfma_f32_16x16x32_bf16 v[112:115], v[24:27], v[8:11], v[112:115]
    v_exp_f32 v194, v194 clamp
    v_max_f32 v50, s51, v50
    v_mfma_f32_16x16x32_bf16 v[116:119], v[28:31], v[8:11], v[116:119]
    v_exp_f32 v195, v195 clamp
    v_max_f32 v51, s51, v51
    v_mfma_f32_16x16x32_bf16 v[132:135], v[28:31], v[12:15], v[132:135]
    ds_read_b128 v[32:35], v5 offset:64
    v_exp_f32 v196, v196 clamp
    v_mfma_f32_16x16x32_bf16 v[128:131], v[24:27], v[12:15], v[128:131]
    ds_read_b128 v[36:39], v5 offset:576
    v_max_f32 v52, s51, v52
    v_exp_f32 v197, v197 clamp
    s_waitcnt lgkmcnt(6)
    v_mfma_f32_16x16x32_bf16 v[136:139], v[40:43], v[12:15], v[136:139]
    v_max_f32 v53, s51, v53
    v_exp_f32 v198, v198 clamp
    v_mfma_f32_16x16x32_bf16 v[140:143], v[44:47], v[12:15], v[140:143]
    ds_read_b64_tr_b16 v[12:13], v2 offset:45344
    v_max_f32 v54, s51, v54
    v_exp_f32 v199, v199 clamp
    v_mfma_f32_16x16x32_bf16 v[124:127], v[44:47], v[8:11], v[124:127]
    ds_read_b64_tr_b16 v[14:15], v2 offset:45600
    v_max_f32 v55, s51, v55
    v_add_f32 v48, v48, v192
    v_mfma_f32_16x16x32_bf16 v[120:123], v[40:43], v[8:11], v[120:123]
    ds_read_b64_tr_b16 v[8:9], v2 offset:45312
    ds_read_b64_tr_b16 v[10:11], v2 offset:45568
    v_add_f32 v49, v49, v193
    s_waitcnt lgkmcnt(6)
    v_mfma_f32_16x16x32_bf16 v[152:155], v[40:43], v[16:19], v[152:155]
    v_add_f32 v50, v50, v194
    v_add_f32 v51, v51, v195
    v_add_f32 v52, v52, v196
    v_mfma_f32_16x16x32_bf16 v[156:159], v[44:47], v[16:19], v[156:159]
    v_add_f32 v53, v53, v197
    v_add_f32 v54, v54, v198
    v_add_f32 v55, v55, v199
    v_mfma_f32_16x16x32_bf16 v[172:175], v[44:47], v[20:23], v[172:175]
    ds_read_b128 v[44:47], v5 offset:4800
    v_cvt_pk_bf16_f32 v48, v48, v49
    v_cvt_pk_bf16_f32 v49, v50, v51
    v_mfma_f32_16x16x32_bf16 v[168:171], v[40:43], v[20:23], v[168:171]
    ds_read_b128 v[40:43], v5 offset:4288
    v_cvt_pk_bf16_f32 v50, v52, v53
    v_cvt_pk_bf16_f32 v51, v54, v55
    v_mfma_f32_16x16x32_bf16 v[164:167], v[28:31], v[20:23], v[164:167]
    v_mul_f32 v192, s50, v56
    v_mul_f32 v193, s50, v57
    v_mul_f32 v194, s50, v58
    v_mfma_f32_16x16x32_bf16 v[160:163], v[24:27], v[20:23], v[160:163]
    ds_read_b64_tr_b16 v[20:21], v2 offset:45408
    v_mul_f32 v195, s50, v59
    v_mul_f32 v196, s50, v60
    v_mfma_f32_16x16x32_bf16 v[144:147], v[24:27], v[16:19], v[144:147]
    ds_read_b64_tr_b16 v[22:23], v2 offset:45664
    v_mul_f32 v197, s50, v61
    v_mul_f32 v198, s50, v62
    v_mfma_f32_16x16x32_bf16 v[148:151], v[28:31], v[16:19], v[148:151]
    ds_read_b64_tr_b16 v[16:17], v2 offset:45376
    ds_read_b64_tr_b16 v[18:19], v2 offset:45632
    v_mul_f32 v199, s50, v63
    s_waitcnt lgkmcnt(6)
    v_mfma_f32_16x16x32_bf16 v[112:115], v[32:35], v[8:11], v[112:115]
    v_exp_f32 v192, v192 clamp
    v_max_f32 v56, s51, v56
    v_mfma_f32_16x16x32_bf16 v[116:119], v[36:39], v[8:11], v[116:119]
    v_exp_f32 v193, v193 clamp
    v_max_f32 v57, s51, v57
    v_mfma_f32_16x16x32_bf16 v[132:135], v[36:39], v[12:15], v[132:135]
    s_waitcnt vmcnt(0)
    s_mov_b64 exec, 1
    buffer_store_dword v6, off, s[20:23], s59 sc1
    buffer_store_dword v6, off, s[20:23], s60 sc1
    s_mov_b64 exec, -1
    v_exp_f32 v194, v194 clamp
    v_mfma_f32_16x16x32_bf16 v[128:131], v[32:35], v[12:15], v[128:131]
    v_max_f32 v58, s51, v58
    v_exp_f32 v195, v195 clamp
    s_waitcnt lgkmcnt(4)
    v_mfma_f32_16x16x32_bf16 v[136:139], v[40:43], v[12:15], v[136:139]
    v_max_f32 v59, s51, v59
    v_exp_f32 v196, v196 clamp
    v_mfma_f32_16x16x32_bf16 v[140:143], v[44:47], v[12:15], v[140:143]
    v_max_f32 v60, s51, v60
    v_exp_f32 v197, v197 clamp
    v_mfma_f32_16x16x32_bf16 v[124:127], v[44:47], v[8:11], v[124:127]
    v_max_f32 v61, s51, v61
    v_exp_f32 v198, v198 clamp
    v_mfma_f32_16x16x32_bf16 v[120:123], v[40:43], v[8:11], v[120:123]
    v_max_f32 v62, s51, v62
    v_exp_f32 v199, v199 clamp
    s_waitcnt lgkmcnt(0)
    v_mfma_f32_16x16x32_bf16 v[152:155], v[40:43], v[16:19], v[152:155]
    v_max_f32 v63, s51, v63
    v_add_f32 v56, v56, v192
    v_add_f32 v57, v57, v193
    v_mfma_f32_16x16x32_bf16 v[156:159], v[44:47], v[16:19], v[156:159]
    v_add_f32 v58, v58, v194
    v_add_f32 v59, v59, v195
    v_add_f32 v60, v60, v196
    v_mfma_f32_16x16x32_bf16 v[172:175], v[44:47], v[20:23], v[172:175]
    v_add_f32 v61, v61, v197
    v_add_f32 v62, v62, v198
    v_add_f32 v63, v63, v199
    v_mfma_f32_16x16x32_bf16 v[168:171], v[40:43], v[20:23], v[168:171]
    s_barrier
    v_cvt_pk_bf16_f32 v56, v56, v57
    v_cvt_pk_bf16_f32 v57, v58, v59
    v_mfma_f32_16x16x32_bf16 v[164:167], v[36:39], v[20:23], v[164:167]
    v_cvt_pk_bf16_f32 v58, v60, v61
    v_cvt_pk_bf16_f32 v59, v62, v63
    v_pk_mul_f32 v[192:193], v[64:65], s[50:51] op_sel_hi:[1,0]
    v_mfma_f32_16x16x32_bf16 v[160:163], v[32:35], v[20:23], v[160:163]
    v_pk_mul_f32 v[194:195], v[66:67], s[50:51] op_sel_hi:[1,0]
    v_pk_mul_f32 v[196:197], v[68:69], s[50:51] op_sel_hi:[1,0]
    v_pk_mul_f32 v[198:199], v[70:71], s[50:51] op_sel_hi:[1,0]
    v_mfma_f32_16x16x32_bf16 v[144:147], v[32:35], v[16:19], v[144:147]
    v_exp_f32 v192, v192 clamp
    v_max_f32 v64, s51, v64
    v_mfma_f32_16x16x32_bf16 v[148:151], v[36:39], v[16:19], v[148:151]
    v_exp_f32 v193, v193 clamp
    v_max_f32 v65, s51, v65
    v_exp_f32 v194, v194 clamp
    v_max_f32 v66, s51, v66
    v_exp_f32 v195, v195 clamp
    v_max_f32 v67, s51, v67
    v_exp_f32 v196, v196 clamp
    v_max_f32 v68, s51, v68
    v_exp_f32 v197, v197 clamp
    v_max_f32 v69, s51, v69
    v_exp_f32 v198, v198 clamp
    v_max_f32 v70, s51, v70
    v_exp_f32 v199, v199 clamp
    v_max_f32 v71, s51, v71
    v_pk_add_f32 v[64:65], v[64:65], v[192:193]
    v_pk_add_f32 v[66:67], v[66:67], v[194:195]
    v_pk_add_f32 v[68:69], v[68:69], v[196:197]
    v_pk_add_f32 v[70:71], v[70:71], v[198:199]
    v_cvt_pk_bf16_f32 v64, v64, v65
    v_cvt_pk_bf16_f32 v65, v66, v67
    v_cvt_pk_bf16_f32 v66, v68, v69
    v_cvt_pk_bf16_f32 v67, v70, v71
    v_pk_mul_f32 v[192:193], v[72:73], s[50:51] op_sel_hi:[1,0]
    v_pk_mul_f32 v[194:195], v[74:75], s[50:51] op_sel_hi:[1,0]
    v_pk_mul_f32 v[196:197], v[76:77], s[50:51] op_sel_hi:[1,0]
    v_pk_mul_f32 v[198:199], v[78:79], s[50:51] op_sel_hi:[1,0]
    v_exp_f32 v192, v192 clamp
    v_max_f32 v72, s51, v72
    v_exp_f32 v193, v193 clamp
    v_max_f32 v73, s51, v73
    v_exp_f32 v194, v194 clamp
    v_max_f32 v74, s51, v74
    v_exp_f32 v195, v195 clamp
    v_max_f32 v75, s51, v75
    v_exp_f32 v196, v196 clamp
    v_max_f32 v76, s51, v76
    v_exp_f32 v197, v197 clamp
    v_max_f32 v77, s51, v77
    v_exp_f32 v198, v198 clamp
    v_max_f32 v78, s51, v78
    v_exp_f32 v199, v199 clamp
    v_max_f32 v79, s51, v79
    v_pk_add_f32 v[72:73], v[72:73], v[192:193]
    v_pk_add_f32 v[74:75], v[74:75], v[194:195]
    v_pk_add_f32 v[76:77], v[76:77], v[196:197]
    v_pk_add_f32 v[78:79], v[78:79], v[198:199]
    v_cvt_pk_bf16_f32 v72, v72, v73
    v_cvt_pk_bf16_f32 v73, v74, v75
    v_cvt_pk_bf16_f32 v74, v76, v77
    v_cvt_pk_bf16_f32 v75, v78, v79
    s_cmp_lg_u32 s40, 0
    s_cbranch_scc1 L_mv_82
    v_mov_b64 v[24:25], v[176:177]
    v_mov_b64 v[26:27], v[178:179]
    v_mov_b64 v[28:29], v[180:181]
    v_mov_b64 v[30:31], v[182:183]
    v_mov_b64 v[32:33], v[184:185]
    v_mov_b64 v[34:35], v[186:187]
    v_mov_b64 v[36:37], v[188:189]
    v_mov_b64 v[38:39], v[190:191]
    s_branch L_mv_83
L_mv_82:
    v_mov_b64 v[24:25], v[184:185]
    v_mov_b64 v[26:27], v[186:187]
    v_mov_b64 v[28:29], v[188:189]
    v_mov_b64 v[30:31], v[190:191]
    v_mov_b64 v[32:33], v[176:177]
    v_mov_b64 v[34:35], v[178:179]
    v_mov_b64 v[36:37], v[180:181]
    v_mov_b64 v[38:39], v[182:183]
L_mv_83:
    v_cvt_pk_bf16_f32 v120, v120, v121
    v_cvt_pk_bf16_f32 v121, v122, v123
    v_cvt_pk_bf16_f32 v122, v124, v125
    v_cvt_pk_bf16_f32 v123, v126, v127
    v_cvt_pk_bf16_f32 v112, v112, v113
    v_cvt_pk_bf16_f32 v113, v114, v115
    v_cvt_pk_bf16_f32 v114, v116, v117
    v_cvt_pk_bf16_f32 v115, v118, v119
    v_cvt_pk_bf16_f32 v136, v136, v137
    v_cvt_pk_bf16_f32 v137, v138, v139
    v_cvt_pk_bf16_f32 v138, v140, v141
    v_cvt_pk_bf16_f32 v139, v142, v143
    v_cvt_pk_bf16_f32 v128, v128, v129
    v_cvt_pk_bf16_f32 v129, v130, v131
    v_cvt_pk_bf16_f32 v130, v132, v133
    v_cvt_pk_bf16_f32 v131, v134, v135
    v_cvt_pk_bf16_f32 v152, v152, v153
    v_cvt_pk_bf16_f32 v153, v154, v155
    v_cvt_pk_bf16_f32 v154, v156, v157
    v_cvt_pk_bf16_f32 v155, v158, v159
    v_cvt_pk_bf16_f32 v144, v144, v145
    v_cvt_pk_bf16_f32 v145, v146, v147
    v_cvt_pk_bf16_f32 v146, v148, v149
    v_cvt_pk_bf16_f32 v147, v150, v151
    v_cvt_pk_bf16_f32 v168, v168, v169
    v_cvt_pk_bf16_f32 v169, v170, v171
    v_cvt_pk_bf16_f32 v170, v172, v173
    v_cvt_pk_bf16_f32 v171, v174, v175
    v_cvt_pk_bf16_f32 v160, v160, v161
    v_cvt_pk_bf16_f32 v161, v162, v163
    v_cvt_pk_bf16_f32 v162, v164, v165
    v_cvt_pk_bf16_f32 v163, v166, v167
    v_add_u32 v5, s16, v4
    v_mfma_f32_16x16x32_bf16 v[176:179], v[48:51], v[112:115], 0
    v_pk_mul_f32 v[192:193], v[80:81], s[50:51] op_sel_hi:[1,0]
    v_pk_mul_f32 v[194:195], v[82:83], s[50:51] op_sel_hi:[1,0]
    v_pk_mul_f32 v[196:197], v[84:85], s[50:51] op_sel_hi:[1,0]
    v_mfma_f32_16x16x32_bf16 v[184:187], v[48:51], v[128:131], 0
    v_pk_mul_f32 v[198:199], v[86:87], s[50:51] op_sel_hi:[1,0]
    v_exp_f32 v192, v192 clamp
    v_max_f32 v80, s51, v80
    v_mfma_f32_16x16x32_bf16 v[204:207], v[48:51], v[224:227], 0
    v_exp_f32 v193, v193 clamp
    v_max_f32 v81, s51, v81
    v_exp_f32 v194, v194 clamp
    v_mfma_f32_16x16x32_bf16 v[180:183], v[64:67], v[112:115], 0
    v_max_f32 v82, s51, v82
    v_exp_f32 v195, v195 clamp
    v_max_f32 v83, s51, v83
    v_mfma_f32_16x16x32_bf16 v[188:191], v[64:67], v[128:131], 0
    v_exp_f32 v196, v196 clamp
    v_max_f32 v84, s51, v84
    v_exp_f32 v197, v197 clamp
    v_mfma_f32_16x16x32_bf16 v[204:207], v[64:67], v[228:231], v[204:207]
    v_max_f32 v85, s51, v85
    v_exp_f32 v198, v198 clamp
    v_max_f32 v86, s51, v86
    v_mfma_f32_16x16x32_bf16 v[176:179], v[56:59], v[120:123], v[176:179]
    v_exp_f32 v199, v199 clamp
    v_max_f32 v87, s51, v87
    v_pk_add_f32 v[80:81], v[80:81], v[192:193]
    v_mfma_f32_16x16x32_bf16 v[184:187], v[56:59], v[136:139], v[184:187]
    v_pk_add_f32 v[82:83], v[82:83], v[194:195]
    v_pk_add_f32 v[84:85], v[84:85], v[196:197]
    v_pk_add_f32 v[86:87], v[86:87], v[198:199]
    v_mfma_f32_16x16x32_bf16 v[204:207], v[56:59], v[224:227], v[204:207]
    v_cvt_pk_bf16_f32 v80, v80, v81
    v_cvt_pk_bf16_f32 v81, v82, v83
    v_cvt_pk_bf16_f32 v82, v84, v85
    v_mfma_f32_16x16x32_bf16 v[180:183], v[72:75], v[120:123], v[180:183]
    v_cvt_pk_bf16_f32 v83, v86, v87
    v_pk_mul_f32 v[192:193], v[96:97], s[50:51] op_sel_hi:[1,0]
    v_pk_mul_f32 v[194:195], v[98:99], s[50:51] op_sel_hi:[1,0]
    v_mfma_f32_16x16x32_bf16 v[188:191], v[72:75], v[136:139], v[188:191]
    v_pk_mul_f32 v[196:197], v[100:101], s[50:51] op_sel_hi:[1,0]
    v_pk_mul_f32 v[198:199], v[102:103], s[50:51] op_sel_hi:[1,0]
    v_exp_f32 v192, v192 clamp
    v_mfma_f32_16x16x32_bf16 v[204:207], v[72:75], v[228:231], v[204:207]
    v_max_f32 v96, s51, v96
    v_exp_f32 v193, v193 clamp
    v_max_f32 v97, s51, v97
    v_exp_f32 v194, v194 clamp
    v_max_f32 v98, s51, v98
    v_exp_f32 v195, v195 clamp
    v_max_f32 v99, s51, v99
    v_exp_f32 v196, v196 clamp
    v_max_f32 v100, s51, v100
    v_exp_f32 v197, v197 clamp
    ds_write_b128 v5, v[176:179] offset:0
    v_max_f32 v101, s51, v101
    v_exp_f32 v198, v198 clamp
    v_max_f32 v102, s51, v102
    v_exp_f32 v199, v199 clamp
    ds_write_b128 v5, v[180:183] offset:1024
    v_max_f32 v103, s51, v103
    v_pk_add_f32 v[96:97], v[96:97], v[192:193]
    v_pk_add_f32 v[98:99], v[98:99], v[194:195]
    v_pk_add_f32 v[100:101], v[100:101], v[196:197]
    ds_write_b128 v5, v[184:187] offset:2048
    v_pk_add_f32 v[102:103], v[102:103], v[198:199]
    v_cvt_pk_bf16_f32 v96, v96, v97
    v_cvt_pk_bf16_f32 v97, v98, v99
    v_cvt_pk_bf16_f32 v98, v100, v101
    ds_write_b128 v5, v[188:191] offset:3072
    v_cvt_pk_bf16_f32 v99, v102, v103
    v_pk_mul_f32 v[192:193], v[88:89], s[50:51] op_sel_hi:[1,0]
    v_pk_mul_f32 v[194:195], v[90:91], s[50:51] op_sel_hi:[1,0]
    v_pk_mul_f32 v[196:197], v[92:93], s[50:51] op_sel_hi:[1,0]
    v_mfma_f32_16x16x32_bf16 v[240:243], v[80:83], v[144:147], 0
    v_pk_mul_f32 v[198:199], v[94:95], s[50:51] op_sel_hi:[1,0]
    v_exp_f32 v192, v192 clamp
    v_max_f32 v88, s51, v88
    v_mfma_f32_16x16x32_bf16 v[248:251], v[80:83], v[160:163], 0
    v_exp_f32 v193, v193 clamp
    v_max_f32 v89, s51, v89
    v_exp_f32 v194, v194 clamp
    v_mfma_f32_16x16x32_bf16 v[204:207], v[80:83], v[232:235], v[204:207]
    v_max_f32 v90, s51, v90
    v_exp_f32 v195, v195 clamp
    v_max_f32 v91, s51, v91
    v_mfma_f32_16x16x32_bf16 v[244:247], v[96:99], v[144:147], 0
    v_exp_f32 v196, v196 clamp
    v_max_f32 v92, s51, v92
    v_exp_f32 v197, v197 clamp
    v_mfma_f32_16x16x32_bf16 v[252:255], v[96:99], v[160:163], 0
    v_max_f32 v93, s51, v93
    v_exp_f32 v198, v198 clamp
    v_max_f32 v94, s51, v94
    v_mfma_f32_16x16x32_bf16 v[204:207], v[96:99], v[236:239], v[204:207]
    v_exp_f32 v199, v199 clamp
    v_max_f32 v95, s51, v95
    v_pk_add_f32 v[88:89], v[88:89], v[192:193]
    v_pk_add_f32 v[90:91], v[90:91], v[194:195]
    v_pk_add_f32 v[92:93], v[92:93], v[196:197]
    v_pk_add_f32 v[94:95], v[94:95], v[198:199]
    v_cvt_pk_bf16_f32 v88, v88, v89
    v_cvt_pk_bf16_f32 v89, v90, v91
    v_cvt_pk_bf16_f32 v90, v92, v93
    v_cvt_pk_bf16_f32 v91, v94, v95
    v_pk_mul_f32 v[192:193], v[104:105], s[50:51] op_sel_hi:[1,0]
    v_pk_mul_f32 v[194:195], v[106:107], s[50:51] op_sel_hi:[1,0]
    v_pk_mul_f32 v[196:197], v[108:109], s[50:51] op_sel_hi:[1,0]
    v_mfma_f32_16x16x32_bf16 v[240:243], v[88:91], v[152:155], v[240:243]
    v_pk_mul_f32 v[198:199], v[110:111], s[50:51] op_sel_hi:[1,0]
    v_exp_f32 v192, v192 clamp
    v_max_f32 v104, s51, v104
    v_mfma_f32_16x16x32_bf16 v[248:251], v[88:91], v[168:171], v[248:251]
    v_exp_f32 v193, v193 clamp
    v_max_f32 v105, s51, v105
    v_exp_f32 v194, v194 clamp
    v_mfma_f32_16x16x32_bf16 v[204:207], v[88:91], v[232:235], v[204:207]
    v_max_f32 v106, s51, v106
    v_exp_f32 v195, v195 clamp
    v_max_f32 v107, s51, v107
    v_exp_f32 v196, v196 clamp
    v_max_f32 v108, s51, v108
    v_exp_f32 v197, v197 clamp
    v_max_f32 v109, s51, v109
    v_exp_f32 v198, v198 clamp
    v_max_f32 v110, s51, v110
    v_exp_f32 v199, v199 clamp
    v_max_f32 v111, s51, v111
    v_pk_add_f32 v[104:105], v[104:105], v[192:193]
    v_pk_add_f32 v[106:107], v[106:107], v[194:195]
    v_pk_add_f32 v[108:109], v[108:109], v[196:197]
    v_pk_add_f32 v[110:111], v[110:111], v[198:199]
    v_cvt_pk_bf16_f32 v104, v104, v105
    v_cvt_pk_bf16_f32 v105, v106, v107
    v_cvt_pk_bf16_f32 v106, v108, v109
    v_cvt_pk_bf16_f32 v107, v110, v111
    s_nop 1
    v_mfma_f32_16x16x32_bf16 v[244:247], v[104:107], v[152:155], v[244:247]
    v_mfma_f32_16x16x32_bf16 v[252:255], v[104:107], v[168:171], v[252:255]
    v_mfma_f32_16x16x32_bf16 v[204:207], v[104:107], v[236:239], v[204:207]
    s_cmp_lg_u32 s40, 0
    s_cbranch_scc1 L_mv_84
    v_mov_b64 v[112:113], v[208:209]
    v_mov_b64 v[114:115], v[210:211]
    v_mov_b64 v[116:117], v[212:213]
    v_mov_b64 v[118:119], v[214:215]
    v_mov_b64 v[120:121], v[216:217]
    v_mov_b64 v[122:123], v[218:219]
    v_mov_b64 v[124:125], v[220:221]
    v_mov_b64 v[126:127], v[222:223]
    s_branch L_mv_85
L_mv_84:
    v_mov_b64 v[112:113], v[216:217]
    v_mov_b64 v[114:115], v[218:219]
    v_mov_b64 v[116:117], v[220:221]
    v_mov_b64 v[118:119], v[222:223]
    v_mov_b64 v[120:121], v[208:209]
    v_mov_b64 v[122:123], v[210:211]
    v_mov_b64 v[124:125], v[212:213]
    v_mov_b64 v[126:127], v[214:215]
L_mv_85:
    v_add_u32 v1, s6, v7
    v_add_u32 v3, s7, v7
    s_mov_b32 s46, s8
    s_mov_b32 s45, s9
    v_add_u32 v2, 4294899712, v2
    v_add_u32 v88, s17, v4
    s_nop 0
    ds_write_b128 v5, v[240:243] offset:4096
    ds_write_b128 v5, v[248:251] offset:6144
    ds_write_b128 v5, v[244:247] offset:5120
    ds_write_b128 v5, v[252:255] offset:7168
    ds_write_b128 v88, v[204:207]
    s_waitcnt lgkmcnt(0)
    s_barrier
    ds_read_b64_tr_b16 v[8:9], v2 offset:8448
    ds_read_b64_tr_b16 v[10:11], v2 offset:8704
    ds_read_b64_tr_b16 v[12:13], v2 offset:8480
    ds_read_b64_tr_b16 v[14:15], v2 offset:8736
    ds_read_b64_tr_b16 v[16:17], v2 offset:8512
    ds_read_b64_tr_b16 v[18:19], v2 offset:8768
    s_waitcnt lgkmcnt(4)
    v_mfma_f32_16x16x32_bf16 v[192:195], v[8:11], v[24:27], 0
    ds_read_b64_tr_b16 v[20:21], v2 offset:8544
    s_bfe_u32 s54, s4, 0x40004
    v_mfma_f32_16x16x32_bf16 v[196:199], v[8:11], v[28:31], 0
    ds_read_b64_tr_b16 v[22:23], v2 offset:8800
    s_lshl_b32 s54, s54, 17
    v_mfma_f32_16x16x32_bf16 v[200:203], v[8:11], v[32:35], 0
    s_add_u32 s54, s54, s46
    v_mfma_f32_16x16x32_bf16 v[204:207], v[8:11], v[36:39], 0
    s_add_u32 s53, s54, 4096
    s_waitcnt lgkmcnt(4)
    v_mfma_f32_16x16x32_bf16 v[220:223], v[12:15], v[36:39], 0
    ds_read_b64_tr_b16 v[8:9], v2 offset:0
    v_mfma_f32_16x16x32_bf16 v[216:219], v[12:15], v[32:35], 0
    ds_read_b64_tr_b16 v[10:11], v2 offset:256
    buffer_load_dwordx4 v[96:99], v1, s[20:23], s54 offen offset:0 sc1
    v_mfma_f32_16x16x32_bf16 v[212:215], v[12:15], v[28:31], 0
    buffer_load_dwordx4 v[100:103], v1, s[20:23], s53 offen offset:0 sc1
    v_mfma_f32_16x16x32_bf16 v[208:211], v[12:15], v[24:27], 0
    s_waitcnt lgkmcnt(4)
    v_mfma_f32_16x16x32_bf16 v[224:227], v[16:19], v[24:27], 0
    ds_read_b64_tr_b16 v[12:13], v2 offset:32
    v_mfma_f32_16x16x32_bf16 v[228:231], v[16:19], v[28:31], 0
    ds_read_b64_tr_b16 v[14:15], v2 offset:288
    buffer_load_dwordx4 v[104:107], v3, s[20:23], s54 offen offset:0 sc1
    v_mfma_f32_16x16x32_bf16 v[232:235], v[16:19], v[32:35], 0
    buffer_load_dwordx4 v[108:111], v3, s[20:23], s53 offen offset:0 sc1
    v_mfma_f32_16x16x32_bf16 v[236:239], v[16:19], v[36:39], 0
    s_waitcnt lgkmcnt(4)
    v_mfma_f32_16x16x32_bf16 v[252:255], v[20:23], v[36:39], 0
    ds_read_b64_tr_b16 v[16:17], v2 offset:64
    v_mfma_f32_16x16x32_bf16 v[248:251], v[20:23], v[32:35], 0
    ds_read_b64_tr_b16 v[18:19], v2 offset:320
    buffer_load_dwordx4 v[72:75], v1, s[20:23], s54 offen offset:2048 sc1
    v_mfma_f32_16x16x32_bf16 v[244:247], v[20:23], v[28:31], 0
    buffer_load_dwordx4 v[76:79], v1, s[20:23], s53 offen offset:2048 sc1
    v_mfma_f32_16x16x32_bf16 v[240:243], v[20:23], v[24:27], 0
    s_waitcnt lgkmcnt(4)
    v_mfma_f32_16x16x32_bf16 v[128:131], v[8:11], v[24:27], 0
    ds_read_b64_tr_b16 v[20:21], v2 offset:96
    v_mfma_f32_16x16x32_bf16 v[132:135], v[8:11], v[28:31], 0
    ds_read_b64_tr_b16 v[22:23], v2 offset:352
    buffer_load_dwordx4 v[80:83], v3, s[20:23], s54 offen offset:2048 sc1
    v_mfma_f32_16x16x32_bf16 v[136:139], v[8:11], v[32:35], 0
    buffer_load_dwordx4 v[84:87], v3, s[20:23], s53 offen offset:2048 sc1
    v_mfma_f32_16x16x32_bf16 v[140:143], v[8:11], v[36:39], 0
    s_waitcnt lgkmcnt(4)
    v_mfma_f32_16x16x32_bf16 v[156:159], v[12:15], v[36:39], 0
    ds_read_b64_tr_b16 v[8:9], v2 offset:12672
    v_mfma_f32_16x16x32_bf16 v[152:155], v[12:15], v[32:35], 0
    ds_read_b64_tr_b16 v[10:11], v2 offset:12928
    v_mfma_f32_16x16x32_bf16 v[148:151], v[12:15], v[28:31], 0
    v_mfma_f32_16x16x32_bf16 v[144:147], v[12:15], v[24:27], 0
    s_waitcnt lgkmcnt(4)
    v_mfma_f32_16x16x32_bf16 v[160:163], v[16:19], v[24:27], 0
    ds_read_b64_tr_b16 v[12:13], v2 offset:12704
    v_mfma_f32_16x16x32_bf16 v[164:167], v[16:19], v[28:31], 0
    ds_read_b64_tr_b16 v[14:15], v2 offset:12960
    v_mfma_f32_16x16x32_bf16 v[168:171], v[16:19], v[32:35], 0
    v_mfma_f32_16x16x32_bf16 v[172:175], v[16:19], v[36:39], 0
    s_waitcnt lgkmcnt(4)
    v_mfma_f32_16x16x32_bf16 v[188:191], v[20:23], v[36:39], 0
    ds_read_b64_tr_b16 v[16:17], v2 offset:12736
    v_mfma_f32_16x16x32_bf16 v[184:187], v[20:23], v[32:35], 0
    ds_read_b64_tr_b16 v[18:19], v2 offset:12992
    v_mfma_f32_16x16x32_bf16 v[180:183], v[20:23], v[28:31], 0
    v_mfma_f32_16x16x32_bf16 v[176:179], v[20:23], v[24:27], 0
    s_waitcnt lgkmcnt(4)
    v_mfma_f32_16x16x32_bf16 v[192:195], v[8:11], v[112:115], v[192:195]
    ds_read_b64_tr_b16 v[20:21], v2 offset:12768
    s_bfe_u32 s54, s4, 0x40008
    v_mfma_f32_16x16x32_bf16 v[196:199], v[8:11], v[116:119], v[196:199]
    ds_read_b64_tr_b16 v[22:23], v2 offset:13024
    s_lshl_b32 s54, s54, 17
    v_mfma_f32_16x16x32_bf16 v[200:203], v[8:11], v[120:123], v[200:203]
    s_add_u32 s54, s54, s46
    v_mfma_f32_16x16x32_bf16 v[204:207], v[8:11], v[124:127], v[204:207]
    s_add_u32 s53, s54, 4096
    s_waitcnt lgkmcnt(4)
    v_mfma_f32_16x16x32_bf16 v[220:223], v[12:15], v[124:127], v[220:223]
    ds_read_b64_tr_b16 v[8:9], v2 offset:4224
    v_mfma_f32_16x16x32_bf16 v[216:219], v[12:15], v[120:123], v[216:219]
    ds_read_b64_tr_b16 v[10:11], v2 offset:4480
    v_mfma_f32_16x16x32_bf16 v[212:215], v[12:15], v[116:119], v[212:215]
    buffer_load_dwordx4 v[24:27], v1, s[20:23], s54 offen offset:0 sc1
    v_mfma_f32_16x16x32_bf16 v[208:211], v[12:15], v[112:115], v[208:211]
    s_waitcnt lgkmcnt(4)
    v_mfma_f32_16x16x32_bf16 v[224:227], v[16:19], v[112:115], v[224:227]
    ds_read_b64_tr_b16 v[12:13], v2 offset:4256
    v_mfma_f32_16x16x32_bf16 v[228:231], v[16:19], v[116:119], v[228:231]
    ds_read_b64_tr_b16 v[14:15], v2 offset:4512
    v_mfma_f32_16x16x32_bf16 v[232:235], v[16:19], v[120:123], v[232:235]
    buffer_load_dwordx4 v[28:31], v1, s[20:23], s53 offen offset:0 sc1
    v_mfma_f32_16x16x32_bf16 v[236:239], v[16:19], v[124:127], v[236:239]
    s_waitcnt lgkmcnt(4)
    v_mfma_f32_16x16x32_bf16 v[252:255], v[20:23], v[124:127], v[252:255]
    ds_read_b64_tr_b16 v[16:17], v2 offset:4288
    v_mfma_f32_16x16x32_bf16 v[248:251], v[20:23], v[120:123], v[248:251]
    ds_read_b64_tr_b16 v[18:19], v2 offset:4544
    v_mfma_f32_16x16x32_bf16 v[244:247], v[20:23], v[116:119], v[244:247]
    buffer_load_dwordx4 v[32:35], v3, s[20:23], s54 offen offset:0 sc1
    v_mfma_f32_16x16x32_bf16 v[240:243], v[20:23], v[112:115], v[240:243]
    s_waitcnt lgkmcnt(4)
    v_mfma_f32_16x16x32_bf16 v[128:131], v[8:11], v[112:115], v[128:131]
    ds_read_b64_tr_b16 v[20:21], v2 offset:4320
    v_mfma_f32_16x16x32_bf16 v[132:135], v[8:11], v[116:119], v[132:135]
    ds_read_b64_tr_b16 v[22:23], v2 offset:4576
    v_mfma_f32_16x16x32_bf16 v[136:139], v[8:11], v[120:123], v[136:139]
    v_add_u32 v2, 16896, v2
    s_barrier
    v_mfma_f32_16x16x32_bf16 v[140:143], v[8:11], v[124:127], v[140:143]
    s_waitcnt lgkmcnt(4)
    v_mfma_f32_16x16x32_bf16 v[156:159], v[12:15], v[124:127], v[156:159]
    ds_read_b64_tr_b16 v[8:9], v2 offset:8448
    v_mfma_f32_16x16x32_bf16 v[152:155], v[12:15], v[120:123], v[152:155]
    ds_read_b64_tr_b16 v[10:11], v2 offset:8704
    v_mfma_f32_16x16x32_bf16 v[148:151], v[12:15], v[116:119], v[148:151]
    buffer_load_dwordx4 v[36:39], v3, s[20:23], s53 offen offset:0 sc1
    v_mfma_f32_16x16x32_bf16 v[144:147], v[12:15], v[112:115], v[144:147]
    s_waitcnt lgkmcnt(4)
    v_mfma_f32_16x16x32_bf16 v[160:163], v[16:19], v[112:115], v[160:163]
    ds_read_b64_tr_b16 v[12:13], v2 offset:8480
    v_mfma_f32_16x16x32_bf16 v[164:167], v[16:19], v[116:119], v[164:167]
    ds_read_b64_tr_b16 v[14:15], v2 offset:8736
    v_mfma_f32_16x16x32_bf16 v[168:171], v[16:19], v[120:123], v[168:171]
    v_mfma_f32_16x16x32_bf16 v[172:175], v[16:19], v[124:127], v[172:175]
    s_waitcnt lgkmcnt(4)
    v_mfma_f32_16x16x32_bf16 v[188:191], v[20:23], v[124:127], v[188:191]
    ds_read_b64_tr_b16 v[16:17], v2 offset:8512
    v_mfma_f32_16x16x32_bf16 v[184:187], v[20:23], v[120:123], v[184:187]
    ds_read_b64_tr_b16 v[18:19], v2 offset:8768
    v_mfma_f32_16x16x32_bf16 v[180:183], v[20:23], v[116:119], v[180:183]
    v_mfma_f32_16x16x32_bf16 v[176:179], v[20:23], v[112:115], v[176:179]
    s_waitcnt vmcnt(8)
    s_waitcnt lgkmcnt(4)
    v_mfma_f32_16x16x32_bf16 v[192:195], v[8:11], v[96:99], v[192:195]
    ds_read_b64_tr_b16 v[20:21], v2 offset:8544
    v_mfma_f32_16x16x32_bf16 v[196:199], v[8:11], v[100:103], v[196:199]
    ds_read_b64_tr_b16 v[22:23], v2 offset:8800
    v_mfma_f32_16x16x32_bf16 v[200:203], v[8:11], v[104:107], v[200:203]
    buffer_load_dwordx4 v[112:115], v1, s[20:23], s54 offen offset:2048 sc1
    v_mfma_f32_16x16x32_bf16 v[204:207], v[8:11], v[108:111], v[204:207]
    s_waitcnt lgkmcnt(4)
    v_mfma_f32_16x16x32_bf16 v[220:223], v[12:15], v[108:111], v[220:223]
    ds_read_b64_tr_b16 v[8:9], v2 offset:0
    v_mfma_f32_16x16x32_bf16 v[216:219], v[12:15], v[104:107], v[216:219]
    ds_read_b64_tr_b16 v[10:11], v2 offset:256
    v_mfma_f32_16x16x32_bf16 v[212:215], v[12:15], v[100:103], v[212:215]
    buffer_load_dwordx4 v[116:119], v1, s[20:23], s53 offen offset:2048 sc1
    v_mfma_f32_16x16x32_bf16 v[208:211], v[12:15], v[96:99], v[208:211]
    s_waitcnt lgkmcnt(4)
    v_mfma_f32_16x16x32_bf16 v[224:227], v[16:19], v[96:99], v[224:227]
    ds_read_b64_tr_b16 v[12:13], v2 offset:32
    v_mfma_f32_16x16x32_bf16 v[228:231], v[16:19], v[100:103], v[228:231]
    ds_read_b64_tr_b16 v[14:15], v2 offset:288
    v_mfma_f32_16x16x32_bf16 v[232:235], v[16:19], v[104:107], v[232:235]
    buffer_load_dwordx4 v[120:123], v3, s[20:23], s54 offen offset:2048 sc1
    v_mfma_f32_16x16x32_bf16 v[236:239], v[16:19], v[108:111], v[236:239]
    s_waitcnt lgkmcnt(4)
    v_mfma_f32_16x16x32_bf16 v[252:255], v[20:23], v[108:111], v[252:255]
    ds_read_b64_tr_b16 v[16:17], v2 offset:64
    v_mfma_f32_16x16x32_bf16 v[248:251], v[20:23], v[104:107], v[248:251]
    ds_read_b64_tr_b16 v[18:19], v2 offset:320
    v_mfma_f32_16x16x32_bf16 v[244:247], v[20:23], v[100:103], v[244:247]
    buffer_load_dwordx4 v[124:127], v3, s[20:23], s53 offen offset:2048 sc1
    v_mfma_f32_16x16x32_bf16 v[240:243], v[20:23], v[96:99], v[240:243]
    s_waitcnt lgkmcnt(4)
    v_mfma_f32_16x16x32_bf16 v[128:131], v[8:11], v[96:99], v[128:131]
    ds_read_b64_tr_b16 v[20:21], v2 offset:96
    v_mfma_f32_16x16x32_bf16 v[132:135], v[8:11], v[100:103], v[132:135]
    ds_read_b64_tr_b16 v[22:23], v2 offset:352
    v_mfma_f32_16x16x32_bf16 v[136:139], v[8:11], v[104:107], v[136:139]
    v_mfma_f32_16x16x32_bf16 v[140:143], v[8:11], v[108:111], v[140:143]
    s_waitcnt lgkmcnt(4)
    v_mfma_f32_16x16x32_bf16 v[156:159], v[12:15], v[108:111], v[156:159]
    ds_read_b64_tr_b16 v[8:9], v2 offset:12672
    v_mfma_f32_16x16x32_bf16 v[152:155], v[12:15], v[104:107], v[152:155]
    ds_read_b64_tr_b16 v[10:11], v2 offset:12928
    v_mfma_f32_16x16x32_bf16 v[148:151], v[12:15], v[100:103], v[148:151]
    v_mfma_f32_16x16x32_bf16 v[144:147], v[12:15], v[96:99], v[144:147]
    s_waitcnt lgkmcnt(4)
    v_mfma_f32_16x16x32_bf16 v[160:163], v[16:19], v[96:99], v[160:163]
    ds_read_b64_tr_b16 v[12:13], v2 offset:12704
    v_mfma_f32_16x16x32_bf16 v[164:167], v[16:19], v[100:103], v[164:167]
    ds_read_b64_tr_b16 v[14:15], v2 offset:12960
    v_mfma_f32_16x16x32_bf16 v[168:171], v[16:19], v[104:107], v[168:171]
    v_mfma_f32_16x16x32_bf16 v[172:175], v[16:19], v[108:111], v[172:175]
    s_waitcnt lgkmcnt(4)
    v_mfma_f32_16x16x32_bf16 v[188:191], v[20:23], v[108:111], v[188:191]
    ds_read_b64_tr_b16 v[16:17], v2 offset:12736
    v_mfma_f32_16x16x32_bf16 v[184:187], v[20:23], v[104:107], v[184:187]
    ds_read_b64_tr_b16 v[18:19], v2 offset:12992
    v_mfma_f32_16x16x32_bf16 v[180:183], v[20:23], v[100:103], v[180:183]
    v_mfma_f32_16x16x32_bf16 v[176:179], v[20:23], v[96:99], v[176:179]
    s_waitcnt vmcnt(8)
    s_waitcnt lgkmcnt(4)
    v_mfma_f32_16x16x32_bf16 v[192:195], v[8:11], v[72:75], v[192:195]
    ds_read_b64_tr_b16 v[20:21], v2 offset:12768
    s_bfe_u32 s54, s4, 0x4000c
    v_mfma_f32_16x16x32_bf16 v[196:199], v[8:11], v[76:79], v[196:199]
    ds_read_b64_tr_b16 v[22:23], v2 offset:13024
    s_lshl_b32 s54, s54, 17
    v_mfma_f32_16x16x32_bf16 v[200:203], v[8:11], v[80:83], v[200:203]
    s_add_u32 s54, s54, s46
    v_mfma_f32_16x16x32_bf16 v[204:207], v[8:11], v[84:87], v[204:207]
    s_add_u32 s53, s54, 4096
    s_waitcnt lgkmcnt(4)
    v_mfma_f32_16x16x32_bf16 v[220:223], v[12:15], v[84:87], v[220:223]
    ds_read_b64_tr_b16 v[8:9], v2 offset:4224
    v_mfma_f32_16x16x32_bf16 v[216:219], v[12:15], v[80:83], v[216:219]
    ds_read_b64_tr_b16 v[10:11], v2 offset:4480
    v_mfma_f32_16x16x32_bf16 v[212:215], v[12:15], v[76:79], v[212:215]
    buffer_load_dwordx4 v[96:99], v1, s[20:23], s54 offen offset:0 sc1
    v_mfma_f32_16x16x32_bf16 v[208:211], v[12:15], v[72:75], v[208:211]
    s_waitcnt lgkmcnt(4)
    v_mfma_f32_16x16x32_bf16 v[224:227], v[16:19], v[72:75], v[224:227]
    ds_read_b64_tr_b16 v[12:13], v2 offset:4256
    v_mfma_f32_16x16x32_bf16 v[228:231], v[16:19], v[76:79], v[228:231]
    ds_read_b64_tr_b16 v[14:15], v2 offset:4512
    v_mfma_f32_16x16x32_bf16 v[232:235], v[16:19], v[80:83], v[232:235]
    buffer_load_dwordx4 v[100:103], v1, s[20:23], s53 offen offset:0 sc1
    v_mfma_f32_16x16x32_bf16 v[236:239], v[16:19], v[84:87], v[236:239]
    s_waitcnt lgkmcnt(4)
    v_mfma_f32_16x16x32_bf16 v[252:255], v[20:23], v[84:87], v[252:255]
    ds_read_b64_tr_b16 v[16:17], v2 offset:4288
    v_mfma_f32_16x16x32_bf16 v[248:251], v[20:23], v[80:83], v[248:251]
    ds_read_b64_tr_b16 v[18:19], v2 offset:4544
    v_mfma_f32_16x16x32_bf16 v[244:247], v[20:23], v[76:79], v[244:247]
    buffer_load_dwordx4 v[104:107], v3, s[20:23], s54 offen offset:0 sc1
    v_mfma_f32_16x16x32_bf16 v[240:243], v[20:23], v[72:75], v[240:243]
    s_waitcnt lgkmcnt(4)
    v_mfma_f32_16x16x32_bf16 v[128:131], v[8:11], v[72:75], v[128:131]
    ds_read_b64_tr_b16 v[20:21], v2 offset:4320
    v_mfma_f32_16x16x32_bf16 v[132:135], v[8:11], v[76:79], v[132:135]
    ds_read_b64_tr_b16 v[22:23], v2 offset:4576
    v_mfma_f32_16x16x32_bf16 v[136:139], v[8:11], v[80:83], v[136:139]
    v_add_u32 v2, 16896, v2
    s_barrier
    v_mfma_f32_16x16x32_bf16 v[140:143], v[8:11], v[84:87], v[140:143]
    s_waitcnt lgkmcnt(4)
    v_mfma_f32_16x16x32_bf16 v[156:159], v[12:15], v[84:87], v[156:159]
    ds_read_b64_tr_b16 v[8:9], v2 offset:8448
    v_mfma_f32_16x16x32_bf16 v[152:155], v[12:15], v[80:83], v[152:155]
    ds_read_b64_tr_b16 v[10:11], v2 offset:8704
    v_mfma_f32_16x16x32_bf16 v[148:151], v[12:15], v[76:79], v[148:151]
    buffer_load_dwordx4 v[108:111], v3, s[20:23], s53 offen offset:0 sc1
    v_mfma_f32_16x16x32_bf16 v[144:147], v[12:15], v[72:75], v[144:147]
    s_waitcnt lgkmcnt(4)
    v_mfma_f32_16x16x32_bf16 v[160:163], v[16:19], v[72:75], v[160:163]
    ds_read_b64_tr_b16 v[12:13], v2 offset:12672
    v_mfma_f32_16x16x32_bf16 v[164:167], v[16:19], v[76:79], v[164:167]
    ds_read_b64_tr_b16 v[14:15], v2 offset:12928
    v_mfma_f32_16x16x32_bf16 v[168:171], v[16:19], v[80:83], v[168:171]
    v_mfma_f32_16x16x32_bf16 v[172:175], v[16:19], v[84:87], v[172:175]
    s_waitcnt lgkmcnt(4)
    v_mfma_f32_16x16x32_bf16 v[188:191], v[20:23], v[84:87], v[188:191]
    ds_read_b64_tr_b16 v[16:17], v2 offset:8480
    v_mfma_f32_16x16x32_bf16 v[184:187], v[20:23], v[80:83], v[184:187]
    ds_read_b64_tr_b16 v[18:19], v2 offset:8736
    v_mfma_f32_16x16x32_bf16 v[180:183], v[20:23], v[76:79], v[180:183]
    v_mfma_f32_16x16x32_bf16 v[176:179], v[20:23], v[72:75], v[176:179]
    s_branch L_c2join
L_cq:
    s_lshl_b32 s55, s38, 1
    s_add_u32 s55, s55, s53
    s_sub_u32 s55, s55, 2
    s_lshl_b32 s55, s55, 17
    s_add_u32 s55, s55, s52
    s_add_u32 s62, s55, 0x20000
    ds_read_b64_tr_b16 v[8:9], v2 offset:4224
    ds_read_b64_tr_b16 v[10:11], v2 offset:4480
    ds_read_b128 v[24:27], v1 offset:0
    ds_read_b128 v[28:31], v1 offset:512
    ds_read_b64_tr_b16 v[12:13], v2 offset:4256
    ds_read_b64_tr_b16 v[14:15], v2 offset:4512
    ds_read_b128 v[40:43], v1 offset:4224
    ds_read_b128 v[44:47], v1 offset:4736
.p2align 6
L_p1_86:
    s_waitcnt lgkmcnt(5)
    v_mfma_f32_16x16x32_bf16 v[112:115], v[8:11], v[24:27], v[112:115]
    ds_read_b64_tr_b16 v[16:17], v2 offset:4288
    s_waitcnt lgkmcnt(5)
    v_mfma_f32_16x16x32_bf16 v[116:119], v[8:11], v[28:31], v[116:119]
    ds_read_b64_tr_b16 v[18:19], v2 offset:4544
    s_waitcnt lgkmcnt(4)
    v_mfma_f32_16x16x32_bf16 v[132:135], v[12:15], v[28:31], v[132:135]
    ds_read_b64_tr_b16 v[20:21], v2 offset:4320
    v_mfma_f32_16x16x32_bf16 v[128:131], v[12:15], v[24:27], v[128:131]
    ds_read_b64_tr_b16 v[22:23], v2 offset:4576
    s_waitcnt lgkmcnt(5)
    v_mfma_f32_16x16x32_bf16 v[136:139], v[12:15], v[40:43], v[136:139]
    s_waitcnt lgkmcnt(4)
    v_mfma_f32_16x16x32_bf16 v[140:143], v[12:15], v[44:47], v[140:143]
    v_mfma_f32_16x16x32_bf16 v[124:127], v[8:11], v[44:47], v[124:127]
    v_mfma_f32_16x16x32_bf16 v[120:123], v[8:11], v[40:43], v[120:123]
    s_waitcnt lgkmcnt(2)
    v_mfma_f32_16x16x32_bf16 v[152:155], v[16:19], v[40:43], v[152:155]
    ds_read_b64_tr_b16 v[8:9], v2 offset:8448
    v_mfma_f32_16x16x32_bf16 v[156:159], v[16:19], v[44:47], v[156:159]
    ds_read_b64_tr_b16 v[10:11], v2 offset:8704
    v_mfma_f32_16x16x32_bf16 v[144:147], v[16:19], v[24:27], v[144:147]
    ds_read_b64_tr_b16 v[12:13], v2 offset:8480
    v_mfma_f32_16x16x32_bf16 v[148:151], v[16:19], v[28:31], v[148:151]
    ds_read_b64_tr_b16 v[14:15], v2 offset:8736
    s_waitcnt lgkmcnt(4)
    v_mfma_f32_16x16x32_bf16 v[164:167], v[20:23], v[28:31], v[164:167]
    ds_read_b64_tr_b16 v[16:17], v2 offset:8512
    v_mfma_f32_16x16x32_bf16 v[160:163], v[20:23], v[24:27], v[160:163]
    ds_read_b64_tr_b16 v[18:19], v2 offset:8768
    v_mfma_f32_16x16x32_bf16 v[172:175], v[20:23], v[44:47], v[172:175]
    v_mfma_f32_16x16x32_bf16 v[168:171], v[20:23], v[40:43], v[168:171]
    s_waitcnt lgkmcnt(4)
    v_mfma_f32_16x16x32_bf16 v[184:187], v[8:11], v[40:43], v[184:187]
    ds_read_b64_tr_b16 v[20:21], v2 offset:8544
    v_mfma_f32_16x16x32_bf16 v[188:191], v[8:11], v[44:47], v[188:191]
    ds_read_b64_tr_b16 v[22:23], v2 offset:8800
    v_mfma_f32_16x16x32_bf16 v[176:179], v[8:11], v[24:27], v[176:179]
    v_mfma_f32_16x16x32_bf16 v[180:183], v[8:11], v[28:31], v[180:183]
    s_waitcnt lgkmcnt(4)
    v_mfma_f32_16x16x32_bf16 v[196:199], v[12:15], v[28:31], v[196:199]
    ds_read_b64_tr_b16 v[8:9], v3 offset:0
    v_mfma_f32_16x16x32_bf16 v[192:195], v[12:15], v[24:27], v[192:195]
    ds_read_b64_tr_b16 v[10:11], v3 offset:256
    v_mfma_f32_16x16x32_bf16 v[204:207], v[12:15], v[44:47], v[204:207]
    v_mfma_f32_16x16x32_bf16 v[200:203], v[12:15], v[40:43], v[200:203]
    s_waitcnt lgkmcnt(4)
    v_mfma_f32_16x16x32_bf16 v[216:219], v[16:19], v[40:43], v[216:219]
    ds_read_b64_tr_b16 v[12:13], v2 offset:0
    v_mfma_f32_16x16x32_bf16 v[220:223], v[16:19], v[44:47], v[220:223]
    ds_read_b64_tr_b16 v[14:15], v2 offset:256
    v_mfma_f32_16x16x32_bf16 v[208:211], v[16:19], v[24:27], v[208:211]
    v_mfma_f32_16x16x32_bf16 v[212:215], v[16:19], v[28:31], v[212:215]
    s_waitcnt lgkmcnt(4)
    v_mfma_f32_16x16x32_bf16 v[228:231], v[20:23], v[28:31], v[228:231]
    ds_read_b64_tr_b16 v[16:17], v2 offset:32
    v_mfma_f32_16x16x32_bf16 v[224:227], v[20:23], v[24:27], v[224:227]
    ds_read_b64_tr_b16 v[18:19], v2 offset:288
    v_mfma_f32_16x16x32_bf16 v[236:239], v[20:23], v[44:47], v[236:239]
    v_mfma_f32_16x16x32_bf16 v[232:235], v[20:23], v[40:43], v[232:235]
    s_waitcnt lgkmcnt(4)
    v_mfma_f32_16x16x32_bf16 v[248:251], v[8:11], v[40:43], v[248:251]
    ds_read_b64_tr_b16 v[20:21], v2 offset:64
    v_mfma_f32_16x16x32_bf16 v[252:255], v[8:11], v[44:47], v[252:255]
    ds_read_b64_tr_b16 v[22:23], v2 offset:320
    v_mfma_f32_16x16x32_bf16 v[240:243], v[8:11], v[24:27], v[240:243]
    v_mfma_f32_16x16x32_bf16 v[244:247], v[8:11], v[28:31], v[244:247]
    s_waitcnt lgkmcnt(4)
    v_mfma_f32_16x16x32_bf16 v[52:55], v[12:15], v[28:31], v[52:55]
    ds_read_b64_tr_b16 v[8:9], v2 offset:96
    v_mfma_f32_16x16x32_bf16 v[48:51], v[12:15], v[24:27], v[48:51]
    ds_read_b64_tr_b16 v[10:11], v2 offset:352
    v_mfma_f32_16x16x32_bf16 v[60:63], v[12:15], v[44:47], v[60:63]
    v_mfma_f32_16x16x32_bf16 v[56:59], v[12:15], v[40:43], v[56:59]
    s_waitcnt lgkmcnt(4)
    v_mfma_f32_16x16x32_bf16 v[72:75], v[16:19], v[40:43], v[72:75]
    v_mfma_f32_16x16x32_bf16 v[76:79], v[16:19], v[44:47], v[76:79]
    v_mfma_f32_16x16x32_bf16 v[64:67], v[16:19], v[24:27], v[64:67]
    s_waitcnt lgkmcnt(0)
    s_barrier
    v_mfma_f32_16x16x32_bf16 v[68:71], v[16:19], v[28:31], v[68:71]
    ds_read_b64_tr_b16 v[12:13], v2 offset:17920
    ds_read_b64_tr_b16 v[14:15], v2 offset:18176
    v_mfma_f32_16x16x32_bf16 v[88:91], v[20:23], v[40:43], v[88:91]
    ds_read_b128 v[32:35], v1 offset:64
    ds_read_b128 v[36:39], v1 offset:576
    v_mfma_f32_16x16x32_bf16 v[92:95], v[20:23], v[44:47], v[92:95]
    ds_read_b64_tr_b16 v[16:17], v2 offset:17952
    v_mfma_f32_16x16x32_bf16 v[108:111], v[8:11], v[44:47], v[108:111]
    ds_read_b64_tr_b16 v[18:19], v2 offset:18208
    v_mfma_f32_16x16x32_bf16 v[104:107], v[8:11], v[40:43], v[104:107]
    ds_read_b128 v[40:43], v1 offset:4288
    v_mfma_f32_16x16x32_bf16 v[100:103], v[8:11], v[28:31], v[100:103]
    ds_read_b128 v[44:47], v1 offset:4800
    v_mfma_f32_16x16x32_bf16 v[96:99], v[8:11], v[24:27], v[96:99]
    v_mfma_f32_16x16x32_bf16 v[80:83], v[20:23], v[24:27], v[80:83]
    v_mfma_f32_16x16x32_bf16 v[84:87], v[20:23], v[28:31], v[84:87]
    s_waitcnt lgkmcnt(5)
    v_mfma_f32_16x16x32_bf16 v[112:115], v[12:15], v[32:35], v[112:115]
    ds_read_b64_tr_b16 v[20:21], v2 offset:17984
    s_waitcnt lgkmcnt(5)
    v_mfma_f32_16x16x32_bf16 v[116:119], v[12:15], v[36:39], v[116:119]
    ds_read_b64_tr_b16 v[22:23], v2 offset:18240
    s_waitcnt lgkmcnt(4)
    v_mfma_f32_16x16x32_bf16 v[132:135], v[16:19], v[36:39], v[132:135]
    ds_read_b64_tr_b16 v[8:9], v2 offset:18016
    v_mfma_f32_16x16x32_bf16 v[128:131], v[16:19], v[32:35], v[128:131]
    ds_read_b64_tr_b16 v[10:11], v2 offset:18272
    s_waitcnt lgkmcnt(5)
    v_mfma_f32_16x16x32_bf16 v[136:139], v[16:19], v[40:43], v[136:139]
    s_waitcnt lgkmcnt(4)
    v_mfma_f32_16x16x32_bf16 v[140:143], v[16:19], v[44:47], v[140:143]
    v_mfma_f32_16x16x32_bf16 v[124:127], v[12:15], v[44:47], v[124:127]
    v_mfma_f32_16x16x32_bf16 v[120:123], v[12:15], v[40:43], v[120:123]
    s_waitcnt lgkmcnt(2)
    v_mfma_f32_16x16x32_bf16 v[152:155], v[20:23], v[40:43], v[152:155]
    ds_read_b64_tr_b16 v[12:13], v2 offset:22144
    v_mfma_f32_16x16x32_bf16 v[156:159], v[20:23], v[44:47], v[156:159]
    ds_read_b64_tr_b16 v[14:15], v2 offset:22400
    v_mfma_f32_16x16x32_bf16 v[144:147], v[20:23], v[32:35], v[144:147]
    ds_read_b64_tr_b16 v[16:17], v2 offset:22176
    v_mfma_f32_16x16x32_bf16 v[148:151], v[20:23], v[36:39], v[148:151]
    ds_read_b64_tr_b16 v[18:19], v2 offset:22432
    s_waitcnt lgkmcnt(4)
    v_mfma_f32_16x16x32_bf16 v[164:167], v[8:11], v[36:39], v[164:167]
    ds_read_b64_tr_b16 v[20:21], v2 offset:22208
    v_mfma_f32_16x16x32_bf16 v[160:163], v[8:11], v[32:35], v[160:163]
    ds_read_b64_tr_b16 v[22:23], v2 offset:22464
    v_mfma_f32_16x16x32_bf16 v[172:175], v[8:11], v[44:47], v[172:175]
    v_mfma_f32_16x16x32_bf16 v[168:171], v[8:11], v[40:43], v[168:171]
    s_waitcnt lgkmcnt(4)
    v_mfma_f32_16x16x32_bf16 v[184:187], v[12:15], v[40:43], v[184:187]
    ds_read_b64_tr_b16 v[8:9], v2 offset:22240
    v_mfma_f32_16x16x32_bf16 v[188:191], v[12:15], v[44:47], v[188:191]
    ds_read_b64_tr_b16 v[10:11], v2 offset:22496
    v_mfma_f32_16x16x32_bf16 v[176:179], v[12:15], v[32:35], v[176:179]
    v_mfma_f32_16x16x32_bf16 v[180:183], v[12:15], v[36:39], v[180:183]
    s_waitcnt lgkmcnt(4)
    v_mfma_f32_16x16x32_bf16 v[196:199], v[16:19], v[36:39], v[196:199]
    ds_read_b64_tr_b16 v[12:13], v3 offset:13696
    v_mfma_f32_16x16x32_bf16 v[192:195], v[16:19], v[32:35], v[192:195]
    ds_read_b64_tr_b16 v[14:15], v3 offset:13952
    v_mfma_f32_16x16x32_bf16 v[204:207], v[16:19], v[44:47], v[204:207]
    v_mfma_f32_16x16x32_bf16 v[200:203], v[16:19], v[40:43], v[200:203]
    s_waitcnt lgkmcnt(4)
    v_mfma_f32_16x16x32_bf16 v[216:219], v[20:23], v[40:43], v[216:219]
    ds_read_b64_tr_b16 v[16:17], v2 offset:13696
    v_mfma_f32_16x16x32_bf16 v[220:223], v[20:23], v[44:47], v[220:223]
    ds_read_b64_tr_b16 v[18:19], v2 offset:13952
    v_mfma_f32_16x16x32_bf16 v[208:211], v[20:23], v[32:35], v[208:211]
    v_mfma_f32_16x16x32_bf16 v[212:215], v[20:23], v[36:39], v[212:215]
    s_waitcnt lgkmcnt(4)
    v_mfma_f32_16x16x32_bf16 v[228:231], v[8:11], v[36:39], v[228:231]
    ds_read_b64_tr_b16 v[20:21], v2 offset:13728
    v_mfma_f32_16x16x32_bf16 v[224:227], v[8:11], v[32:35], v[224:227]
    ds_read_b64_tr_b16 v[22:23], v2 offset:13984
    v_mfma_f32_16x16x32_bf16 v[236:239], v[8:11], v[44:47], v[236:239]
    v_mfma_f32_16x16x32_bf16 v[232:235], v[8:11], v[40:43], v[232:235]
    s_waitcnt lgkmcnt(4)
    v_mfma_f32_16x16x32_bf16 v[248:251], v[12:15], v[40:43], v[248:251]
    ds_read_b64_tr_b16 v[8:9], v2 offset:13760
    v_mfma_f32_16x16x32_bf16 v[252:255], v[12:15], v[44:47], v[252:255]
    ds_read_b64_tr_b16 v[10:11], v2 offset:14016
    v_mfma_f32_16x16x32_bf16 v[240:243], v[12:15], v[32:35], v[240:243]
    v_mfma_f32_16x16x32_bf16 v[244:247], v[12:15], v[36:39], v[244:247]
    s_waitcnt lgkmcnt(4)
    v_mfma_f32_16x16x32_bf16 v[52:55], v[16:19], v[36:39], v[52:55]
    ds_read_b64_tr_b16 v[12:13], v2 offset:13792
    v_mfma_f32_16x16x32_bf16 v[48:51], v[16:19], v[32:35], v[48:51]
    ds_read_b64_tr_b16 v[14:15], v2 offset:14048
    v_mfma_f32_16x16x32_bf16 v[60:63], v[16:19], v[44:47], v[60:63]
    s_add_u32 s46, s46, 33792
    s_cmp_eq_u32 s46, 101376
    v_mfma_f32_16x16x32_bf16 v[56:59], v[16:19], v[40:43], v[56:59]
    s_cselect_b32 s47, s48, s49
    s_cselect_b32 s46, 0, s46
    s_waitcnt lgkmcnt(4)
    v_mfma_f32_16x16x32_bf16 v[72:75], v[20:23], v[40:43], v[72:75]
    v_add_u32 v1, s47, v1
    v_mfma_f32_16x16x32_bf16 v[76:79], v[20:23], v[44:47], v[76:79]
    v_mfma_f32_16x16x32_bf16 v[64:67], v[20:23], v[32:35], v[64:67]
    s_waitcnt lgkmcnt(0)
    s_barrier
    v_mfma_f32_16x16x32_bf16 v[68:71], v[20:23], v[36:39], v[68:71]
    ds_read_b64_tr_b16 v[16:17], v2 offset:31616
    ds_read_b64_tr_b16 v[18:19], v2 offset:31872
    v_mfma_f32_16x16x32_bf16 v[88:91], v[8:11], v[40:43], v[88:91]
    ds_read_b128 v[24:27], v1 offset:0
    ds_read_b128 v[28:31], v1 offset:512
    v_mfma_f32_16x16x32_bf16 v[92:95], v[8:11], v[44:47], v[92:95]
    ds_read_b64_tr_b16 v[20:21], v2 offset:31648
    v_mfma_f32_16x16x32_bf16 v[108:111], v[12:15], v[44:47], v[108:111]
    ds_read_b64_tr_b16 v[22:23], v2 offset:31904
    v_mfma_f32_16x16x32_bf16 v[104:107], v[12:15], v[40:43], v[104:107]
    ds_read_b128 v[40:43], v1 offset:4224
    v_mfma_f32_16x16x32_bf16 v[100:103], v[12:15], v[36:39], v[100:103]
    ds_read_b128 v[44:47], v1 offset:4736
    v_mfma_f32_16x16x32_bf16 v[96:99], v[12:15], v[32:35], v[96:99]
    v_mfma_f32_16x16x32_bf16 v[80:83], v[8:11], v[32:35], v[80:83]
    v_mfma_f32_16x16x32_bf16 v[84:87], v[8:11], v[36:39], v[84:87]
    s_waitcnt lgkmcnt(5)
    v_mfma_f32_16x16x32_bf16 v[112:115], v[16:19], v[24:27], v[112:115]
    ds_read_b64_tr_b16 v[8:9], v2 offset:31680
    s_waitcnt lgkmcnt(5)
    v_mfma_f32_16x16x32_bf16 v[116:119], v[16:19], v[28:31], v[116:119]
    ds_read_b64_tr_b16 v[10:11], v2 offset:31936
    s_waitcnt lgkmcnt(4)
    v_mfma_f32_16x16x32_bf16 v[132:135], v[20:23], v[28:31], v[132:135]
    ds_read_b64_tr_b16 v[12:13], v2 offset:31712
    v_mfma_f32_16x16x32_bf16 v[128:131], v[20:23], v[24:27], v[128:131]
    ds_read_b64_tr_b16 v[14:15], v2 offset:31968
    s_waitcnt lgkmcnt(5)
    v_mfma_f32_16x16x32_bf16 v[136:139], v[20:23], v[40:43], v[136:139]
    s_waitcnt lgkmcnt(4)
    v_mfma_f32_16x16x32_bf16 v[140:143], v[20:23], v[44:47], v[140:143]
    v_mfma_f32_16x16x32_bf16 v[124:127], v[16:19], v[44:47], v[124:127]
    v_mfma_f32_16x16x32_bf16 v[120:123], v[16:19], v[40:43], v[120:123]
    s_waitcnt lgkmcnt(2)
    v_mfma_f32_16x16x32_bf16 v[152:155], v[8:11], v[40:43], v[152:155]
    ds_read_b64_tr_b16 v[16:17], v2 offset:35840
    v_mfma_f32_16x16x32_bf16 v[156:159], v[8:11], v[44:47], v[156:159]
    ds_read_b64_tr_b16 v[18:19], v2 offset:36096
    v_mfma_f32_16x16x32_bf16 v[144:147], v[8:11], v[24:27], v[144:147]
    ds_read_b64_tr_b16 v[20:21], v2 offset:35872
    v_mfma_f32_16x16x32_bf16 v[148:151], v[8:11], v[28:31], v[148:151]
    ds_read_b64_tr_b16 v[22:23], v2 offset:36128
    s_waitcnt lgkmcnt(4)
    v_mfma_f32_16x16x32_bf16 v[164:167], v[12:15], v[28:31], v[164:167]
    ds_read_b64_tr_b16 v[8:9], v2 offset:35904
    v_mfma_f32_16x16x32_bf16 v[160:163], v[12:15], v[24:27], v[160:163]
    ds_read_b64_tr_b16 v[10:11], v2 offset:36160
    v_mfma_f32_16x16x32_bf16 v[172:175], v[12:15], v[44:47], v[172:175]
    v_mfma_f32_16x16x32_bf16 v[168:171], v[12:15], v[40:43], v[168:171]
    s_waitcnt lgkmcnt(4)
    v_mfma_f32_16x16x32_bf16 v[184:187], v[16:19], v[40:43], v[184:187]
    ds_read_b64_tr_b16 v[12:13], v2 offset:35936
    v_mfma_f32_16x16x32_bf16 v[188:191], v[16:19], v[44:47], v[188:191]
    ds_read_b64_tr_b16 v[14:15], v2 offset:36192
    v_mfma_f32_16x16x32_bf16 v[176:179], v[16:19], v[24:27], v[176:179]
    v_mfma_f32_16x16x32_bf16 v[180:183], v[16:19], v[28:31], v[180:183]
    s_waitcnt lgkmcnt(4)
    v_mfma_f32_16x16x32_bf16 v[196:199], v[20:23], v[28:31], v[196:199]
    ds_read_b64_tr_b16 v[16:17], v3 offset:27392
    v_mfma_f32_16x16x32_bf16 v[192:195], v[20:23], v[24:27], v[192:195]
    ds_read_b64_tr_b16 v[18:19], v3 offset:27648
    v_mfma_f32_16x16x32_bf16 v[204:207], v[20:23], v[44:47], v[204:207]
    v_mfma_f32_16x16x32_bf16 v[200:203], v[20:23], v[40:43], v[200:203]
    s_waitcnt lgkmcnt(4)
    v_mfma_f32_16x16x32_bf16 v[216:219], v[8:11], v[40:43], v[216:219]
    ds_read_b64_tr_b16 v[20:21], v2 offset:27392
    v_mfma_f32_16x16x32_bf16 v[220:223], v[8:11], v[44:47], v[220:223]
    ds_read_b64_tr_b16 v[22:23], v2 offset:27648
    v_mfma_f32_16x16x32_bf16 v[208:211], v[8:11], v[24:27], v[208:211]
    v_mfma_f32_16x16x32_bf16 v[212:215], v[8:11], v[28:31], v[212:215]
    s_waitcnt lgkmcnt(4)
    v_mfma_f32_16x16x32_bf16 v[228:231], v[12:15], v[28:31], v[228:231]
    ds_read_b64_tr_b16 v[8:9], v2 offset:27424
    v_mfma_f32_16x16x32_bf16 v[224:227], v[12:15], v[24:27], v[224:227]
    ds_read_b64_tr_b16 v[10:11], v2 offset:27680
    v_mfma_f32_16x16x32_bf16 v[236:239], v[12:15], v[44:47], v[236:239]
    v_mfma_f32_16x16x32_bf16 v[232:235], v[12:15], v[40:43], v[232:235]
    s_waitcnt lgkmcnt(4)
    v_mfma_f32_16x16x32_bf16 v[248:251], v[16:19], v[40:43], v[248:251]
    ds_read_b64_tr_b16 v[12:13], v2 offset:27456
    v_mfma_f32_16x16x32_bf16 v[252:255], v[16:19], v[44:47], v[252:255]
    ds_read_b64_tr_b16 v[14:15], v2 offset:27712
    v_mfma_f32_16x16x32_bf16 v[240:243], v[16:19], v[24:27], v[240:243]
    v_mfma_f32_16x16x32_bf16 v[244:247], v[16:19], v[28:31], v[244:247]
    s_waitcnt lgkmcnt(4)
    v_mfma_f32_16x16x32_bf16 v[52:55], v[20:23], v[28:31], v[52:55]
    ds_read_b64_tr_b16 v[16:17], v2 offset:27488
    v_mfma_f32_16x16x32_bf16 v[48:51], v[20:23], v[24:27], v[48:51]
    ds_read_b64_tr_b16 v[18:19], v2 offset:27744
    v_mfma_f32_16x16x32_bf16 v[60:63], v[20:23], v[44:47], v[60:63]
    v_mfma_f32_16x16x32_bf16 v[56:59], v[20:23], v[40:43], v[56:59]
    s_waitcnt lgkmcnt(4)
    v_mfma_f32_16x16x32_bf16 v[72:75], v[8:11], v[40:43], v[72:75]
    v_mfma_f32_16x16x32_bf16 v[76:79], v[8:11], v[44:47], v[76:79]
    v_mfma_f32_16x16x32_bf16 v[64:67], v[8:11], v[24:27], v[64:67]
    s_waitcnt lgkmcnt(0)
    s_barrier
    v_mfma_f32_16x16x32_bf16 v[68:71], v[8:11], v[28:31], v[68:71]
    ds_read_b64_tr_b16 v[20:21], v2 offset:45312
    ds_read_b64_tr_b16 v[22:23], v2 offset:45568
    v_mfma_f32_16x16x32_bf16 v[88:91], v[12:15], v[40:43], v[88:91]
    ds_read_b128 v[32:35], v1 offset:64
    ds_read_b128 v[36:39], v1 offset:576
    v_mfma_f32_16x16x32_bf16 v[92:95], v[12:15], v[44:47], v[92:95]
    ds_read_b64_tr_b16 v[8:9], v2 offset:45344
    v_mfma_f32_16x16x32_bf16 v[108:111], v[16:19], v[44:47], v[108:111]
    ds_read_b64_tr_b16 v[10:11], v2 offset:45600
    v_mfma_f32_16x16x32_bf16 v[104:107], v[16:19], v[40:43], v[104:107]
    ds_read_b128 v[40:43], v1 offset:4288
    v_mfma_f32_16x16x32_bf16 v[100:103], v[16:19], v[28:31], v[100:103]
    ds_read_b128 v[44:47], v1 offset:4800
    v_mfma_f32_16x16x32_bf16 v[96:99], v[16:19], v[24:27], v[96:99]
    v_mfma_f32_16x16x32_bf16 v[80:83], v[12:15], v[24:27], v[80:83]
    v_mfma_f32_16x16x32_bf16 v[84:87], v[12:15], v[28:31], v[84:87]
    s_waitcnt lgkmcnt(5)
    v_mfma_f32_16x16x32_bf16 v[112:115], v[20:23], v[32:35], v[112:115]
    ds_read_b64_tr_b16 v[12:13], v2 offset:45376
    s_waitcnt lgkmcnt(5)
    v_mfma_f32_16x16x32_bf16 v[116:119], v[20:23], v[36:39], v[116:119]
    ds_read_b64_tr_b16 v[14:15], v2 offset:45632
    s_waitcnt lgkmcnt(4)
    v_mfma_f32_16x16x32_bf16 v[132:135], v[8:11], v[36:39], v[132:135]
    ds_read_b64_tr_b16 v[16:17], v2 offset:45408
    v_mfma_f32_16x16x32_bf16 v[128:131], v[8:11], v[32:35], v[128:131]
    ds_read_b64_tr_b16 v[18:19], v2 offset:45664
    s_waitcnt lgkmcnt(5)
    v_mfma_f32_16x16x32_bf16 v[136:139], v[8:11], v[40:43], v[136:139]
    s_waitcnt lgkmcnt(4)
    v_mfma_f32_16x16x32_bf16 v[140:143], v[8:11], v[44:47], v[140:143]
    v_mfma_f32_16x16x32_bf16 v[124:127], v[20:23], v[44:47], v[124:127]
    v_mfma_f32_16x16x32_bf16 v[120:123], v[20:23], v[40:43], v[120:123]
    s_waitcnt lgkmcnt(2)
    v_mfma_f32_16x16x32_bf16 v[152:155], v[12:15], v[40:43], v[152:155]
    ds_read_b64_tr_b16 v[20:21], v2 offset:49536
    v_mfma_f32_16x16x32_bf16 v[156:159], v[12:15], v[44:47], v[156:159]
    ds_read_b64_tr_b16 v[22:23], v2 offset:49792
    v_mfma_f32_16x16x32_bf16 v[144:147], v[12:15], v[32:35], v[144:147]
    ds_read_b64_tr_b16 v[8:9], v2 offset:49568
    v_mfma_f32_16x16x32_bf16 v[148:151], v[12:15], v[36:39], v[148:151]
    ds_read_b64_tr_b16 v[10:11], v2 offset:49824
    s_waitcnt lgkmcnt(4)
    v_mfma_f32_16x16x32_bf16 v[164:167], v[16:19], v[36:39], v[164:167]
    ds_read_b64_tr_b16 v[12:13], v2 offset:49600
    v_mfma_f32_16x16x32_bf16 v[160:163], v[16:19], v[32:35], v[160:163]
    ds_read_b64_tr_b16 v[14:15], v2 offset:49856
    v_mfma_f32_16x16x32_bf16 v[172:175], v[16:19], v[44:47], v[172:175]
    v_mfma_f32_16x16x32_bf16 v[168:171], v[16:19], v[40:43], v[168:171]
    s_waitcnt lgkmcnt(4)
    v_mfma_f32_16x16x32_bf16 v[184:187], v[20:23], v[40:43], v[184:187]
    ds_read_b64_tr_b16 v[16:17], v2 offset:49632
    v_mfma_f32_16x16x32_bf16 v[188:191], v[20:23], v[44:47], v[188:191]
    ds_read_b64_tr_b16 v[18:19], v2 offset:49888
    v_mfma_f32_16x16x32_bf16 v[176:179], v[20:23], v[32:35], v[176:179]
    v_mfma_f32_16x16x32_bf16 v[180:183], v[20:23], v[36:39], v[180:183]
    s_waitcnt lgkmcnt(4)
    v_mfma_f32_16x16x32_bf16 v[196:199], v[8:11], v[36:39], v[196:199]
    ds_read_b64_tr_b16 v[20:21], v3 offset:41088
    v_mfma_f32_16x16x32_bf16 v[192:195], v[8:11], v[32:35], v[192:195]
    ds_read_b64_tr_b16 v[22:23], v3 offset:41344
    v_mfma_f32_16x16x32_bf16 v[204:207], v[8:11], v[44:47], v[204:207]
    v_mfma_f32_16x16x32_bf16 v[200:203], v[8:11], v[40:43], v[200:203]
    s_waitcnt lgkmcnt(4)
    v_mfma_f32_16x16x32_bf16 v[216:219], v[12:15], v[40:43], v[216:219]
    ds_read_b64_tr_b16 v[8:9], v2 offset:41088
    v_mfma_f32_16x16x32_bf16 v[220:223], v[12:15], v[44:47], v[220:223]
    ds_read_b64_tr_b16 v[10:11], v2 offset:41344
    v_mfma_f32_16x16x32_bf16 v[208:211], v[12:15], v[32:35], v[208:211]
    v_mfma_f32_16x16x32_bf16 v[212:215], v[12:15], v[36:39], v[212:215]
    s_waitcnt lgkmcnt(4)
    v_mfma_f32_16x16x32_bf16 v[228:231], v[16:19], v[36:39], v[228:231]
    ds_read_b64_tr_b16 v[12:13], v2 offset:41120
    v_mfma_f32_16x16x32_bf16 v[224:227], v[16:19], v[32:35], v[224:227]
    ds_read_b64_tr_b16 v[14:15], v2 offset:41376
    v_mfma_f32_16x16x32_bf16 v[236:239], v[16:19], v[44:47], v[236:239]
    v_mfma_f32_16x16x32_bf16 v[232:235], v[16:19], v[40:43], v[232:235]
    s_waitcnt lgkmcnt(4)
    v_mfma_f32_16x16x32_bf16 v[248:251], v[20:23], v[40:43], v[248:251]
    ds_read_b64_tr_b16 v[16:17], v2 offset:41152
    v_mfma_f32_16x16x32_bf16 v[252:255], v[20:23], v[44:47], v[252:255]
    ds_read_b64_tr_b16 v[18:19], v2 offset:41408
    v_mfma_f32_16x16x32_bf16 v[240:243], v[20:23], v[32:35], v[240:243]
    v_mfma_f32_16x16x32_bf16 v[244:247], v[20:23], v[36:39], v[244:247]
    s_waitcnt lgkmcnt(4)
    v_mfma_f32_16x16x32_bf16 v[52:55], v[8:11], v[36:39], v[52:55]
    ds_read_b64_tr_b16 v[20:21], v2 offset:41184
    v_mfma_f32_16x16x32_bf16 v[48:51], v[8:11], v[32:35], v[48:51]
    ds_read_b64_tr_b16 v[22:23], v2 offset:41440
    v_mfma_f32_16x16x32_bf16 v[60:63], v[8:11], v[44:47], v[60:63]
    s_add_u32 s46, s46, 33792
    s_cmp_eq_u32 s46, 101376
    v_mfma_f32_16x16x32_bf16 v[56:59], v[8:11], v[40:43], v[56:59]
    s_cselect_b32 s47, s48, s49
    s_cselect_b32 s46, 0, s46
    s_waitcnt lgkmcnt(4)
    v_mfma_f32_16x16x32_bf16 v[72:75], v[12:15], v[40:43], v[72:75]
    v_add_u32 v1, s47, v1
    v_mfma_f32_16x16x32_bf16 v[76:79], v[12:15], v[44:47], v[76:79]
    v_mfma_f32_16x16x32_bf16 v[64:67], v[12:15], v[32:35], v[64:67]
    s_waitcnt lgkmcnt(0)
    s_barrier
    v_mfma_f32_16x16x32_bf16 v[68:71], v[12:15], v[36:39], v[68:71]
    ds_read_b64_tr_b16 v[8:9], v2 offset:4224
    ds_read_b64_tr_b16 v[10:11], v2 offset:4480
    v_mfma_f32_16x16x32_bf16 v[88:91], v[16:19], v[40:43], v[88:91]
    ds_read_b128 v[24:27], v1 offset:0
    ds_read_b128 v[28:31], v1 offset:512
    v_mfma_f32_16x16x32_bf16 v[92:95], v[16:19], v[44:47], v[92:95]
    ds_read_b64_tr_b16 v[12:13], v2 offset:4256
    v_mfma_f32_16x16x32_bf16 v[108:111], v[20:23], v[44:47], v[108:111]
    ds_read_b64_tr_b16 v[14:15], v2 offset:4512
    v_mfma_f32_16x16x32_bf16 v[104:107], v[20:23], v[40:43], v[104:107]
    ds_read_b128 v[40:43], v1 offset:4224
    v_mfma_f32_16x16x32_bf16 v[100:103], v[20:23], v[36:39], v[100:103]
    ds_read_b128 v[44:47], v1 offset:4736
    v_mfma_f32_16x16x32_bf16 v[96:99], v[20:23], v[32:35], v[96:99]
    s_sub_u32 s45, s45, 1
    v_mfma_f32_16x16x32_bf16 v[80:83], v[16:19], v[32:35], v[80:83]
    s_cmp_lg_u32 s45, 0
    v_mfma_f32_16x16x32_bf16 v[84:87], v[16:19], v[36:39], v[84:87]
    s_cbranch_scc1 L_p1_86
    v_mov_b32 v5, 163832
    ds_read_b32 v6, v5
    v_add_u32 v5, 4294899712, v1
    s_waitcnt lgkmcnt(6)
    v_mfma_f32_16x16x32_bf16 v[112:115], v[8:11], v[24:27], v[112:115]
    ds_read_b64_tr_b16 v[16:17], v2 offset:4288
    ds_read_b64_tr_b16 v[18:19], v2 offset:4544
    s_waitcnt lgkmcnt(7)
    v_mfma_f32_16x16x32_bf16 v[116:119], v[8:11], v[28:31], v[116:119]
    ds_read_b64_tr_b16 v[20:21], v2 offset:4320
    ds_read_b64_tr_b16 v[22:23], v2 offset:4576
    s_waitcnt lgkmcnt(7)
    v_mfma_f32_16x16x32_bf16 v[132:135], v[12:15], v[28:31], v[132:135]
    ds_read_b128 v[32:35], v1 offset:64
    v_mfma_f32_16x16x32_bf16 v[128:131], v[12:15], v[24:27], v[128:131]
    ds_read_b128 v[36:39], v1 offset:576
    s_waitcnt lgkmcnt(8)
    v_mfma_f32_16x16x32_bf16 v[136:139], v[12:15], v[40:43], v[136:139]
    s_waitcnt lgkmcnt(7)
    v_mfma_f32_16x16x32_bf16 v[140:143], v[12:15], v[44:47], v[140:143]
    ds_read_b64_tr_b16 v[12:13], v2 offset:17952
    v_mfma_f32_16x16x32_bf16 v[124:127], v[8:11], v[44:47], v[124:127]
    ds_read_b64_tr_b16 v[14:15], v2 offset:18208
    v_mfma_f32_16x16x32_bf16 v[120:123], v[8:11], v[40:43], v[120:123]
    ds_read_b64_tr_b16 v[8:9], v2 offset:17920
    ds_read_b64_tr_b16 v[10:11], v2 offset:18176
    s_waitcnt lgkmcnt(8)
    v_mfma_f32_16x16x32_bf16 v[152:155], v[16:19], v[40:43], v[152:155]
    v_mfma_f32_16x16x32_bf16 v[156:159], v[16:19], v[44:47], v[156:159]
    s_waitcnt lgkmcnt(6)
    v_mfma_f32_16x16x32_bf16 v[172:175], v[20:23], v[44:47], v[172:175]
    ds_read_b128 v[44:47], v1 offset:4800
    v_mfma_f32_16x16x32_bf16 v[168:171], v[20:23], v[40:43], v[168:171]
    ds_read_b128 v[40:43], v1 offset:4288
    v_mfma_f32_16x16x32_bf16 v[164:167], v[20:23], v[28:31], v[164:167]
    v_mfma_f32_16x16x32_bf16 v[160:163], v[20:23], v[24:27], v[160:163]
    ds_read_b64_tr_b16 v[20:21], v2 offset:18016
    v_mfma_f32_16x16x32_bf16 v[144:147], v[16:19], v[24:27], v[144:147]
    ds_read_b64_tr_b16 v[22:23], v2 offset:18272
    v_mfma_f32_16x16x32_bf16 v[148:151], v[16:19], v[28:31], v[148:151]
    ds_read_b64_tr_b16 v[16:17], v2 offset:17984
    ds_read_b64_tr_b16 v[18:19], v2 offset:18240
    s_waitcnt lgkmcnt(6)
    v_mfma_f32_16x16x32_bf16 v[112:115], v[8:11], v[32:35], v[112:115]
    v_mfma_f32_16x16x32_bf16 v[116:119], v[8:11], v[36:39], v[116:119]
    v_mfma_f32_16x16x32_bf16 v[132:135], v[12:15], v[36:39], v[132:135]
    v_mfma_f32_16x16x32_bf16 v[128:131], v[12:15], v[32:35], v[128:131]
    s_barrier
    ds_read_b128 v[24:27], v5 offset:0
    s_waitcnt lgkmcnt(5)
    v_mfma_f32_16x16x32_bf16 v[136:139], v[12:15], v[40:43], v[136:139]
    ds_read_b128 v[28:31], v5 offset:512
    v_mfma_f32_16x16x32_bf16 v[140:143], v[12:15], v[44:47], v[140:143]
    ds_read_b64_tr_b16 v[12:13], v2 offset:31648
    v_mfma_f32_16x16x32_bf16 v[124:127], v[8:11], v[44:47], v[124:127]
    ds_read_b64_tr_b16 v[14:15], v2 offset:31904
    v_mfma_f32_16x16x32_bf16 v[120:123], v[8:11], v[40:43], v[120:123]
    ds_read_b64_tr_b16 v[8:9], v2 offset:31616
    ds_read_b64_tr_b16 v[10:11], v2 offset:31872
    s_waitcnt lgkmcnt(6)
    v_mfma_f32_16x16x32_bf16 v[152:155], v[16:19], v[40:43], v[152:155]
    v_mfma_f32_16x16x32_bf16 v[156:159], v[16:19], v[44:47], v[156:159]
    v_mfma_f32_16x16x32_bf16 v[172:175], v[20:23], v[44:47], v[172:175]
    ds_read_b128 v[44:47], v5 offset:4736
    v_mfma_f32_16x16x32_bf16 v[168:171], v[20:23], v[40:43], v[168:171]
    ds_read_b128 v[40:43], v5 offset:4224
    v_mfma_f32_16x16x32_bf16 v[164:167], v[20:23], v[36:39], v[164:167]
    v_mfma_f32_16x16x32_bf16 v[160:163], v[20:23], v[32:35], v[160:163]
    ds_read_b64_tr_b16 v[20:21], v2 offset:31712
    v_mfma_f32_16x16x32_bf16 v[144:147], v[16:19], v[32:35], v[144:147]
    ds_read_b64_tr_b16 v[22:23], v2 offset:31968
    v_mfma_f32_16x16x32_bf16 v[148:151], v[16:19], v[36:39], v[148:151]
    ds_read_b64_tr_b16 v[16:17], v2 offset:31680
    ds_read_b64_tr_b16 v[18:19], v2 offset:31936
    s_waitcnt lgkmcnt(6)
    v_mfma_f32_16x16x32_bf16 v[112:115], v[8:11], v[24:27], v[112:115]
    v_mfma_f32_16x16x32_bf16 v[116:119], v[8:11], v[28:31], v[116:119]
    v_mfma_f32_16x16x32_bf16 v[132:135], v[12:15], v[28:31], v[132:135]
    v_mfma_f32_16x16x32_bf16 v[128:131], v[12:15], v[24:27], v[128:131]
    s_waitcnt lgkmcnt(4)
    v_mfma_f32_16x16x32_bf16 v[136:139], v[12:15], v[40:43], v[136:139]
    v_mfma_f32_16x16x32_bf16 v[140:143], v[12:15], v[44:47], v[140:143]
    s_barrier
    ds_read_b128 v[32:35], v5 offset:64
    v_mfma_f32_16x16x32_bf16 v[124:127], v[8:11], v[44:47], v[124:127]
    ds_read_b128 v[36:39], v5 offset:576
    v_mfma_f32_16x16x32_bf16 v[120:123], v[8:11], v[40:43], v[120:123]
    ds_read_b64_tr_b16 v[8:9], v2 offset:45312
    ds_read_b64_tr_b16 v[10:11], v2 offset:45568
    s_waitcnt lgkmcnt(4)
    v_mfma_f32_16x16x32_bf16 v[152:155], v[16:19], v[40:43], v[152:155]
    ds_read_b64_tr_b16 v[12:13], v2 offset:45344
    v_mfma_f32_16x16x32_bf16 v[156:159], v[16:19], v[44:47], v[156:159]
    ds_read_b64_tr_b16 v[14:15], v2 offset:45600
    v_mfma_f32_16x16x32_bf16 v[172:175], v[20:23], v[44:47], v[172:175]
    ds_read_b128 v[44:47], v5 offset:4800
    v_mfma_f32_16x16x32_bf16 v[168:171], v[20:23], v[40:43], v[168:171]
    ds_read_b128 v[40:43], v5 offset:4288
    v_mfma_f32_16x16x32_bf16 v[164:167], v[20:23], v[28:31], v[164:167]
    v_mfma_f32_16x16x32_bf16 v[160:163], v[20:23], v[24:27], v[160:163]
    ds_read_b64_tr_b16 v[20:21], v2 offset:45408
    v_mfma_f32_16x16x32_bf16 v[144:147], v[16:19], v[24:27], v[144:147]
    ds_read_b64_tr_b16 v[22:23], v2 offset:45664
    v_mfma_f32_16x16x32_bf16 v[148:151], v[16:19], v[28:31], v[148:151]
    ds_read_b64_tr_b16 v[16:17], v2 offset:45376
    ds_read_b64_tr_b16 v[18:19], v2 offset:45632
    s_waitcnt lgkmcnt(8)
    v_mfma_f32_16x16x32_bf16 v[112:115], v[8:11], v[32:35], v[112:115]
    v_mfma_f32_16x16x32_bf16 v[116:119], v[8:11], v[36:39], v[116:119]
    s_waitcnt lgkmcnt(6)
    v_mfma_f32_16x16x32_bf16 v[132:135], v[12:15], v[36:39], v[132:135]
    ds_read_b128 v[24:27], v1 offset:0
    v_mfma_f32_16x16x32_bf16 v[128:131], v[12:15], v[32:35], v[128:131]
    ds_read_b128 v[28:31], v1 offset:512
    s_waitcnt lgkmcnt(6)
    v_mfma_f32_16x16x32_bf16 v[136:139], v[12:15], v[40:43], v[136:139]
    v_mfma_f32_16x16x32_bf16 v[140:143], v[12:15], v[44:47], v[140:143]
    ds_read_b64_tr_b16 v[12:13], v2 offset:8480
    v_mfma_f32_16x16x32_bf16 v[124:127], v[8:11], v[44:47], v[124:127]
    ds_read_b64_tr_b16 v[14:15], v2 offset:8736
    v_mfma_f32_16x16x32_bf16 v[120:123], v[8:11], v[40:43], v[120:123]
    ds_read_b64_tr_b16 v[8:9], v2 offset:8448
    ds_read_b64_tr_b16 v[10:11], v2 offset:8704
    s_waitcnt lgkmcnt(6)
    v_mfma_f32_16x16x32_bf16 v[152:155], v[16:19], v[40:43], v[152:155]
    v_mfma_f32_16x16x32_bf16 v[156:159], v[16:19], v[44:47], v[156:159]
    v_mfma_f32_16x16x32_bf16 v[172:175], v[20:23], v[44:47], v[172:175]
    ds_read_b128 v[44:47], v1 offset:4736
    v_mfma_f32_16x16x32_bf16 v[168:171], v[20:23], v[40:43], v[168:171]
    ds_read_b128 v[40:43], v1 offset:4224
    v_mfma_f32_16x16x32_bf16 v[164:167], v[20:23], v[36:39], v[164:167]
    v_mfma_f32_16x16x32_bf16 v[160:163], v[20:23], v[32:35], v[160:163]
    ds_read_b64_tr_b16 v[20:21], v2 offset:8544
    v_mfma_f32_16x16x32_bf16 v[144:147], v[16:19], v[32:35], v[144:147]
    ds_read_b64_tr_b16 v[22:23], v2 offset:8800
    v_mfma_f32_16x16x32_bf16 v[148:151], v[16:19], v[36:39], v[148:151]
    ds_read_b64_tr_b16 v[16:17], v2 offset:8512
    ds_read_b64_tr_b16 v[18:19], v2 offset:8768
    s_waitcnt lgkmcnt(6)
    v_mfma_f32_16x16x32_bf16 v[176:179], v[8:11], v[24:27], v[176:179]
    v_mfma_f32_16x16x32_bf16 v[180:183], v[8:11], v[28:31], v[180:183]
    v_mfma_f32_16x16x32_bf16 v[196:199], v[12:15], v[28:31], v[196:199]
    v_mfma_f32_16x16x32_bf16 v[192:195], v[12:15], v[24:27], v[192:195]
    v_xor_b32 v7, v6, v7
    v_readfirstlane_b32 s33, v6
    s_waitcnt lgkmcnt(4)
    v_mfma_f32_16x16x32_bf16 v[200:203], v[12:15], v[40:43], v[200:203]
    v_mov_b32 v6, 1
    s_xor_b32 s59, s59, s33
    v_mfma_f32_16x16x32_bf16 v[204:207], v[12:15], v[44:47], v[204:207]
    ds_read_b64_tr_b16 v[12:13], v2 offset:22144
    s_xor_b32 s60, s60, s33
    v_mfma_f32_16x16x32_bf16 v[188:191], v[8:11], v[44:47], v[188:191]
    ds_read_b64_tr_b16 v[14:15], v2 offset:22400
    v_cvt_pk_bf16_f32 v120, v120, v121
    v_mfma_f32_16x16x32_bf16 v[184:187], v[8:11], v[40:43], v[184:187]
    ds_read_b64_tr_b16 v[8:9], v3 offset:0
    ds_read_b64_tr_b16 v[10:11], v3 offset:256
    s_waitcnt lgkmcnt(4)
    v_mfma_f32_16x16x32_bf16 v[216:219], v[16:19], v[40:43], v[216:219]
    ds_read_b128 v[32:35], v1 offset:64
    v_cvt_pk_bf16_f32 v121, v122, v123
    v_mfma_f32_16x16x32_bf16 v[220:223], v[16:19], v[44:47], v[220:223]
    ds_read_b128 v[36:39], v1 offset:576
    v_cvt_pk_bf16_f32 v122, v136, v137
    v_mfma_f32_16x16x32_bf16 v[208:211], v[16:19], v[24:27], v[208:211]
    v_cvt_pk_bf16_f32 v123, v138, v139
    v_pk_max_i16 v120, v120, 0
    v_mfma_f32_16x16x32_bf16 v[212:215], v[16:19], v[28:31], v[212:215]
    ds_read_b64_tr_b16 v[16:17], v2 offset:22176
    v_pk_max_i16 v121, v121, 0
    v_mfma_f32_16x16x32_bf16 v[232:235], v[20:23], v[40:43], v[232:235]
    ds_read_b64_tr_b16 v[18:19], v2 offset:22432
    v_pk_max_i16 v122, v122, 0
    v_mfma_f32_16x16x32_bf16 v[236:239], v[20:23], v[44:47], v[236:239]
    v_pk_max_i16 v123, v123, 0
    v_cvt_pk_bf16_f32 v152, v152, v153
    s_waitcnt lgkmcnt(4)
    v_mfma_f32_16x16x32_bf16 v[252:255], v[8:11], v[44:47], v[252:255]
    ds_read_b128 v[44:47], v1 offset:4800
    s_add_u32 s56, s55, 16384
    buffer_store_dwordx4 v[120:123], v7, s[20:23], s56 offen offset:0 sc1
    v_mfma_f32_16x16x32_bf16 v[248:251], v[8:11], v[40:43], v[248:251]
    ds_read_b128 v[40:43], v1 offset:4288
    v_cvt_pk_bf16_f32 v153, v154, v155
    v_mfma_f32_16x16x32_bf16 v[244:247], v[8:11], v[28:31], v[244:247]
    v_cvt_pk_bf16_f32 v154, v168, v169
    v_cvt_pk_bf16_f32 v155, v170, v171
    v_mfma_f32_16x16x32_bf16 v[240:243], v[8:11], v[24:27], v[240:243]
    ds_read_b64_tr_b16 v[8:9], v2 offset:22240
    v_pk_max_i16 v152, v152, 0
    v_mfma_f32_16x16x32_bf16 v[224:227], v[20:23], v[24:27], v[224:227]
    ds_read_b64_tr_b16 v[10:11], v2 offset:22496
    v_pk_max_i16 v153, v153, 0
    v_mfma_f32_16x16x32_bf16 v[228:231], v[20:23], v[28:31], v[228:231]
    ds_read_b64_tr_b16 v[20:21], v2 offset:22208
    ds_read_b64_tr_b16 v[22:23], v2 offset:22464
    s_waitcnt lgkmcnt(9)
    v_mfma_f32_16x16x32_bf16 v[176:179], v[12:15], v[32:35], v[176:179]
    v_pk_max_i16 v154, v154, 0
    v_pk_max_i16 v155, v155, 0
    s_waitcnt lgkmcnt(8)
    v_mfma_f32_16x16x32_bf16 v[180:183], v[12:15], v[36:39], v[180:183]
    v_cvt_pk_bf16_f32 v124, v124, v125
    v_cvt_pk_bf16_f32 v125, v126, v127
    s_waitcnt lgkmcnt(6)
    v_mfma_f32_16x16x32_bf16 v[196:199], v[16:19], v[36:39], v[196:199]
    v_cvt_pk_bf16_f32 v126, v140, v141
    v_cvt_pk_bf16_f32 v127, v142, v143
    v_mfma_f32_16x16x32_bf16 v[192:195], v[16:19], v[32:35], v[192:195]
    v_pk_max_i16 v124, v124, 0
    v_pk_max_i16 v125, v125, 0
    s_waitcnt lgkmcnt(4)
    v_mfma_f32_16x16x32_bf16 v[200:203], v[16:19], v[40:43], v[200:203]
    v_pk_max_i16 v126, v126, 0
    v_pk_max_i16 v127, v127, 0
    v_mfma_f32_16x16x32_bf16 v[204:207], v[16:19], v[44:47], v[204:207]
    ds_read_b64_tr_b16 v[16:17], v2 offset:35840
    v_cvt_pk_bf16_f32 v156, v156, v157
    v_mfma_f32_16x16x32_bf16 v[188:191], v[12:15], v[44:47], v[188:191]
    ds_read_b64_tr_b16 v[18:19], v2 offset:36096
    s_add_u32 s56, s55, 16384
    buffer_store_dwordx4 v[152:155], v7, s[20:23], s56 offen offset:2048 sc1
    v_mfma_f32_16x16x32_bf16 v[184:187], v[12:15], v[40:43], v[184:187]
    ds_read_b64_tr_b16 v[12:13], v3 offset:13696
    ds_read_b64_tr_b16 v[14:15], v3 offset:13952
    s_waitcnt lgkmcnt(4)
    v_mfma_f32_16x16x32_bf16 v[216:219], v[20:23], v[40:43], v[216:219]
    ds_read_b128 v[24:27], v5 offset:0
    v_cvt_pk_bf16_f32 v157, v158, v159
    v_mfma_f32_16x16x32_bf16 v[220:223], v[20:23], v[44:47], v[220:223]
    ds_read_b128 v[28:31], v5 offset:512
    v_cvt_pk_bf16_f32 v158, v172, v173
    v_mfma_f32_16x16x32_bf16 v[208:211], v[20:23], v[32:35], v[208:211]
    v_cvt_pk_bf16_f32 v159, v174, v175
    v_pk_max_i16 v156, v156, 0
    v_mfma_f32_16x16x32_bf16 v[212:215], v[20:23], v[36:39], v[212:215]
    ds_read_b64_tr_b16 v[20:21], v2 offset:35872
    v_pk_max_i16 v157, v157, 0
    v_mfma_f32_16x16x32_bf16 v[232:235], v[8:11], v[40:43], v[232:235]
    ds_read_b64_tr_b16 v[22:23], v2 offset:36128
    v_pk_max_i16 v158, v158, 0
    v_mfma_f32_16x16x32_bf16 v[236:239], v[8:11], v[44:47], v[236:239]
    v_pk_max_i16 v159, v159, 0
    v_cvt_pk_bf16_f32 v112, v112, v113
    s_waitcnt lgkmcnt(4)
    v_mfma_f32_16x16x32_bf16 v[252:255], v[12:15], v[44:47], v[252:255]
    ds_read_b128 v[44:47], v5 offset:4736
    v_cvt_pk_bf16_f32 v113, v114, v115
    v_mfma_f32_16x16x32_bf16 v[248:251], v[12:15], v[40:43], v[248:251]
    ds_read_b128 v[40:43], v5 offset:4224
    v_cvt_pk_bf16_f32 v114, v128, v129
    v_mfma_f32_16x16x32_bf16 v[244:247], v[12:15], v[36:39], v[244:247]
    v_cvt_pk_bf16_f32 v115, v130, v131
    v_pk_max_i16 v112, v112, 0
    v_mfma_f32_16x16x32_bf16 v[240:243], v[12:15], v[32:35], v[240:243]
    ds_read_b64_tr_b16 v[12:13], v2 offset:35936
    v_pk_max_i16 v113, v113, 0
    v_mfma_f32_16x16x32_bf16 v[224:227], v[8:11], v[32:35], v[224:227]
    ds_read_b64_tr_b16 v[14:15], v2 offset:36192
    s_add_u32 s56, s55, 20480
    buffer_store_dwordx4 v[124:127], v7, s[20:23], s56 offen offset:0 sc1
    v_mfma_f32_16x16x32_bf16 v[228:231], v[8:11], v[36:39], v[228:231]
    ds_read_b64_tr_b16 v[8:9], v2 offset:35904
    ds_read_b64_tr_b16 v[10:11], v2 offset:36160
    s_waitcnt lgkmcnt(9)
    v_mfma_f32_16x16x32_bf16 v[176:179], v[16:19], v[24:27], v[176:179]
    v_pk_max_i16 v114, v114, 0
    v_pk_max_i16 v115, v115, 0
    s_waitcnt lgkmcnt(8)
    v_mfma_f32_16x16x32_bf16 v[180:183], v[16:19], v[28:31], v[180:183]
    v_cvt_pk_bf16_f32 v144, v144, v145
    v_cvt_pk_bf16_f32 v145, v146, v147
    s_waitcnt lgkmcnt(6)
    v_mfma_f32_16x16x32_bf16 v[196:199], v[20:23], v[28:31], v[196:199]
    v_cvt_pk_bf16_f32 v146, v160, v161
    v_cvt_pk_bf16_f32 v147, v162, v163
    v_mfma_f32_16x16x32_bf16 v[192:195], v[20:23], v[24:27], v[192:195]
    v_pk_max_i16 v144, v144, 0
    v_pk_max_i16 v145, v145, 0
    s_waitcnt lgkmcnt(4)
    v_mfma_f32_16x16x32_bf16 v[200:203], v[20:23], v[40:43], v[200:203]
    v_pk_max_i16 v146, v146, 0
    v_pk_max_i16 v147, v147, 0
    v_mfma_f32_16x16x32_bf16 v[204:207], v[20:23], v[44:47], v[204:207]
    ds_read_b64_tr_b16 v[20:21], v2 offset:49536
    v_cvt_pk_bf16_f32 v116, v116, v117
    v_mfma_f32_16x16x32_bf16 v[188:191], v[16:19], v[44:47], v[188:191]
    ds_read_b64_tr_b16 v[22:23], v2 offset:49792
    v_cvt_pk_bf16_f32 v117, v118, v119
    v_mfma_f32_16x16x32_bf16 v[184:187], v[16:19], v[40:43], v[184:187]
    ds_read_b64_tr_b16 v[16:17], v3 offset:27392
    ds_read_b64_tr_b16 v[18:19], v3 offset:27648
    s_waitcnt lgkmcnt(4)
    v_mfma_f32_16x16x32_bf16 v[216:219], v[8:11], v[40:43], v[216:219]
    ds_read_b128 v[32:35], v5 offset:64
    v_cvt_pk_bf16_f32 v118, v132, v133
    v_mfma_f32_16x16x32_bf16 v[220:223], v[8:11], v[44:47], v[220:223]
    ds_read_b128 v[36:39], v5 offset:576
    v_cvt_pk_bf16_f32 v119, v134, v135
    v_mfma_f32_16x16x32_bf16 v[208:211], v[8:11], v[24:27], v[208:211]
    s_add_u32 s56, s55, 20480
    buffer_store_dwordx4 v[156:159], v7, s[20:23], s56 offen offset:2048 sc1
    v_mfma_f32_16x16x32_bf16 v[212:215], v[8:11], v[28:31], v[212:215]
    ds_read_b64_tr_b16 v[8:9], v2 offset:49568
    v_pk_max_i16 v116, v116, 0
    v_mfma_f32_16x16x32_bf16 v[232:235], v[12:15], v[40:43], v[232:235]
    ds_read_b64_tr_b16 v[10:11], v2 offset:49824
    v_pk_max_i16 v117, v117, 0
    v_mfma_f32_16x16x32_bf16 v[236:239], v[12:15], v[44:47], v[236:239]
    v_pk_max_i16 v118, v118, 0
    v_pk_max_i16 v119, v119, 0
    s_waitcnt lgkmcnt(4)
    v_mfma_f32_16x16x32_bf16 v[252:255], v[16:19], v[44:47], v[252:255]
    ds_read_b128 v[44:47], v5 offset:4800
    v_cvt_pk_bf16_f32 v148, v148, v149
    v_mfma_f32_16x16x32_bf16 v[248:251], v[16:19], v[40:43], v[248:251]
    ds_read_b128 v[40:43], v5 offset:4288
    v_cvt_pk_bf16_f32 v149, v150, v151
    v_mfma_f32_16x16x32_bf16 v[244:247], v[16:19], v[28:31], v[244:247]
    v_cvt_pk_bf16_f32 v150, v164, v165
    v_cvt_pk_bf16_f32 v151, v166, v167
    v_mfma_f32_16x16x32_bf16 v[240:243], v[16:19], v[24:27], v[240:243]
    ds_read_b64_tr_b16 v[16:17], v2 offset:49632
    v_pk_max_i16 v148, v148, 0
    v_mfma_f32_16x16x32_bf16 v[224:227], v[12:15], v[24:27], v[224:227]
    ds_read_b64_tr_b16 v[18:19], v2 offset:49888
    v_pk_max_i16 v149, v149, 0
    v_mfma_f32_16x16x32_bf16 v[228:231], v[12:15], v[28:31], v[228:231]
    ds_read_b64_tr_b16 v[12:13], v2 offset:49600
    ds_read_b64_tr_b16 v[14:15], v2 offset:49856
    s_waitcnt lgkmcnt(9)
    v_mfma_f32_16x16x32_bf16 v[176:179], v[20:23], v[32:35], v[176:179]
    v_pk_max_i16 v150, v150, 0
    v_pk_max_i16 v151, v151, 0
    s_waitcnt lgkmcnt(8)
    v_mfma_f32_16x16x32_bf16 v[180:183], v[20:23], v[36:39], v[180:183]
    s_waitcnt lgkmcnt(6)
    v_mfma_f32_16x16x32_bf16 v[196:199], v[8:11], v[36:39], v[196:199]
    s_add_u32 s56, s55, 0
    buffer_store_dwordx4 v[112:115], v7, s[20:23], s56 offen offset:0 sc1
    v_mfma_f32_16x16x32_bf16 v[192:195], v[8:11], v[32:35], v[192:195]
    s_waitcnt lgkmcnt(4)
    v_mfma_f32_16x16x32_bf16 v[200:203], v[8:11], v[40:43], v[200:203]
    v_mfma_f32_16x16x32_bf16 v[204:207], v[8:11], v[44:47], v[204:207]
    ds_read_b64_tr_b16 v[8:9], v2 offset:0
    v_mfma_f32_16x16x32_bf16 v[188:191], v[20:23], v[44:47], v[188:191]
    ds_read_b64_tr_b16 v[10:11], v2 offset:256
    v_mfma_f32_16x16x32_bf16 v[184:187], v[20:23], v[40:43], v[184:187]
    ds_read_b64_tr_b16 v[20:21], v3 offset:41088
    ds_read_b64_tr_b16 v[22:23], v3 offset:41344
    s_waitcnt lgkmcnt(4)
    v_mfma_f32_16x16x32_bf16 v[216:219], v[12:15], v[40:43], v[216:219]
    ds_read_b128 v[24:27], v1 offset:0
    v_mfma_f32_16x16x32_bf16 v[220:223], v[12:15], v[44:47], v[220:223]
    ds_read_b128 v[28:31], v1 offset:512
    v_mfma_f32_16x16x32_bf16 v[208:211], v[12:15], v[32:35], v[208:211]
    v_mfma_f32_16x16x32_bf16 v[212:215], v[12:15], v[36:39], v[212:215]
    ds_read_b64_tr_b16 v[12:13], v2 offset:32
    v_mfma_f32_16x16x32_bf16 v[232:235], v[16:19], v[40:43], v[232:235]
    ds_read_b64_tr_b16 v[14:15], v2 offset:288
    v_mfma_f32_16x16x32_bf16 v[236:239], v[16:19], v[44:47], v[236:239]
    s_waitcnt lgkmcnt(4)
    v_mfma_f32_16x16x32_bf16 v[252:255], v[20:23], v[44:47], v[252:255]
    ds_read_b128 v[44:47], v1 offset:4736
    s_add_u32 s56, s55, 0
    buffer_store_dwordx4 v[144:147], v7, s[20:23], s56 offen offset:2048 sc1
    v_mfma_f32_16x16x32_bf16 v[248:251], v[20:23], v[40:43], v[248:251]
    ds_read_b128 v[40:43], v1 offset:4224
    v_mfma_f32_16x16x32_bf16 v[244:247], v[20:23], v[36:39], v[244:247]
    v_mfma_f32_16x16x32_bf16 v[240:243], v[20:23], v[32:35], v[240:243]
    ds_read_b64_tr_b16 v[20:21], v2 offset:96
    v_mfma_f32_16x16x32_bf16 v[224:227], v[16:19], v[32:35], v[224:227]
    ds_read_b64_tr_b16 v[22:23], v2 offset:352
    v_mfma_f32_16x16x32_bf16 v[228:231], v[16:19], v[36:39], v[228:231]
    ds_read_b64_tr_b16 v[16:17], v2 offset:64
    ds_read_b64_tr_b16 v[18:19], v2 offset:320
    s_waitcnt lgkmcnt(9)
    v_mfma_f32_16x16x32_bf16 v[48:51], v[8:11], v[24:27], v[48:51]
    s_waitcnt lgkmcnt(8)
    v_mfma_f32_16x16x32_bf16 v[52:55], v[8:11], v[28:31], v[52:55]
    s_waitcnt lgkmcnt(6)
    v_mfma_f32_16x16x32_bf16 v[68:71], v[12:15], v[28:31], v[68:71]
    ds_read_b128 v[32:35], v1 offset:64
    v_mfma_f32_16x16x32_bf16 v[64:67], v[12:15], v[24:27], v[64:67]
    ds_read_b128 v[36:39], v1 offset:576
    v_bfe_u32 v3, v0, 4, 1
    v_mul_u32_u24 v3, 3584, v3
    s_waitcnt lgkmcnt(6)
    v_mfma_f32_16x16x32_bf16 v[72:75], v[12:15], v[40:43], v[72:75]
    v_lshrrev_b32 v128, 5, v0
    v_lshlrev_b32 v128, 9, v128
    v_sub_u32 v3, v3, v128
    v_mfma_f32_16x16x32_bf16 v[76:79], v[12:15], v[44:47], v[76:79]
    ds_read_b64_tr_b16 v[12:13], v2 offset:13728
    v_add_u32 v3, v3, v7
    v_cvt_pk_bf16_f32 v248, v248, v249
    v_mfma_f32_16x16x32_bf16 v[60:63], v[8:11], v[44:47], v[60:63]
    ds_read_b64_tr_b16 v[14:15], v2 offset:13984
    s_add_u32 s56, s55, 4096
    buffer_store_dwordx4 v[116:119], v7, s[20:23], s56 offen offset:0 sc1
    v_mfma_f32_16x16x32_bf16 v[56:59], v[8:11], v[40:43], v[56:59]
    ds_read_b64_tr_b16 v[8:9], v2 offset:13696
    ds_read_b64_tr_b16 v[10:11], v2 offset:13952
    v_cvt_pk_bf16_f32 v249, v250, v251
    s_waitcnt lgkmcnt(6)
    v_mfma_f32_16x16x32_bf16 v[88:91], v[16:19], v[40:43], v[88:91]
    v_cvt_pk_bf16_f32 v250, v252, v253
    v_cvt_pk_bf16_f32 v251, v254, v255
    v_pk_max_i16 v248, v248, 0
    v_mfma_f32_16x16x32_bf16 v[92:95], v[16:19], v[44:47], v[92:95]
    v_pk_max_i16 v249, v249, 0
    v_pk_max_i16 v250, v250, 0
    v_pk_max_i16 v251, v251, 0
    v_mfma_f32_16x16x32_bf16 v[108:111], v[20:23], v[44:47], v[108:111]
    ds_read_b128 v[44:47], v1 offset:4800
    v_cvt_pk_bf16_f32 v240, v240, v241
    v_cvt_pk_bf16_f32 v241, v242, v243
    v_mfma_f32_16x16x32_bf16 v[104:107], v[20:23], v[40:43], v[104:107]
    ds_read_b128 v[40:43], v1 offset:4288
    v_cvt_pk_bf16_f32 v242, v244, v245
    v_cvt_pk_bf16_f32 v243, v246, v247
    v_mfma_f32_16x16x32_bf16 v[100:103], v[20:23], v[28:31], v[100:103]
    v_pk_max_i16 v240, v240, 0
    v_pk_max_i16 v241, v241, 0
    v_pk_max_i16 v242, v242, 0
    v_mfma_f32_16x16x32_bf16 v[96:99], v[20:23], v[24:27], v[96:99]
    ds_read_b64_tr_b16 v[20:21], v2 offset:13792
    v_pk_max_i16 v243, v243, 0
    s_nop 1
    v_permlane16_swap_b32 v248, v250
    v_mfma_f32_16x16x32_bf16 v[80:83], v[16:19], v[24:27], v[80:83]
    ds_read_b64_tr_b16 v[22:23], v2 offset:14048
    v_permlane16_swap_b32 v249, v251
    buffer_store_dwordx4 v[248:251], v3, s[20:23], s67 offen sc1
    v_mfma_f32_16x16x32_bf16 v[84:87], v[16:19], v[28:31], v[84:87]
    ds_read_b64_tr_b16 v[16:17], v2 offset:13760
    ds_read_b64_tr_b16 v[18:19], v2 offset:14016
    s_nop 1
    v_permlane16_swap_b32 v240, v242
    s_waitcnt lgkmcnt(6)
    v_mfma_f32_16x16x32_bf16 v[48:51], v[8:11], v[32:35], v[48:51]
    v_permlane16_swap_b32 v241, v243
    buffer_store_dwordx4 v[240:243], v3, s[20:23], s66 offen sc1
    v_cvt_pk_bf16_f32 v184, v184, v185
    v_mfma_f32_16x16x32_bf16 v[52:55], v[8:11], v[36:39], v[52:55]
    v_cvt_pk_bf16_f32 v185, v186, v187
    v_cvt_pk_bf16_f32 v186, v200, v201
    v_cvt_pk_bf16_f32 v187, v202, v203
    v_mfma_f32_16x16x32_bf16 v[68:71], v[12:15], v[36:39], v[68:71]
    ds_read_b128 v[24:27], v5 offset:0
    s_add_u32 s56, s55, 4096
    buffer_store_dwordx4 v[148:151], v7, s[20:23], s56 offen offset:2048 sc1
    v_mfma_f32_16x16x32_bf16 v[64:67], v[12:15], v[32:35], v[64:67]
    ds_read_b128 v[28:31], v5 offset:512
    v_pk_max_i16 v184, v184, 0
    v_pk_max_i16 v185, v185, 0
    s_waitcnt lgkmcnt(6)
    v_mfma_f32_16x16x32_bf16 v[72:75], v[12:15], v[40:43], v[72:75]
    v_pk_max_i16 v186, v186, 0
    v_pk_max_i16 v187, v187, 0
    v_cvt_pk_bf16_f32 v216, v216, v217
    v_mfma_f32_16x16x32_bf16 v[76:79], v[12:15], v[44:47], v[76:79]
    ds_read_b64_tr_b16 v[12:13], v2 offset:27424
    v_cvt_pk_bf16_f32 v217, v218, v219
    v_cvt_pk_bf16_f32 v218, v232, v233
    v_mfma_f32_16x16x32_bf16 v[60:63], v[8:11], v[44:47], v[60:63]
    ds_read_b64_tr_b16 v[14:15], v2 offset:27680
    v_cvt_pk_bf16_f32 v219, v234, v235
    v_pk_max_i16 v216, v216, 0
    v_mfma_f32_16x16x32_bf16 v[56:59], v[8:11], v[40:43], v[56:59]
    ds_read_b64_tr_b16 v[8:9], v2 offset:27392
    ds_read_b64_tr_b16 v[10:11], v2 offset:27648
    v_pk_max_i16 v217, v217, 0
    s_waitcnt lgkmcnt(6)
    v_mfma_f32_16x16x32_bf16 v[88:91], v[16:19], v[40:43], v[88:91]
    v_pk_max_i16 v218, v218, 0
    v_pk_max_i16 v219, v219, 0
    v_cvt_pk_bf16_f32 v188, v188, v189
    v_mfma_f32_16x16x32_bf16 v[92:95], v[16:19], v[44:47], v[92:95]
    v_cvt_pk_bf16_f32 v189, v190, v191
    v_cvt_pk_bf16_f32 v190, v204, v205
    v_cvt_pk_bf16_f32 v191, v206, v207
    v_mfma_f32_16x16x32_bf16 v[108:111], v[20:23], v[44:47], v[108:111]
    ds_read_b128 v[44:47], v5 offset:4736
    v_pk_max_i16 v188, v188, 0
    v_pk_max_i16 v189, v189, 0
    v_mfma_f32_16x16x32_bf16 v[104:107], v[20:23], v[40:43], v[104:107]
    ds_read_b128 v[40:43], v5 offset:4224
    v_pk_max_i16 v190, v190, 0
    v_pk_max_i16 v191, v191, 0
    v_mfma_f32_16x16x32_bf16 v[100:103], v[20:23], v[36:39], v[100:103]
    v_cvt_pk_bf16_f32 v220, v220, v221
    v_cvt_pk_bf16_f32 v221, v222, v223
    v_cvt_pk_bf16_f32 v222, v236, v237
    v_mfma_f32_16x16x32_bf16 v[96:99], v[20:23], v[32:35], v[96:99]
    s_barrier
    ds_read_b64_tr_b16 v[20:21], v2 offset:27488
    v_cvt_pk_bf16_f32 v223, v238, v239
    v_mfma_f32_16x16x32_bf16 v[80:83], v[16:19], v[32:35], v[80:83]
    ds_read_b64_tr_b16 v[22:23], v2 offset:27744
    v_pk_max_i16 v220, v220, 0
    v_pk_max_i16 v221, v221, 0
    v_mfma_f32_16x16x32_bf16 v[84:87], v[16:19], v[36:39], v[84:87]
    ds_read_b64_tr_b16 v[16:17], v2 offset:27456
    ds_read_b64_tr_b16 v[18:19], v2 offset:27712
    v_pk_max_i16 v222, v222, 0
    s_waitcnt lgkmcnt(6)
    v_mfma_f32_16x16x32_bf16 v[48:51], v[8:11], v[24:27], v[48:51]
    v_pk_max_i16 v223, v223, 0
    v_cvt_pk_bf16_f32 v176, v176, v177
    v_cvt_pk_bf16_f32 v177, v178, v179
    v_mfma_f32_16x16x32_bf16 v[52:55], v[8:11], v[28:31], v[52:55]
    v_cvt_pk_bf16_f32 v178, v192, v193
    v_cvt_pk_bf16_f32 v179, v194, v195
    v_pk_max_i16 v176, v176, 0
    v_mfma_f32_16x16x32_bf16 v[68:71], v[12:15], v[28:31], v[68:71]
    ds_read_b128 v[32:35], v5 offset:64
    v_pk_max_i16 v177, v177, 0
    v_pk_max_i16 v178, v178, 0
    v_mfma_f32_16x16x32_bf16 v[64:67], v[12:15], v[24:27], v[64:67]
    ds_read_b128 v[36:39], v5 offset:576
    v_pk_max_i16 v179, v179, 0
    v_cvt_pk_bf16_f32 v208, v208, v209
    s_waitcnt lgkmcnt(6)
    v_mfma_f32_16x16x32_bf16 v[72:75], v[12:15], v[40:43], v[72:75]
    v_cvt_pk_bf16_f32 v209, v210, v211
    v_cvt_pk_bf16_f32 v210, v224, v225
    v_cvt_pk_bf16_f32 v211, v226, v227
    v_mfma_f32_16x16x32_bf16 v[76:79], v[12:15], v[44:47], v[76:79]
    ds_read_b64_tr_b16 v[12:13], v2 offset:41120
    v_pk_max_i16 v208, v208, 0
    v_pk_max_i16 v209, v209, 0
    v_mfma_f32_16x16x32_bf16 v[60:63], v[8:11], v[44:47], v[60:63]
    ds_read_b64_tr_b16 v[14:15], v2 offset:41376
    v_pk_max_i16 v210, v210, 0
    v_pk_max_i16 v211, v211, 0
    v_mfma_f32_16x16x32_bf16 v[56:59], v[8:11], v[40:43], v[56:59]
    ds_read_b64_tr_b16 v[8:9], v2 offset:41088
    ds_read_b64_tr_b16 v[10:11], v2 offset:41344
    v_cvt_pk_bf16_f32 v180, v180, v181
    s_waitcnt lgkmcnt(6)
    v_mfma_f32_16x16x32_bf16 v[88:91], v[16:19], v[40:43], v[88:91]
    v_cvt_pk_bf16_f32 v181, v182, v183
    v_cvt_pk_bf16_f32 v182, v196, v197
    v_cvt_pk_bf16_f32 v183, v198, v199
    v_mfma_f32_16x16x32_bf16 v[92:95], v[16:19], v[44:47], v[92:95]
    v_pk_max_i16 v180, v180, 0
    v_pk_max_i16 v181, v181, 0
    v_pk_max_i16 v182, v182, 0
    v_mfma_f32_16x16x32_bf16 v[108:111], v[20:23], v[44:47], v[108:111]
    ds_read_b128 v[44:47], v5 offset:4800
    v_pk_max_i16 v183, v183, 0
    v_cvt_pk_bf16_f32 v212, v212, v213
    v_mfma_f32_16x16x32_bf16 v[104:107], v[20:23], v[40:43], v[104:107]
    ds_read_b128 v[40:43], v5 offset:4288
    v_cvt_pk_bf16_f32 v213, v214, v215
    v_cvt_pk_bf16_f32 v214, v228, v229
    v_mfma_f32_16x16x32_bf16 v[100:103], v[20:23], v[28:31], v[100:103]
    v_cvt_pk_bf16_f32 v215, v230, v231
    v_pk_max_i16 v212, v212, 0
    v_pk_max_i16 v213, v213, 0
    v_mfma_f32_16x16x32_bf16 v[96:99], v[20:23], v[24:27], v[96:99]
    ds_read_b64_tr_b16 v[20:21], v2 offset:41184
    v_pk_max_i16 v214, v214, 0
    v_pk_max_i16 v215, v215, 0
    v_mfma_f32_16x16x32_bf16 v[80:83], v[16:19], v[24:27], v[80:83]
    ds_read_b64_tr_b16 v[22:23], v2 offset:41440
    v_mfma_f32_16x16x32_bf16 v[84:87], v[16:19], v[28:31], v[84:87]
    ds_read_b64_tr_b16 v[16:17], v2 offset:41152
    ds_read_b64_tr_b16 v[18:19], v2 offset:41408
    s_waitcnt lgkmcnt(6)
    v_mfma_f32_16x16x32_bf16 v[48:51], v[8:11], v[32:35], v[48:51]
    v_mfma_f32_16x16x32_bf16 v[52:55], v[8:11], v[36:39], v[52:55]
    v_mfma_f32_16x16x32_bf16 v[68:71], v[12:15], v[36:39], v[68:71]
    s_waitcnt vmcnt(0)
    s_mov_b64 exec, 1
    buffer_store_dword v6, off, s[20:23], s59 sc1
    s_mov_b64 exec, -1
    v_mfma_f32_16x16x32_bf16 v[64:67], v[12:15], v[32:35], v[64:67]
    s_waitcnt lgkmcnt(4)
    v_mfma_f32_16x16x32_bf16 v[72:75], v[12:15], v[40:43], v[72:75]
    v_mfma_f32_16x16x32_bf16 v[76:79], v[12:15], v[44:47], v[76:79]
    v_mfma_f32_16x16x32_bf16 v[60:63], v[8:11], v[44:47], v[60:63]
    v_mfma_f32_16x16x32_bf16 v[56:59], v[8:11], v[40:43], v[56:59]
    s_waitcnt lgkmcnt(0)
    v_mfma_f32_16x16x32_bf16 v[88:91], v[16:19], v[40:43], v[88:91]
    v_mfma_f32_16x16x32_bf16 v[92:95], v[16:19], v[44:47], v[92:95]
    v_mfma_f32_16x16x32_bf16 v[108:111], v[20:23], v[44:47], v[108:111]
    v_mfma_f32_16x16x32_bf16 v[104:107], v[20:23], v[40:43], v[104:107]
    s_barrier
    v_mfma_f32_16x16x32_bf16 v[100:103], v[20:23], v[36:39], v[100:103]
    v_mfma_f32_16x16x32_bf16 v[96:99], v[20:23], v[32:35], v[96:99]
    v_mfma_f32_16x16x32_bf16 v[80:83], v[16:19], v[32:35], v[80:83]
    v_mfma_f32_16x16x32_bf16 v[84:87], v[16:19], v[36:39], v[84:87]
    s_lshl_b32 s55, s3, 13
    v_add_u32 v5, s55, v4
    v_cvt_pk_bf16_f32 v56, v56, v57
    v_cvt_pk_bf16_f32 v57, v58, v59
    v_cvt_pk_bf16_f32 v58, v72, v73
    v_cvt_pk_bf16_f32 v59, v74, v75
    ds_write_b128 v5, v[56:59] offset:4096
    v_cvt_pk_bf16_f32 v60, v60, v61
    v_cvt_pk_bf16_f32 v61, v62, v63
    v_cvt_pk_bf16_f32 v62, v76, v77
    v_cvt_pk_bf16_f32 v63, v78, v79
    ds_write_b128 v5, v[60:63] offset:6144
    v_cvt_pk_bf16_f32 v48, v48, v49
    v_cvt_pk_bf16_f32 v49, v50, v51
    v_cvt_pk_bf16_f32 v50, v64, v65
    v_cvt_pk_bf16_f32 v51, v66, v67
    ds_write_b128 v5, v[48:51] offset:0
    v_cvt_pk_bf16_f32 v52, v52, v53
    v_cvt_pk_bf16_f32 v53, v54, v55
    v_cvt_pk_bf16_f32 v54, v68, v69
    v_cvt_pk_bf16_f32 v55, v70, v71
    ds_write_b128 v5, v[52:55] offset:2048
    v_cvt_pk_bf16_f32 v88, v88, v89
    v_cvt_pk_bf16_f32 v89, v90, v91
    v_cvt_pk_bf16_f32 v90, v104, v105
    v_cvt_pk_bf16_f32 v91, v106, v107
    ds_write_b128 v5, v[88:91] offset:5120
    v_cvt_pk_bf16_f32 v92, v92, v93
    v_cvt_pk_bf16_f32 v93, v94, v95
    v_cvt_pk_bf16_f32 v94, v108, v109
    v_cvt_pk_bf16_f32 v95, v110, v111
    ds_write_b128 v5, v[92:95] offset:7168
    v_cvt_pk_bf16_f32 v80, v80, v81
    v_cvt_pk_bf16_f32 v81, v82, v83
    v_cvt_pk_bf16_f32 v82, v96, v97
    v_cvt_pk_bf16_f32 v83, v98, v99
    ds_write_b128 v5, v[80:83] offset:1024
    v_cvt_pk_bf16_f32 v84, v84, v85
    v_cvt_pk_bf16_f32 v85, v86, v87
    v_cvt_pk_bf16_f32 v86, v100, v101
    v_cvt_pk_bf16_f32 v87, v102, v103
    ds_write_b128 v5, v[84:87] offset:3072
    v_add_u32 v1, s6, v7
    v_add_u32 v3, s7, v7
    s_mov_b32 s46, s8
    s_mov_b32 s45, s9
    v_add_u32 v2, 4294899712, v2
    s_sub_u32 s62, s62, s52
    s_add_u32 s63, s62, 4096
    s_cmp_lg_u32 s40, 0
    s_cbranch_scc1 L_mv_89
    v_mov_b64 v[24:25], v[112:113]
    v_mov_b64 v[26:27], v[114:115]
    v_mov_b64 v[28:29], v[116:117]
    v_mov_b64 v[30:31], v[118:119]
    v_mov_b64 v[32:33], v[120:121]
    v_mov_b64 v[34:35], v[122:123]
    v_mov_b64 v[36:37], v[124:125]
    v_mov_b64 v[38:39], v[126:127]
    v_mov_b64 v[112:113], v[144:145]
    v_mov_b64 v[114:115], v[146:147]
    v_mov_b64 v[116:117], v[148:149]
    v_mov_b64 v[118:119], v[150:151]
    v_mov_b64 v[120:121], v[152:153]
    v_mov_b64 v[122:123], v[154:155]
    v_mov_b64 v[124:125], v[156:157]
    v_mov_b64 v[126:127], v[158:159]
    s_branch L_mv_90
L_mv_89:
    v_mov_b64 v[24:25], v[120:121]
    v_mov_b64 v[26:27], v[122:123]
    v_mov_b64 v[28:29], v[124:125]
    v_mov_b64 v[30:31], v[126:127]
    v_mov_b64 v[32:33], v[112:113]
    v_mov_b64 v[34:35], v[114:115]
    v_mov_b64 v[36:37], v[116:117]
    v_mov_b64 v[38:39], v[118:119]
    v_mov_b64 v[112:113], v[152:153]
    v_mov_b64 v[114:115], v[154:155]
    v_mov_b64 v[116:117], v[156:157]
    v_mov_b64 v[118:119], v[158:159]
    v_mov_b64 v[120:121], v[144:145]
    v_mov_b64 v[122:123], v[146:147]
    v_mov_b64 v[124:125], v[148:149]
    v_mov_b64 v[126:127], v[150:151]
L_mv_90:
    s_waitcnt lgkmcnt(0)
    s_cmp_lg_u32 s40, 0
    s_cbranch_scc1 L_mv_87
    v_mov_b64 v[40:41], v[176:177]
    v_mov_b64 v[42:43], v[178:179]
    v_mov_b64 v[44:45], v[180:181]
    v_mov_b64 v[46:47], v[182:183]
    v_mov_b64 v[48:49], v[184:185]
    v_mov_b64 v[50:51], v[186:187]
    v_mov_b64 v[52:53], v[188:189]
    v_mov_b64 v[54:55], v[190:191]
    v_mov_b64 v[56:57], v[208:209]
    v_mov_b64 v[58:59], v[210:211]
    v_mov_b64 v[60:61], v[212:213]
    v_mov_b64 v[62:63], v[214:215]
    v_mov_b64 v[64:65], v[216:217]
    v_mov_b64 v[66:67], v[218:219]
    v_mov_b64 v[68:69], v[220:221]
    v_mov_b64 v[70:71], v[222:223]
    s_branch L_mv_88
L_mv_87:
    v_mov_b64 v[40:41], v[184:185]
    v_mov_b64 v[42:43], v[186:187]
    v_mov_b64 v[44:45], v[188:189]
    v_mov_b64 v[46:47], v[190:191]
    v_mov_b64 v[48:49], v[176:177]
    v_mov_b64 v[50:51], v[178:179]
    v_mov_b64 v[52:53], v[180:181]
    v_mov_b64 v[54:55], v[182:183]
    v_mov_b64 v[56:57], v[216:217]
    v_mov_b64 v[58:59], v[218:219]
    v_mov_b64 v[60:61], v[220:221]
    v_mov_b64 v[62:63], v[222:223]
    v_mov_b64 v[64:65], v[208:209]
    v_mov_b64 v[66:67], v[210:211]
    v_mov_b64 v[68:69], v[212:213]
    v_mov_b64 v[70:71], v[214:215]
L_mv_88:
    s_barrier
    ds_read_b64_tr_b16 v[8:9], v2 offset:8448
    ds_read_b64_tr_b16 v[10:11], v2 offset:8704
    ds_read_b64_tr_b16 v[12:13], v2 offset:8480
    ds_read_b64_tr_b16 v[14:15], v2 offset:8736
    ds_read_b64_tr_b16 v[16:17], v2 offset:8512
    ds_read_b64_tr_b16 v[18:19], v2 offset:8768
    s_waitcnt lgkmcnt(4)
    v_mfma_f32_16x16x32_bf16 v[192:195], v[8:11], v[24:27], 0
    ds_read_b64_tr_b16 v[20:21], v2 offset:8544
    buffer_store_dwordx4 v[40:43], v1, s[20:23], s62 offen offset:0 sc1
    v_mfma_f32_16x16x32_bf16 v[196:199], v[8:11], v[28:31], 0
    ds_read_b64_tr_b16 v[22:23], v2 offset:8800
    v_mfma_f32_16x16x32_bf16 v[200:203], v[8:11], v[32:35], 0
    v_mfma_f32_16x16x32_bf16 v[204:207], v[8:11], v[36:39], 0
    s_waitcnt lgkmcnt(4)
    v_mfma_f32_16x16x32_bf16 v[220:223], v[12:15], v[36:39], 0
    ds_read_b64_tr_b16 v[8:9], v2 offset:0
    v_mfma_f32_16x16x32_bf16 v[216:219], v[12:15], v[32:35], 0
    ds_read_b64_tr_b16 v[10:11], v2 offset:256
    v_mfma_f32_16x16x32_bf16 v[212:215], v[12:15], v[28:31], 0
    v_mfma_f32_16x16x32_bf16 v[208:211], v[12:15], v[24:27], 0
    s_waitcnt lgkmcnt(4)
    v_mfma_f32_16x16x32_bf16 v[224:227], v[16:19], v[24:27], 0
    ds_read_b64_tr_b16 v[12:13], v2 offset:32
    buffer_store_dwordx4 v[44:47], v1, s[20:23], s63 offen offset:0 sc1
    v_mfma_f32_16x16x32_bf16 v[228:231], v[16:19], v[28:31], 0
    ds_read_b64_tr_b16 v[14:15], v2 offset:288
    v_mfma_f32_16x16x32_bf16 v[232:235], v[16:19], v[32:35], 0
    v_mfma_f32_16x16x32_bf16 v[236:239], v[16:19], v[36:39], 0
    s_waitcnt lgkmcnt(4)
    v_mfma_f32_16x16x32_bf16 v[252:255], v[20:23], v[36:39], 0
    ds_read_b64_tr_b16 v[16:17], v2 offset:64
    v_mfma_f32_16x16x32_bf16 v[248:251], v[20:23], v[32:35], 0
    ds_read_b64_tr_b16 v[18:19], v2 offset:320
    v_mfma_f32_16x16x32_bf16 v[244:247], v[20:23], v[28:31], 0
    v_mfma_f32_16x16x32_bf16 v[240:243], v[20:23], v[24:27], 0
    s_waitcnt lgkmcnt(4)
    v_mfma_f32_16x16x32_bf16 v[128:131], v[8:11], v[24:27], 0
    ds_read_b64_tr_b16 v[20:21], v2 offset:96
    buffer_store_dwordx4 v[48:51], v3, s[20:23], s62 offen offset:0 sc1
    v_mfma_f32_16x16x32_bf16 v[132:135], v[8:11], v[28:31], 0
    ds_read_b64_tr_b16 v[22:23], v2 offset:352
    v_mfma_f32_16x16x32_bf16 v[136:139], v[8:11], v[32:35], 0
    v_mfma_f32_16x16x32_bf16 v[140:143], v[8:11], v[36:39], 0
    s_waitcnt lgkmcnt(4)
    v_mfma_f32_16x16x32_bf16 v[156:159], v[12:15], v[36:39], 0
    ds_read_b64_tr_b16 v[8:9], v2 offset:12672
    v_mfma_f32_16x16x32_bf16 v[152:155], v[12:15], v[32:35], 0
    ds_read_b64_tr_b16 v[10:11], v2 offset:12928
    v_mfma_f32_16x16x32_bf16 v[148:151], v[12:15], v[28:31], 0
    v_mfma_f32_16x16x32_bf16 v[144:147], v[12:15], v[24:27], 0
    s_waitcnt lgkmcnt(4)
    v_mfma_f32_16x16x32_bf16 v[160:163], v[16:19], v[24:27], 0
    ds_read_b64_tr_b16 v[12:13], v2 offset:12704
    buffer_store_dwordx4 v[52:55], v3, s[20:23], s63 offen offset:0 sc1
    v_mfma_f32_16x16x32_bf16 v[164:167], v[16:19], v[28:31], 0
    ds_read_b64_tr_b16 v[14:15], v2 offset:12960
    v_mfma_f32_16x16x32_bf16 v[168:171], v[16:19], v[32:35], 0
    v_mfma_f32_16x16x32_bf16 v[172:175], v[16:19], v[36:39], 0
    s_waitcnt lgkmcnt(4)
    v_mfma_f32_16x16x32_bf16 v[188:191], v[20:23], v[36:39], 0
    ds_read_b64_tr_b16 v[16:17], v2 offset:12736
    v_mfma_f32_16x16x32_bf16 v[184:187], v[20:23], v[32:35], 0
    ds_read_b64_tr_b16 v[18:19], v2 offset:12992
    v_mfma_f32_16x16x32_bf16 v[180:183], v[20:23], v[28:31], 0
    v_mfma_f32_16x16x32_bf16 v[176:179], v[20:23], v[24:27], 0
    s_waitcnt lgkmcnt(4)
    v_mfma_f32_16x16x32_bf16 v[192:195], v[8:11], v[112:115], v[192:195]
    ds_read_b64_tr_b16 v[20:21], v2 offset:12768
    s_bfe_u32 s54, s4, 0x40008
    v_mfma_f32_16x16x32_bf16 v[196:199], v[8:11], v[116:119], v[196:199]
    ds_read_b64_tr_b16 v[22:23], v2 offset:13024
    s_lshl_b32 s54, s54, 17
    v_mfma_f32_16x16x32_bf16 v[200:203], v[8:11], v[120:123], v[200:203]
    s_add_u32 s54, s54, s46
    buffer_store_dwordx4 v[56:59], v1, s[20:23], s62 offen offset:2048 sc1
    v_mfma_f32_16x16x32_bf16 v[204:207], v[8:11], v[124:127], v[204:207]
    s_add_u32 s53, s54, 4096
    s_waitcnt lgkmcnt(4)
    v_mfma_f32_16x16x32_bf16 v[220:223], v[12:15], v[124:127], v[220:223]
    ds_read_b64_tr_b16 v[8:9], v2 offset:4224
    v_mfma_f32_16x16x32_bf16 v[216:219], v[12:15], v[120:123], v[216:219]
    ds_read_b64_tr_b16 v[10:11], v2 offset:4480
    v_mfma_f32_16x16x32_bf16 v[212:215], v[12:15], v[116:119], v[212:215]
    v_mfma_f32_16x16x32_bf16 v[208:211], v[12:15], v[112:115], v[208:211]
    s_waitcnt lgkmcnt(4)
    v_mfma_f32_16x16x32_bf16 v[224:227], v[16:19], v[112:115], v[224:227]
    ds_read_b64_tr_b16 v[12:13], v2 offset:4256
    v_mfma_f32_16x16x32_bf16 v[228:231], v[16:19], v[116:119], v[228:231]
    ds_read_b64_tr_b16 v[14:15], v2 offset:4512
    buffer_store_dwordx4 v[60:63], v1, s[20:23], s63 offen offset:2048 sc1
    v_mfma_f32_16x16x32_bf16 v[232:235], v[16:19], v[120:123], v[232:235]
    v_mfma_f32_16x16x32_bf16 v[236:239], v[16:19], v[124:127], v[236:239]
    s_waitcnt lgkmcnt(4)
    v_mfma_f32_16x16x32_bf16 v[252:255], v[20:23], v[124:127], v[252:255]
    ds_read_b64_tr_b16 v[16:17], v2 offset:4288
    v_mfma_f32_16x16x32_bf16 v[248:251], v[20:23], v[120:123], v[248:251]
    ds_read_b64_tr_b16 v[18:19], v2 offset:4544
    v_mfma_f32_16x16x32_bf16 v[244:247], v[20:23], v[116:119], v[244:247]
    v_mfma_f32_16x16x32_bf16 v[240:243], v[20:23], v[112:115], v[240:243]
    s_waitcnt lgkmcnt(4)
    v_mfma_f32_16x16x32_bf16 v[128:131], v[8:11], v[112:115], v[128:131]
    ds_read_b64_tr_b16 v[20:21], v2 offset:4320
    v_mfma_f32_16x16x32_bf16 v[132:135], v[8:11], v[116:119], v[132:135]
    ds_read_b64_tr_b16 v[22:23], v2 offset:4576
    buffer_store_dwordx4 v[64:67], v3, s[20:23], s62 offen offset:2048 sc1
    v_mfma_f32_16x16x32_bf16 v[136:139], v[8:11], v[120:123], v[136:139]
    v_add_u32 v2, 16896, v2
    s_barrier
    v_mfma_f32_16x16x32_bf16 v[140:143], v[8:11], v[124:127], v[140:143]
    s_waitcnt lgkmcnt(4)
    v_mfma_f32_16x16x32_bf16 v[156:159], v[12:15], v[124:127], v[156:159]
    ds_read_b64_tr_b16 v[8:9], v2 offset:8448
    v_mfma_f32_16x16x32_bf16 v[152:155], v[12:15], v[120:123], v[152:155]
    ds_read_b64_tr_b16 v[10:11], v2 offset:8704
    buffer_load_dwordx4 v[24:27], v1, s[20:23], s54 offen offset:0 sc1
    v_mfma_f32_16x16x32_bf16 v[148:151], v[12:15], v[116:119], v[148:151]
    buffer_load_dwordx4 v[28:31], v1, s[20:23], s53 offen offset:0 sc1
    v_mfma_f32_16x16x32_bf16 v[144:147], v[12:15], v[112:115], v[144:147]
    s_waitcnt lgkmcnt(4)
    v_mfma_f32_16x16x32_bf16 v[160:163], v[16:19], v[112:115], v[160:163]
    ds_read_b64_tr_b16 v[12:13], v2 offset:8480
    buffer_store_dwordx4 v[68:71], v3, s[20:23], s63 offen offset:2048 sc1
    v_mfma_f32_16x16x32_bf16 v[164:167], v[16:19], v[116:119], v[164:167]
    ds_read_b64_tr_b16 v[14:15], v2 offset:8736
    buffer_load_dwordx4 v[32:35], v3, s[20:23], s54 offen offset:0 sc1
    v_mfma_f32_16x16x32_bf16 v[168:171], v[16:19], v[120:123], v[168:171]
    buffer_load_dwordx4 v[36:39], v3, s[20:23], s53 offen offset:0 sc1
    v_mfma_f32_16x16x32_bf16 v[172:175], v[16:19], v[124:127], v[172:175]
    s_waitcnt lgkmcnt(4)
    v_mfma_f32_16x16x32_bf16 v[188:191], v[20:23], v[124:127], v[188:191]
    ds_read_b64_tr_b16 v[16:17], v2 offset:8512
    v_mfma_f32_16x16x32_bf16 v[184:187], v[20:23], v[120:123], v[184:187]
    ds_read_b64_tr_b16 v[18:19], v2 offset:8768
    v_mfma_f32_16x16x32_bf16 v[180:183], v[20:23], v[116:119], v[180:183]
    v_mfma_f32_16x16x32_bf16 v[176:179], v[20:23], v[112:115], v[176:179]
    s_waitcnt lgkmcnt(4)
    v_mfma_f32_16x16x32_bf16 v[192:195], v[8:11], v[40:43], v[192:195]
    ds_read_b64_tr_b16 v[20:21], v2 offset:8544
    v_mfma_f32_16x16x32_bf16 v[196:199], v[8:11], v[44:47], v[196:199]
    ds_read_b64_tr_b16 v[22:23], v2 offset:8800
    v_mfma_f32_16x16x32_bf16 v[200:203], v[8:11], v[48:51], v[200:203]
    buffer_load_dwordx4 v[112:115], v1, s[20:23], s54 offen offset:2048 sc1
    v_mfma_f32_16x16x32_bf16 v[204:207], v[8:11], v[52:55], v[204:207]
    s_waitcnt lgkmcnt(4)
    v_mfma_f32_16x16x32_bf16 v[220:223], v[12:15], v[52:55], v[220:223]
    ds_read_b64_tr_b16 v[8:9], v2 offset:0
    v_mfma_f32_16x16x32_bf16 v[216:219], v[12:15], v[48:51], v[216:219]
    ds_read_b64_tr_b16 v[10:11], v2 offset:256
    v_mfma_f32_16x16x32_bf16 v[212:215], v[12:15], v[44:47], v[212:215]
    buffer_load_dwordx4 v[116:119], v1, s[20:23], s53 offen offset:2048 sc1
    v_mfma_f32_16x16x32_bf16 v[208:211], v[12:15], v[40:43], v[208:211]
    s_waitcnt lgkmcnt(4)
    v_mfma_f32_16x16x32_bf16 v[224:227], v[16:19], v[40:43], v[224:227]
    ds_read_b64_tr_b16 v[12:13], v2 offset:32
    v_mfma_f32_16x16x32_bf16 v[228:231], v[16:19], v[44:47], v[228:231]
    ds_read_b64_tr_b16 v[14:15], v2 offset:288
    v_mfma_f32_16x16x32_bf16 v[232:235], v[16:19], v[48:51], v[232:235]
    buffer_load_dwordx4 v[120:123], v3, s[20:23], s54 offen offset:2048 sc1
    v_mfma_f32_16x16x32_bf16 v[236:239], v[16:19], v[52:55], v[236:239]
    s_waitcnt lgkmcnt(4)
    v_mfma_f32_16x16x32_bf16 v[252:255], v[20:23], v[52:55], v[252:255]
    ds_read_b64_tr_b16 v[16:17], v2 offset:64
    v_mfma_f32_16x16x32_bf16 v[248:251], v[20:23], v[48:51], v[248:251]
    ds_read_b64_tr_b16 v[18:19], v2 offset:320
    v_mfma_f32_16x16x32_bf16 v[244:247], v[20:23], v[44:47], v[244:247]
    buffer_load_dwordx4 v[124:127], v3, s[20:23], s53 offen offset:2048 sc1
    v_mfma_f32_16x16x32_bf16 v[240:243], v[20:23], v[40:43], v[240:243]
    s_waitcnt lgkmcnt(4)
    v_mfma_f32_16x16x32_bf16 v[128:131], v[8:11], v[40:43], v[128:131]
    ds_read_b64_tr_b16 v[20:21], v2 offset:96
    v_mfma_f32_16x16x32_bf16 v[132:135], v[8:11], v[44:47], v[132:135]
    ds_read_b64_tr_b16 v[22:23], v2 offset:352
    v_mfma_f32_16x16x32_bf16 v[136:139], v[8:11], v[48:51], v[136:139]
    v_mfma_f32_16x16x32_bf16 v[140:143], v[8:11], v[52:55], v[140:143]
    s_waitcnt lgkmcnt(4)
    v_mfma_f32_16x16x32_bf16 v[156:159], v[12:15], v[52:55], v[156:159]
    ds_read_b64_tr_b16 v[8:9], v2 offset:12672
    v_mfma_f32_16x16x32_bf16 v[152:155], v[12:15], v[48:51], v[152:155]
    ds_read_b64_tr_b16 v[10:11], v2 offset:12928
    v_mfma_f32_16x16x32_bf16 v[148:151], v[12:15], v[44:47], v[148:151]
    v_mfma_f32_16x16x32_bf16 v[144:147], v[12:15], v[40:43], v[144:147]
    s_waitcnt lgkmcnt(4)
    v_mfma_f32_16x16x32_bf16 v[160:163], v[16:19], v[40:43], v[160:163]
    ds_read_b64_tr_b16 v[12:13], v2 offset:12704
    v_mfma_f32_16x16x32_bf16 v[164:167], v[16:19], v[44:47], v[164:167]
    ds_read_b64_tr_b16 v[14:15], v2 offset:12960
    v_mfma_f32_16x16x32_bf16 v[168:171], v[16:19], v[48:51], v[168:171]
    v_mfma_f32_16x16x32_bf16 v[172:175], v[16:19], v[52:55], v[172:175]
    s_waitcnt lgkmcnt(4)
    v_mfma_f32_16x16x32_bf16 v[188:191], v[20:23], v[52:55], v[188:191]
    ds_read_b64_tr_b16 v[16:17], v2 offset:12736
    v_mfma_f32_16x16x32_bf16 v[184:187], v[20:23], v[48:51], v[184:187]
    ds_read_b64_tr_b16 v[18:19], v2 offset:12992
    v_mfma_f32_16x16x32_bf16 v[180:183], v[20:23], v[44:47], v[180:183]
    v_mfma_f32_16x16x32_bf16 v[176:179], v[20:23], v[40:43], v[176:179]
    s_waitcnt lgkmcnt(4)
    v_mfma_f32_16x16x32_bf16 v[192:195], v[8:11], v[56:59], v[192:195]
    ds_read_b64_tr_b16 v[20:21], v2 offset:12768
    s_bfe_u32 s54, s4, 0x4000c
    v_mfma_f32_16x16x32_bf16 v[196:199], v[8:11], v[60:63], v[196:199]
    ds_read_b64_tr_b16 v[22:23], v2 offset:13024
    s_lshl_b32 s54, s54, 17
    v_mfma_f32_16x16x32_bf16 v[200:203], v[8:11], v[64:67], v[200:203]
    s_add_u32 s54, s54, s46
    v_mfma_f32_16x16x32_bf16 v[204:207], v[8:11], v[68:71], v[204:207]
    s_add_u32 s53, s54, 4096
    s_waitcnt lgkmcnt(4)
    v_mfma_f32_16x16x32_bf16 v[220:223], v[12:15], v[68:71], v[220:223]
    ds_read_b64_tr_b16 v[8:9], v2 offset:4224
    v_mfma_f32_16x16x32_bf16 v[216:219], v[12:15], v[64:67], v[216:219]
    ds_read_b64_tr_b16 v[10:11], v2 offset:4480
    v_mfma_f32_16x16x32_bf16 v[212:215], v[12:15], v[60:63], v[212:215]
    buffer_load_dwordx4 v[96:99], v1, s[20:23], s54 offen offset:0 sc1
    v_mfma_f32_16x16x32_bf16 v[208:211], v[12:15], v[56:59], v[208:211]
    s_waitcnt lgkmcnt(4)
    v_mfma_f32_16x16x32_bf16 v[224:227], v[16:19], v[56:59], v[224:227]
    ds_read_b64_tr_b16 v[12:13], v2 offset:4256
    v_mfma_f32_16x16x32_bf16 v[228:231], v[16:19], v[60:63], v[228:231]
    ds_read_b64_tr_b16 v[14:15], v2 offset:4512
    v_mfma_f32_16x16x32_bf16 v[232:235], v[16:19], v[64:67], v[232:235]
    buffer_load_dwordx4 v[100:103], v1, s[20:23], s53 offen offset:0 sc1
    v_mfma_f32_16x16x32_bf16 v[236:239], v[16:19], v[68:71], v[236:239]
    s_waitcnt lgkmcnt(4)
    v_mfma_f32_16x16x32_bf16 v[252:255], v[20:23], v[68:71], v[252:255]
    ds_read_b64_tr_b16 v[16:17], v2 offset:4288
    v_mfma_f32_16x16x32_bf16 v[248:251], v[20:23], v[64:67], v[248:251]
    ds_read_b64_tr_b16 v[18:19], v2 offset:4544
    v_mfma_f32_16x16x32_bf16 v[244:247], v[20:23], v[60:63], v[244:247]
    buffer_load_dwordx4 v[104:107], v3, s[20:23], s54 offen offset:0 sc1
    v_mfma_f32_16x16x32_bf16 v[240:243], v[20:23], v[56:59], v[240:243]
    s_waitcnt lgkmcnt(4)
    v_mfma_f32_16x16x32_bf16 v[128:131], v[8:11], v[56:59], v[128:131]
    ds_read_b64_tr_b16 v[20:21], v2 offset:4320
    v_mfma_f32_16x16x32_bf16 v[132:135], v[8:11], v[60:63], v[132:135]
    ds_read_b64_tr_b16 v[22:23], v2 offset:4576
    v_mfma_f32_16x16x32_bf16 v[136:139], v[8:11], v[64:67], v[136:139]
    v_add_u32 v2, 16896, v2
    s_barrier
    v_mfma_f32_16x16x32_bf16 v[140:143], v[8:11], v[68:71], v[140:143]
    s_waitcnt lgkmcnt(4)
    v_mfma_f32_16x16x32_bf16 v[156:159], v[12:15], v[68:71], v[156:159]
    ds_read_b64_tr_b16 v[8:9], v2 offset:8448
    v_mfma_f32_16x16x32_bf16 v[152:155], v[12:15], v[64:67], v[152:155]
    ds_read_b64_tr_b16 v[10:11], v2 offset:8704
    v_mfma_f32_16x16x32_bf16 v[148:151], v[12:15], v[60:63], v[148:151]
    buffer_load_dwordx4 v[108:111], v3, s[20:23], s53 offen offset:0 sc1
    v_mfma_f32_16x16x32_bf16 v[144:147], v[12:15], v[56:59], v[144:147]
    s_waitcnt lgkmcnt(4)
    v_mfma_f32_16x16x32_bf16 v[160:163], v[16:19], v[56:59], v[160:163]
    ds_read_b64_tr_b16 v[12:13], v2 offset:12672
    v_mfma_f32_16x16x32_bf16 v[164:167], v[16:19], v[60:63], v[164:167]
    ds_read_b64_tr_b16 v[14:15], v2 offset:12928
    v_mfma_f32_16x16x32_bf16 v[168:171], v[16:19], v[64:67], v[168:171]
    v_mfma_f32_16x16x32_bf16 v[172:175], v[16:19], v[68:71], v[172:175]
    s_waitcnt lgkmcnt(4)
    v_mfma_f32_16x16x32_bf16 v[188:191], v[20:23], v[68:71], v[188:191]
    ds_read_b64_tr_b16 v[16:17], v2 offset:8480
    v_mfma_f32_16x16x32_bf16 v[184:187], v[20:23], v[64:67], v[184:187]
    ds_read_b64_tr_b16 v[18:19], v2 offset:8736
    v_mfma_f32_16x16x32_bf16 v[180:183], v[20:23], v[60:63], v[180:183]
    v_mfma_f32_16x16x32_bf16 v[176:179], v[20:23], v[56:59], v[176:179]
L_c2join:
    s_waitcnt vmcnt(4)
    s_waitcnt lgkmcnt(2)
    v_mfma_f32_16x16x32_bf16 v[192:195], v[8:11], v[24:27], v[192:195]
    ds_read_b64_tr_b16 v[20:21], v2 offset:12704
    s_lshr_b32 s68, s2, 6
    v_mfma_f32_16x16x32_bf16 v[192:195], v[12:15], v[112:115], v[192:195]
    ds_read_b64_tr_b16 v[22:23], v2 offset:12960
    s_lshl_b32 s68, s68, 2
    v_mfma_f32_16x16x32_bf16 v[196:199], v[12:15], v[116:119], v[196:199]
    ds_read_b64_tr_b16 v[88:89], v2 offset:8512
    s_bfe_u32 s56, s2, 0x20003
    v_mfma_f32_16x16x32_bf16 v[196:199], v[8:11], v[28:31], v[196:199]
    ds_read_b64_tr_b16 v[90:91], v2 offset:8768
    s_add_u32 s68, s68, s56
    v_mfma_f32_16x16x32_bf16 v[200:203], v[8:11], v[32:35], v[200:203]
    ds_read_b64_tr_b16 v[92:93], v2 offset:12736
    buffer_load_dwordx4 v[72:75], v1, s[20:23], s54 offen offset:2048 sc1
    v_mfma_f32_16x16x32_bf16 v[200:203], v[12:15], v[120:123], v[200:203]
    ds_read_b64_tr_b16 v[94:95], v2 offset:12992
    s_lshl_b32 s68, s68, 1
    v_mfma_f32_16x16x32_bf16 v[204:207], v[12:15], v[124:127], v[204:207]
    buffer_load_dwordx4 v[76:79], v1, s[20:23], s53 offen offset:2048 sc1
    s_bfe_u32 s56, s2, 0x10005
    v_mfma_f32_16x16x32_bf16 v[204:207], v[8:11], v[36:39], v[204:207]
    s_add_u32 s68, s68, s56
    s_waitcnt lgkmcnt(4)
    v_mfma_f32_16x16x32_bf16 v[220:223], v[16:19], v[36:39], v[220:223]
    ds_read_b64_tr_b16 v[8:9], v2 offset:8544
    s_lshl_b32 s68, s68, 2
    v_mfma_f32_16x16x32_bf16 v[220:223], v[20:23], v[124:127], v[220:223]
    ds_read_b64_tr_b16 v[10:11], v2 offset:8800
    s_add_u32 s68, s68, s32
    v_mfma_f32_16x16x32_bf16 v[216:219], v[20:23], v[120:123], v[216:219]
    ds_read_b64_tr_b16 v[12:13], v2 offset:12768
    s_lshl_b32 s68, s68, 4
    v_mfma_f32_16x16x32_bf16 v[216:219], v[16:19], v[32:35], v[216:219]
    ds_read_b64_tr_b16 v[14:15], v2 offset:13024
    s_add_u32 s68, s68, s3
    v_mfma_f32_16x16x32_bf16 v[212:215], v[16:19], v[28:31], v[212:215]
    buffer_load_dwordx4 v[80:83], v3, s[20:23], s54 offen offset:2048 sc1
    s_lshl_b32 s68, s68, 14
    v_mfma_f32_16x16x32_bf16 v[212:215], v[20:23], v[116:119], v[212:215]
    s_xor_b32 s62, s68, 0x40000
    s_add_u32 s62, s62, 50331648
    v_mfma_f32_16x16x32_bf16 v[208:211], v[20:23], v[112:115], v[208:211]
    buffer_load_dwordx4 v[84:87], v3, s[20:23], s53 offen offset:2048 sc1
    s_add_u32 s65, s62, 4096
    v_mfma_f32_16x16x32_bf16 v[208:211], v[16:19], v[24:27], v[208:211]
    s_bfe_u32 s54, s4, 0x40010
    s_waitcnt lgkmcnt(4)
    v_mfma_f32_16x16x32_bf16 v[224:227], v[88:91], v[24:27], v[224:227]
    ds_read_b64_tr_b16 v[16:17], v2 offset:0
    s_lshl_b32 s54, s54, 17
    v_mfma_f32_16x16x32_bf16 v[224:227], v[92:95], v[112:115], v[224:227]
    ds_read_b64_tr_b16 v[18:19], v2 offset:256
    s_add_u32 s54, s54, s46
    v_mfma_f32_16x16x32_bf16 v[228:231], v[92:95], v[116:119], v[228:231]
    ds_read_b64_tr_b16 v[20:21], v2 offset:4224
    s_add_u32 s53, s54, 4096
    v_mfma_f32_16x16x32_bf16 v[228:231], v[88:91], v[28:31], v[228:231]
    ds_read_b64_tr_b16 v[22:23], v2 offset:4480
    s_xor_b32 s63, s68, 0x80000
    v_mfma_f32_16x16x32_bf16 v[232:235], v[88:91], v[32:35], v[232:235]
    buffer_load_dwordx4 v[40:43], v1, s[20:23], s54 offen offset:0 sc1
    s_add_u32 s63, s63, 50397184
    v_mfma_f32_16x16x32_bf16 v[232:235], v[92:95], v[120:123], v[232:235]
    s_add_u32 s66, s63, 4096
    s_xor_b32 s64, s68, 0xc0000
    v_mfma_f32_16x16x32_bf16 v[236:239], v[92:95], v[124:127], v[236:239]
    buffer_load_dwordx4 v[44:47], v1, s[20:23], s53 offen offset:0 sc1
    s_add_u32 s64, s64, 50462720
    v_mfma_f32_16x16x32_bf16 v[236:239], v[88:91], v[36:39], v[236:239]
    s_add_u32 s67, s64, 4096
    s_waitcnt lgkmcnt(4)
    v_mfma_f32_16x16x32_bf16 v[252:255], v[8:11], v[36:39], v[252:255]
    ds_read_b64_tr_b16 v[88:89], v2 offset:32
    s_add_u32 s59, s59, 1536
    v_mfma_f32_16x16x32_bf16 v[252:255], v[12:15], v[124:127], v[252:255]
    ds_read_b64_tr_b16 v[90:91], v2 offset:288
    s_lshl_b32 s68, s3, 12
    v_mfma_f32_16x16x32_bf16 v[248:251], v[12:15], v[120:123], v[248:251]
    ds_read_b64_tr_b16 v[92:93], v2 offset:4256
    s_add_u32 s68, s68, 135168
    v_mfma_f32_16x16x32_bf16 v[248:251], v[8:11], v[32:35], v[248:251]
    ds_read_b64_tr_b16 v[94:95], v2 offset:4512
    s_add_u32 s69, s3, 14
    v_mfma_f32_16x16x32_bf16 v[244:247], v[8:11], v[28:31], v[244:247]
    buffer_load_dwordx4 v[48:51], v3, s[20:23], s54 offen offset:0 sc1
    s_and_b32 s69, s69, 7
    v_mfma_f32_16x16x32_bf16 v[244:247], v[12:15], v[116:119], v[244:247]
    s_mul_i32 s69, s69, 16896
    s_add_u32 s69, s69, 8448
    v_mfma_f32_16x16x32_bf16 v[240:243], v[12:15], v[112:115], v[240:243]
    buffer_load_dwordx4 v[52:55], v3, s[20:23], s53 offen offset:0 sc1
    s_mov_b32 s28, s18
    v_mfma_f32_16x16x32_bf16 v[240:243], v[8:11], v[24:27], v[240:243]
    s_mov_b32 s29, s19
    s_waitcnt lgkmcnt(4)
    v_mfma_f32_16x16x32_bf16 v[128:131], v[16:19], v[24:27], v[128:131]
    ds_read_b64_tr_b16 v[8:9], v2 offset:64
    s_mov_b32 s30, 0x400000
    v_mfma_f32_16x16x32_bf16 v[128:131], v[20:23], v[112:115], v[128:131]
    ds_read_b64_tr_b16 v[10:11], v2 offset:320
    s_mov_b32 s31, 0x20000
    v_mfma_f32_16x16x32_bf16 v[132:135], v[20:23], v[116:119], v[132:135]
    ds_read_b64_tr_b16 v[12:13], v2 offset:4288
    s_lshl_b32 s55, s36, 2
    v_mfma_f32_16x16x32_bf16 v[132:135], v[16:19], v[28:31], v[132:135]
    ds_read_b64_tr_b16 v[14:15], v2 offset:4544
    s_add_u32 s55, s55, s3
    v_mfma_f32_16x16x32_bf16 v[136:139], v[16:19], v[32:35], v[136:139]
    buffer_load_dwordx4 v[56:59], v1, s[20:23], s54 offen offset:2048 sc1
    s_lshl_b32 s55, s55, 17
    v_mfma_f32_16x16x32_bf16 v[136:139], v[20:23], v[120:123], v[136:139]
    s_lshl_b32 s56, s40, 16
    s_add_u32 s55, s55, s56
    v_mfma_f32_16x16x32_bf16 v[140:143], v[20:23], v[124:127], v[140:143]
    buffer_load_dwordx4 v[60:63], v1, s[20:23], s53 offen offset:2048 sc1
    s_lshl_b32 s56, s41, 8
    v_mfma_f32_16x16x32_bf16 v[140:143], v[16:19], v[36:39], v[140:143]
    s_add_u32 s55, s55, s56
    s_waitcnt lgkmcnt(4)
    v_mfma_f32_16x16x32_bf16 v[156:159], v[88:91], v[36:39], v[156:159]
    ds_read_b64_tr_b16 v[16:17], v2 offset:96
    s_lshl_b32 s56, s42, 7
    v_mfma_f32_16x16x32_bf16 v[156:159], v[92:95], v[124:127], v[156:159]
    ds_read_b64_tr_b16 v[18:19], v2 offset:352
    s_add_u32 s55, s55, s56
    v_mfma_f32_16x16x32_bf16 v[152:155], v[92:95], v[120:123], v[152:155]
    ds_read_b64_tr_b16 v[20:21], v2 offset:4320
    s_lshl_b32 s50, s3, 1
    v_mfma_f32_16x16x32_bf16 v[152:155], v[88:91], v[32:35], v[152:155]
    ds_read_b64_tr_b16 v[22:23], v2 offset:4576
    s_add_u32 s50, s50, s40
    v_mfma_f32_16x16x32_bf16 v[148:151], v[88:91], v[28:31], v[148:151]
    buffer_load_dwordx4 v[64:67], v3, s[20:23], s54 offen offset:2048 sc1
    s_lshl_b32 s50, s50, 7
    v_mfma_f32_16x16x32_bf16 v[148:151], v[92:95], v[116:119], v[148:151]
    v_add_u32 v2, 16896, v2
    s_barrier
    v_mfma_f32_16x16x32_bf16 v[144:147], v[92:95], v[112:115], v[144:147]
    buffer_load_dwordx4 v[68:71], v3, s[20:23], s53 offen offset:2048 sc1
    s_add_u32 s50, s50, 162816
    v_mfma_f32_16x16x32_bf16 v[144:147], v[88:91], v[24:27], v[144:147]
    s_waitcnt lgkmcnt(4)
    v_mfma_f32_16x16x32_bf16 v[160:163], v[8:11], v[24:27], v[160:163]
    ds_read_b64_tr_b16 v[88:89], v2 offset:8448
    v_mfma_f32_16x16x32_bf16 v[160:163], v[12:15], v[112:115], v[160:163]
    ds_read_b64_tr_b16 v[90:91], v2 offset:8704
    v_mfma_f32_16x16x32_bf16 v[164:167], v[12:15], v[116:119], v[164:167]
    ds_read_b64_tr_b16 v[92:93], v2 offset:12672
    v_mfma_f32_16x16x32_bf16 v[164:167], v[8:11], v[28:31], v[164:167]
    ds_read_b64_tr_b16 v[94:95], v2 offset:12928
    v_mfma_f32_16x16x32_bf16 v[168:171], v[8:11], v[32:35], v[168:171]
    v_mfma_f32_16x16x32_bf16 v[168:171], v[12:15], v[120:123], v[168:171]
    v_mfma_f32_16x16x32_bf16 v[172:175], v[12:15], v[124:127], v[172:175]
    v_mfma_f32_16x16x32_bf16 v[172:175], v[8:11], v[36:39], v[172:175]
    s_waitcnt lgkmcnt(4)
    v_mfma_f32_16x16x32_bf16 v[188:191], v[16:19], v[36:39], v[188:191]
    ds_read_b64_tr_b16 v[8:9], v2 offset:8480
    v_mfma_f32_16x16x32_bf16 v[188:191], v[20:23], v[124:127], v[188:191]
    ds_read_b64_tr_b16 v[10:11], v2 offset:8736
    v_mfma_f32_16x16x32_bf16 v[184:187], v[20:23], v[120:123], v[184:187]
    ds_read_b64_tr_b16 v[12:13], v2 offset:12704
    v_mfma_f32_16x16x32_bf16 v[184:187], v[16:19], v[32:35], v[184:187]
    ds_read_b64_tr_b16 v[14:15], v2 offset:12960
    v_mfma_f32_16x16x32_bf16 v[180:183], v[16:19], v[28:31], v[180:183]
    v_mfma_f32_16x16x32_bf16 v[180:183], v[20:23], v[116:119], v[180:183]
    v_mfma_f32_16x16x32_bf16 v[176:179], v[20:23], v[112:115], v[176:179]
    v_mfma_f32_16x16x32_bf16 v[176:179], v[16:19], v[24:27], v[176:179]
    s_waitcnt vmcnt(8)
    s_mov_b64 exec, 1
    buffer_store_dword v6, off, s[20:23], s60 sc1
    s_mov_b64 exec, -1
    s_waitcnt lgkmcnt(4)
    v_mfma_f32_16x16x32_bf16 v[192:195], v[88:91], v[96:99], v[192:195]
    ds_read_b64_tr_b16 v[16:17], v2 offset:8512
    s_bfe_u32 s54, s4, 0x40014
    v_mfma_f32_16x16x32_bf16 v[192:195], v[92:95], v[72:75], v[192:195]
    ds_read_b64_tr_b16 v[18:19], v2 offset:8768
    s_lshl_b32 s54, s54, 17
    v_mfma_f32_16x16x32_bf16 v[196:199], v[92:95], v[76:79], v[196:199]
    ds_read_b64_tr_b16 v[20:21], v2 offset:12736
    s_add_u32 s54, s54, s46
    v_mfma_f32_16x16x32_bf16 v[196:199], v[88:91], v[100:103], v[196:199]
    ds_read_b64_tr_b16 v[22:23], v2 offset:12992
    s_add_u32 s53, s54, 4096
    v_mfma_f32_16x16x32_bf16 v[200:203], v[88:91], v[104:107], v[200:203]
    buffer_load_dwordx4 v[24:27], v1, s[20:23], s54 offen offset:0 sc1
    v_mfma_f32_16x16x32_bf16 v[200:203], v[92:95], v[80:83], v[200:203]
    v_mfma_f32_16x16x32_bf16 v[204:207], v[92:95], v[84:87], v[204:207]
    buffer_load_dwordx4 v[28:31], v1, s[20:23], s53 offen offset:0 sc1
    v_mfma_f32_16x16x32_bf16 v[204:207], v[88:91], v[108:111], v[204:207]
    s_waitcnt lgkmcnt(4)
    v_mfma_f32_16x16x32_bf16 v[220:223], v[8:11], v[108:111], v[220:223]
    ds_read_b64_tr_b16 v[88:89], v2 offset:8544
    v_mfma_f32_16x16x32_bf16 v[220:223], v[12:15], v[84:87], v[220:223]
    ds_read_b64_tr_b16 v[90:91], v2 offset:8800
    v_mfma_f32_16x16x32_bf16 v[216:219], v[12:15], v[80:83], v[216:219]
    ds_read_b64_tr_b16 v[92:93], v2 offset:12768
    v_mfma_f32_16x16x32_bf16 v[216:219], v[8:11], v[104:107], v[216:219]
    ds_read_b64_tr_b16 v[94:95], v2 offset:13024
    v_mfma_f32_16x16x32_bf16 v[212:215], v[8:11], v[100:103], v[212:215]
    buffer_load_dwordx4 v[32:35], v3, s[20:23], s54 offen offset:0 sc1
    v_mfma_f32_16x16x32_bf16 v[212:215], v[12:15], v[76:79], v[212:215]
    v_mfma_f32_16x16x32_bf16 v[208:211], v[12:15], v[72:75], v[208:211]
    buffer_load_dwordx4 v[36:39], v3, s[20:23], s53 offen offset:0 sc1
    v_mfma_f32_16x16x32_bf16 v[208:211], v[8:11], v[96:99], v[208:211]
    s_waitcnt lgkmcnt(4)
    v_mfma_f32_16x16x32_bf16 v[224:227], v[16:19], v[96:99], v[224:227]
    ds_read_b64_tr_b16 v[8:9], v2 offset:0
    v_mfma_f32_16x16x32_bf16 v[224:227], v[20:23], v[72:75], v[224:227]
    ds_read_b64_tr_b16 v[10:11], v2 offset:256
    v_mfma_f32_16x16x32_bf16 v[228:231], v[20:23], v[76:79], v[228:231]
    ds_read_b64_tr_b16 v[12:13], v2 offset:4224
    v_mfma_f32_16x16x32_bf16 v[228:231], v[16:19], v[100:103], v[228:231]
    ds_read_b64_tr_b16 v[14:15], v2 offset:4480
    v_mfma_f32_16x16x32_bf16 v[232:235], v[16:19], v[104:107], v[232:235]
    buffer_load_dwordx4 v[112:115], v1, s[20:23], s54 offen offset:2048 sc1
    v_mfma_f32_16x16x32_bf16 v[232:235], v[20:23], v[80:83], v[232:235]
    v_mfma_f32_16x16x32_bf16 v[236:239], v[20:23], v[84:87], v[236:239]
    buffer_load_dwordx4 v[116:119], v1, s[20:23], s53 offen offset:2048 sc1
    v_mfma_f32_16x16x32_bf16 v[236:239], v[16:19], v[108:111], v[236:239]
    s_waitcnt lgkmcnt(4)
    v_mfma_f32_16x16x32_bf16 v[252:255], v[88:91], v[108:111], v[252:255]
    ds_read_b64_tr_b16 v[16:17], v2 offset:32
    v_mfma_f32_16x16x32_bf16 v[252:255], v[92:95], v[84:87], v[252:255]
    ds_read_b64_tr_b16 v[18:19], v2 offset:288
    v_mfma_f32_16x16x32_bf16 v[248:251], v[92:95], v[80:83], v[248:251]
    ds_read_b64_tr_b16 v[20:21], v2 offset:4256
    v_mfma_f32_16x16x32_bf16 v[248:251], v[88:91], v[104:107], v[248:251]
    ds_read_b64_tr_b16 v[22:23], v2 offset:4512
    v_mfma_f32_16x16x32_bf16 v[244:247], v[88:91], v[100:103], v[244:247]
    buffer_load_dwordx4 v[120:123], v3, s[20:23], s54 offen offset:2048 sc1
    v_mfma_f32_16x16x32_bf16 v[244:247], v[92:95], v[76:79], v[244:247]
    v_mfma_f32_16x16x32_bf16 v[240:243], v[92:95], v[72:75], v[240:243]
    buffer_load_dwordx4 v[124:127], v3, s[20:23], s53 offen offset:2048 sc1
    v_mfma_f32_16x16x32_bf16 v[240:243], v[88:91], v[96:99], v[240:243]
    s_waitcnt lgkmcnt(4)
    v_mfma_f32_16x16x32_bf16 v[128:131], v[8:11], v[96:99], v[128:131]
    ds_read_b64_tr_b16 v[88:89], v2 offset:64
    v_mfma_f32_16x16x32_bf16 v[128:131], v[12:15], v[72:75], v[128:131]
    ds_read_b64_tr_b16 v[90:91], v2 offset:320
    v_mfma_f32_16x16x32_bf16 v[132:135], v[12:15], v[76:79], v[132:135]
    ds_read_b64_tr_b16 v[92:93], v2 offset:4288
    v_mfma_f32_16x16x32_bf16 v[132:135], v[8:11], v[100:103], v[132:135]
    ds_read_b64_tr_b16 v[94:95], v2 offset:4544
    v_mfma_f32_16x16x32_bf16 v[136:139], v[8:11], v[104:107], v[136:139]
    v_mfma_f32_16x16x32_bf16 v[136:139], v[12:15], v[80:83], v[136:139]
    v_mfma_f32_16x16x32_bf16 v[140:143], v[12:15], v[84:87], v[140:143]
    v_mfma_f32_16x16x32_bf16 v[140:143], v[8:11], v[108:111], v[140:143]
    s_waitcnt lgkmcnt(4)
    v_mfma_f32_16x16x32_bf16 v[156:159], v[16:19], v[108:111], v[156:159]
    ds_read_b64_tr_b16 v[8:9], v2 offset:96
    v_mfma_f32_16x16x32_bf16 v[156:159], v[20:23], v[84:87], v[156:159]
    ds_read_b64_tr_b16 v[10:11], v2 offset:352
    v_mfma_f32_16x16x32_bf16 v[152:155], v[20:23], v[80:83], v[152:155]
    ds_read_b64_tr_b16 v[12:13], v2 offset:4320
    v_mfma_f32_16x16x32_bf16 v[152:155], v[16:19], v[104:107], v[152:155]
    ds_read_b64_tr_b16 v[14:15], v2 offset:4576
    v_mfma_f32_16x16x32_bf16 v[148:151], v[16:19], v[100:103], v[148:151]
    v_mfma_f32_16x16x32_bf16 v[148:151], v[20:23], v[76:79], v[148:151]
    v_add_u32 v2, 16896, v2
    s_barrier
    v_mfma_f32_16x16x32_bf16 v[144:147], v[20:23], v[72:75], v[144:147]
    v_mfma_f32_16x16x32_bf16 v[144:147], v[16:19], v[96:99], v[144:147]
    s_waitcnt lgkmcnt(4)
    v_mfma_f32_16x16x32_bf16 v[160:163], v[88:91], v[96:99], v[160:163]
    ds_read_b64_tr_b16 v[16:17], v2 offset:8448
    v_mfma_f32_16x16x32_bf16 v[160:163], v[92:95], v[72:75], v[160:163]
    ds_read_b64_tr_b16 v[18:19], v2 offset:8704
    v_mfma_f32_16x16x32_bf16 v[164:167], v[92:95], v[76:79], v[164:167]
    ds_read_b64_tr_b16 v[20:21], v2 offset:12672
    v_mfma_f32_16x16x32_bf16 v[164:167], v[88:91], v[100:103], v[164:167]
    ds_read_b64_tr_b16 v[22:23], v2 offset:12928
    v_mfma_f32_16x16x32_bf16 v[168:171], v[88:91], v[104:107], v[168:171]
    v_mfma_f32_16x16x32_bf16 v[168:171], v[92:95], v[80:83], v[168:171]
    v_mfma_f32_16x16x32_bf16 v[172:175], v[92:95], v[84:87], v[172:175]
    v_mfma_f32_16x16x32_bf16 v[172:175], v[88:91], v[108:111], v[172:175]
    s_waitcnt lgkmcnt(4)
    v_mfma_f32_16x16x32_bf16 v[188:191], v[8:11], v[108:111], v[188:191]
    ds_read_b64_tr_b16 v[88:89], v2 offset:8480
    v_mfma_f32_16x16x32_bf16 v[188:191], v[12:15], v[84:87], v[188:191]
    ds_read_b64_tr_b16 v[90:91], v2 offset:8736
    v_mfma_f32_16x16x32_bf16 v[184:187], v[12:15], v[80:83], v[184:187]
    ds_read_b64_tr_b16 v[92:93], v2 offset:12704
    v_mfma_f32_16x16x32_bf16 v[184:187], v[8:11], v[104:107], v[184:187]
    ds_read_b64_tr_b16 v[94:95], v2 offset:12960
    v_mfma_f32_16x16x32_bf16 v[180:183], v[8:11], v[100:103], v[180:183]
    v_mfma_f32_16x16x32_bf16 v[180:183], v[12:15], v[76:79], v[180:183]
    v_mfma_f32_16x16x32_bf16 v[176:179], v[12:15], v[72:75], v[176:179]
    v_mfma_f32_16x16x32_bf16 v[176:179], v[8:11], v[96:99], v[176:179]
    s_waitcnt vmcnt(9)
    s_waitcnt lgkmcnt(4)
    v_mfma_f32_16x16x32_bf16 v[192:195], v[16:19], v[40:43], v[192:195]
    ds_read_b64_tr_b16 v[8:9], v2 offset:8512
    s_bfe_u32 s54, s4, 0x40018
    v_mfma_f32_16x16x32_bf16 v[192:195], v[20:23], v[56:59], v[192:195]
    ds_read_b64_tr_b16 v[10:11], v2 offset:8768
    s_lshl_b32 s54, s54, 17
    v_mfma_f32_16x16x32_bf16 v[196:199], v[20:23], v[60:63], v[196:199]
    ds_read_b64_tr_b16 v[12:13], v2 offset:12736
    s_add_u32 s54, s54, s46
    v_mfma_f32_16x16x32_bf16 v[196:199], v[16:19], v[44:47], v[196:199]
    ds_read_b64_tr_b16 v[14:15], v2 offset:12992
    s_add_u32 s53, s54, 4096
    v_mfma_f32_16x16x32_bf16 v[200:203], v[16:19], v[48:51], v[200:203]
    buffer_load_dwordx4 v[96:99], v1, s[20:23], s54 offen offset:0 sc1
    v_mfma_f32_16x16x32_bf16 v[200:203], v[20:23], v[64:67], v[200:203]
    v_mfma_f32_16x16x32_bf16 v[204:207], v[20:23], v[68:71], v[204:207]
    buffer_load_dwordx4 v[100:103], v1, s[20:23], s53 offen offset:0 sc1
    v_mfma_f32_16x16x32_bf16 v[204:207], v[16:19], v[52:55], v[204:207]
    s_waitcnt lgkmcnt(4)
    v_mfma_f32_16x16x32_bf16 v[220:223], v[88:91], v[52:55], v[220:223]
    ds_read_b64_tr_b16 v[16:17], v2 offset:8544
    v_mfma_f32_16x16x32_bf16 v[220:223], v[92:95], v[68:71], v[220:223]
    ds_read_b64_tr_b16 v[18:19], v2 offset:8800
    v_mfma_f32_16x16x32_bf16 v[216:219], v[92:95], v[64:67], v[216:219]
    ds_read_b64_tr_b16 v[20:21], v2 offset:12768
    v_mfma_f32_16x16x32_bf16 v[216:219], v[88:91], v[48:51], v[216:219]
    ds_read_b64_tr_b16 v[22:23], v2 offset:13024
    v_mfma_f32_16x16x32_bf16 v[212:215], v[88:91], v[44:47], v[212:215]
    buffer_load_dwordx4 v[104:107], v3, s[20:23], s54 offen offset:0 sc1
    v_mfma_f32_16x16x32_bf16 v[212:215], v[92:95], v[60:63], v[212:215]
    v_mfma_f32_16x16x32_bf16 v[208:211], v[92:95], v[56:59], v[208:211]
    buffer_load_dwordx4 v[108:111], v3, s[20:23], s53 offen offset:0 sc1
    v_mfma_f32_16x16x32_bf16 v[208:211], v[88:91], v[40:43], v[208:211]
    s_waitcnt lgkmcnt(4)
    v_mfma_f32_16x16x32_bf16 v[224:227], v[8:11], v[40:43], v[224:227]
    ds_read_b64_tr_b16 v[88:89], v2 offset:0
    v_mfma_f32_16x16x32_bf16 v[224:227], v[12:15], v[56:59], v[224:227]
    ds_read_b64_tr_b16 v[90:91], v2 offset:256
    v_mfma_f32_16x16x32_bf16 v[228:231], v[12:15], v[60:63], v[228:231]
    ds_read_b64_tr_b16 v[92:93], v2 offset:4224
    v_mfma_f32_16x16x32_bf16 v[228:231], v[8:11], v[44:47], v[228:231]
    ds_read_b64_tr_b16 v[94:95], v2 offset:4480
    v_mfma_f32_16x16x32_bf16 v[232:235], v[8:11], v[48:51], v[232:235]
    buffer_load_dwordx4 v[72:75], v1, s[20:23], s54 offen offset:2048 sc1
    v_mfma_f32_16x16x32_bf16 v[232:235], v[12:15], v[64:67], v[232:235]
    v_mfma_f32_16x16x32_bf16 v[236:239], v[12:15], v[68:71], v[236:239]
    buffer_load_dwordx4 v[76:79], v1, s[20:23], s53 offen offset:2048 sc1
    v_mfma_f32_16x16x32_bf16 v[236:239], v[8:11], v[52:55], v[236:239]
    s_waitcnt lgkmcnt(4)
    v_mfma_f32_16x16x32_bf16 v[252:255], v[16:19], v[52:55], v[252:255]
    ds_read_b64_tr_b16 v[8:9], v2 offset:32
    v_mfma_f32_16x16x32_bf16 v[252:255], v[20:23], v[68:71], v[252:255]
    ds_read_b64_tr_b16 v[10:11], v2 offset:288
    v_mfma_f32_16x16x32_bf16 v[248:251], v[20:23], v[64:67], v[248:251]
    ds_read_b64_tr_b16 v[12:13], v2 offset:4256
    v_mfma_f32_16x16x32_bf16 v[248:251], v[16:19], v[48:51], v[248:251]
    ds_read_b64_tr_b16 v[14:15], v2 offset:4512
    v_mfma_f32_16x16x32_bf16 v[244:247], v[16:19], v[44:47], v[244:247]
    buffer_load_dwordx4 v[80:83], v3, s[20:23], s54 offen offset:2048 sc1
    v_mfma_f32_16x16x32_bf16 v[244:247], v[20:23], v[60:63], v[244:247]
    v_mfma_f32_16x16x32_bf16 v[240:243], v[20:23], v[56:59], v[240:243]
    buffer_load_dwordx4 v[84:87], v3, s[20:23], s53 offen offset:2048 sc1
    v_mfma_f32_16x16x32_bf16 v[240:243], v[16:19], v[40:43], v[240:243]
    s_waitcnt lgkmcnt(4)
    v_mfma_f32_16x16x32_bf16 v[128:131], v[88:91], v[40:43], v[128:131]
    ds_read_b64_tr_b16 v[16:17], v2 offset:64
    v_mfma_f32_16x16x32_bf16 v[128:131], v[92:95], v[56:59], v[128:131]
    ds_read_b64_tr_b16 v[18:19], v2 offset:320
    v_mfma_f32_16x16x32_bf16 v[132:135], v[92:95], v[60:63], v[132:135]
    ds_read_b64_tr_b16 v[20:21], v2 offset:4288
    v_mfma_f32_16x16x32_bf16 v[132:135], v[88:91], v[44:47], v[132:135]
    ds_read_b64_tr_b16 v[22:23], v2 offset:4544
    v_mfma_f32_16x16x32_bf16 v[136:139], v[88:91], v[48:51], v[136:139]
    v_mfma_f32_16x16x32_bf16 v[136:139], v[92:95], v[64:67], v[136:139]
    v_mfma_f32_16x16x32_bf16 v[140:143], v[92:95], v[68:71], v[140:143]
    v_mfma_f32_16x16x32_bf16 v[140:143], v[88:91], v[52:55], v[140:143]
    s_waitcnt lgkmcnt(4)
    v_mfma_f32_16x16x32_bf16 v[156:159], v[8:11], v[52:55], v[156:159]
    ds_read_b64_tr_b16 v[88:89], v2 offset:96
    v_mfma_f32_16x16x32_bf16 v[156:159], v[12:15], v[68:71], v[156:159]
    ds_read_b64_tr_b16 v[90:91], v2 offset:352
    v_mfma_f32_16x16x32_bf16 v[152:155], v[12:15], v[64:67], v[152:155]
    ds_read_b64_tr_b16 v[92:93], v2 offset:4320
    v_mfma_f32_16x16x32_bf16 v[152:155], v[8:11], v[48:51], v[152:155]
    ds_read_b64_tr_b16 v[94:95], v2 offset:4576
    v_mfma_f32_16x16x32_bf16 v[148:151], v[8:11], v[44:47], v[148:151]
    v_mfma_f32_16x16x32_bf16 v[148:151], v[12:15], v[60:63], v[148:151]
    v_add_u32 v2, 16896, v2
    s_barrier
    v_mfma_f32_16x16x32_bf16 v[144:147], v[12:15], v[56:59], v[144:147]
    v_mfma_f32_16x16x32_bf16 v[144:147], v[8:11], v[40:43], v[144:147]
    s_waitcnt lgkmcnt(4)
    v_mfma_f32_16x16x32_bf16 v[160:163], v[16:19], v[40:43], v[160:163]
    ds_read_b64_tr_b16 v[8:9], v2 offset:8448
    v_mfma_f32_16x16x32_bf16 v[160:163], v[20:23], v[56:59], v[160:163]
    ds_read_b64_tr_b16 v[10:11], v2 offset:8704
    v_mfma_f32_16x16x32_bf16 v[164:167], v[20:23], v[60:63], v[164:167]
    ds_read_b64_tr_b16 v[12:13], v2 offset:12672
    v_mfma_f32_16x16x32_bf16 v[164:167], v[16:19], v[44:47], v[164:167]
    ds_read_b64_tr_b16 v[14:15], v2 offset:12928
    v_mfma_f32_16x16x32_bf16 v[168:171], v[16:19], v[48:51], v[168:171]
    v_mfma_f32_16x16x32_bf16 v[168:171], v[20:23], v[64:67], v[168:171]
    v_mfma_f32_16x16x32_bf16 v[172:175], v[20:23], v[68:71], v[172:175]
    v_mfma_f32_16x16x32_bf16 v[172:175], v[16:19], v[52:55], v[172:175]
    s_waitcnt lgkmcnt(4)
    v_mfma_f32_16x16x32_bf16 v[188:191], v[88:91], v[52:55], v[188:191]
    ds_read_b64_tr_b16 v[16:17], v2 offset:8480
    v_mfma_f32_16x16x32_bf16 v[188:191], v[92:95], v[68:71], v[188:191]
    ds_read_b64_tr_b16 v[18:19], v2 offset:8736
    v_mfma_f32_16x16x32_bf16 v[184:187], v[92:95], v[64:67], v[184:187]
    ds_read_b64_tr_b16 v[20:21], v2 offset:12704
    v_mfma_f32_16x16x32_bf16 v[184:187], v[88:91], v[48:51], v[184:187]
    ds_read_b64_tr_b16 v[22:23], v2 offset:12960
    v_mfma_f32_16x16x32_bf16 v[180:183], v[88:91], v[44:47], v[180:183]
    v_mfma_f32_16x16x32_bf16 v[180:183], v[92:95], v[60:63], v[180:183]
    v_mfma_f32_16x16x32_bf16 v[176:179], v[92:95], v[56:59], v[176:179]
    v_mfma_f32_16x16x32_bf16 v[176:179], v[88:91], v[40:43], v[176:179]
    s_waitcnt vmcnt(8)
    s_waitcnt lgkmcnt(4)
    v_mfma_f32_16x16x32_bf16 v[192:195], v[8:11], v[24:27], v[192:195]
    ds_read_b64_tr_b16 v[88:89], v2 offset:8512
    s_bfe_u32 s54, s4, 0x4001c
    v_mfma_f32_16x16x32_bf16 v[192:195], v[12:15], v[112:115], v[192:195]
    ds_read_b64_tr_b16 v[90:91], v2 offset:8768
    s_lshl_b32 s54, s54, 17
    v_mfma_f32_16x16x32_bf16 v[196:199], v[12:15], v[116:119], v[196:199]
    ds_read_b64_tr_b16 v[92:93], v2 offset:12736
    s_add_u32 s54, s54, s46
    v_mfma_f32_16x16x32_bf16 v[196:199], v[8:11], v[28:31], v[196:199]
    ds_read_b64_tr_b16 v[94:95], v2 offset:12992
    s_add_u32 s53, s54, 4096
    v_mfma_f32_16x16x32_bf16 v[200:203], v[8:11], v[32:35], v[200:203]
    buffer_load_dwordx4 v[40:43], v1, s[20:23], s54 offen offset:0 sc1
    v_mfma_f32_16x16x32_bf16 v[200:203], v[12:15], v[120:123], v[200:203]
    v_mfma_f32_16x16x32_bf16 v[204:207], v[12:15], v[124:127], v[204:207]
    buffer_load_dwordx4 v[44:47], v1, s[20:23], s53 offen offset:0 sc1
    v_mfma_f32_16x16x32_bf16 v[204:207], v[8:11], v[36:39], v[204:207]
    s_waitcnt lgkmcnt(4)
    v_mfma_f32_16x16x32_bf16 v[220:223], v[16:19], v[36:39], v[220:223]
    ds_read_b64_tr_b16 v[8:9], v2 offset:8544
    v_mfma_f32_16x16x32_bf16 v[220:223], v[20:23], v[124:127], v[220:223]
    ds_read_b64_tr_b16 v[10:11], v2 offset:8800
    v_mfma_f32_16x16x32_bf16 v[216:219], v[20:23], v[120:123], v[216:219]
    ds_read_b64_tr_b16 v[12:13], v2 offset:12768
    v_mfma_f32_16x16x32_bf16 v[216:219], v[16:19], v[32:35], v[216:219]
    ds_read_b64_tr_b16 v[14:15], v2 offset:13024
    v_mfma_f32_16x16x32_bf16 v[212:215], v[16:19], v[28:31], v[212:215]
    buffer_load_dwordx4 v[48:51], v3, s[20:23], s54 offen offset:0 sc1
    v_mfma_f32_16x16x32_bf16 v[212:215], v[20:23], v[116:119], v[212:215]
    v_mfma_f32_16x16x32_bf16 v[208:211], v[20:23], v[112:115], v[208:211]
    buffer_load_dwordx4 v[52:55], v3, s[20:23], s53 offen offset:0 sc1
    v_mfma_f32_16x16x32_bf16 v[208:211], v[16:19], v[24:27], v[208:211]
    s_waitcnt lgkmcnt(4)
    v_mfma_f32_16x16x32_bf16 v[224:227], v[88:91], v[24:27], v[224:227]
    ds_read_b64_tr_b16 v[16:17], v2 offset:0
    v_mfma_f32_16x16x32_bf16 v[224:227], v[92:95], v[112:115], v[224:227]
    ds_read_b64_tr_b16 v[18:19], v2 offset:256
    v_mfma_f32_16x16x32_bf16 v[228:231], v[92:95], v[116:119], v[228:231]
    ds_read_b64_tr_b16 v[20:21], v2 offset:4224
    v_mfma_f32_16x16x32_bf16 v[228:231], v[88:91], v[28:31], v[228:231]
    ds_read_b64_tr_b16 v[22:23], v2 offset:4480
    v_mfma_f32_16x16x32_bf16 v[232:235], v[88:91], v[32:35], v[232:235]
    buffer_load_dwordx4 v[56:59], v1, s[20:23], s54 offen offset:2048 sc1
    v_mfma_f32_16x16x32_bf16 v[232:235], v[92:95], v[120:123], v[232:235]
    v_mfma_f32_16x16x32_bf16 v[236:239], v[92:95], v[124:127], v[236:239]
    buffer_load_dwordx4 v[60:63], v1, s[20:23], s53 offen offset:2048 sc1
    v_mfma_f32_16x16x32_bf16 v[236:239], v[88:91], v[36:39], v[236:239]
    s_waitcnt lgkmcnt(4)
    v_mfma_f32_16x16x32_bf16 v[252:255], v[8:11], v[36:39], v[252:255]
    ds_read_b64_tr_b16 v[88:89], v2 offset:32
    v_mfma_f32_16x16x32_bf16 v[252:255], v[12:15], v[124:127], v[252:255]
    ds_read_b64_tr_b16 v[90:91], v2 offset:288
    v_mfma_f32_16x16x32_bf16 v[248:251], v[12:15], v[120:123], v[248:251]
    ds_read_b64_tr_b16 v[92:93], v2 offset:4256
    v_mfma_f32_16x16x32_bf16 v[248:251], v[8:11], v[32:35], v[248:251]
    ds_read_b64_tr_b16 v[94:95], v2 offset:4512
    v_mfma_f32_16x16x32_bf16 v[244:247], v[8:11], v[28:31], v[244:247]
    buffer_load_dwordx4 v[64:67], v3, s[20:23], s54 offen offset:2048 sc1
    v_mfma_f32_16x16x32_bf16 v[244:247], v[12:15], v[116:119], v[244:247]
    v_mfma_f32_16x16x32_bf16 v[240:243], v[12:15], v[112:115], v[240:243]
    buffer_load_dwordx4 v[68:71], v3, s[20:23], s53 offen offset:2048 sc1
    v_mfma_f32_16x16x32_bf16 v[240:243], v[8:11], v[24:27], v[240:243]
    s_waitcnt lgkmcnt(4)
    v_mfma_f32_16x16x32_bf16 v[128:131], v[16:19], v[24:27], v[128:131]
    ds_read_b64_tr_b16 v[8:9], v2 offset:64
    v_mfma_f32_16x16x32_bf16 v[128:131], v[20:23], v[112:115], v[128:131]
    ds_read_b64_tr_b16 v[10:11], v2 offset:320
    v_mfma_f32_16x16x32_bf16 v[132:135], v[20:23], v[116:119], v[132:135]
    ds_read_b64_tr_b16 v[12:13], v2 offset:4288
    v_mfma_f32_16x16x32_bf16 v[132:135], v[16:19], v[28:31], v[132:135]
    ds_read_b64_tr_b16 v[14:15], v2 offset:4544
    v_mfma_f32_16x16x32_bf16 v[136:139], v[16:19], v[32:35], v[136:139]
    v_mfma_f32_16x16x32_bf16 v[136:139], v[20:23], v[120:123], v[136:139]
    v_mfma_f32_16x16x32_bf16 v[140:143], v[20:23], v[124:127], v[140:143]
    v_mfma_f32_16x16x32_bf16 v[140:143], v[16:19], v[36:39], v[140:143]
    s_waitcnt lgkmcnt(4)
    v_mfma_f32_16x16x32_bf16 v[156:159], v[88:91], v[36:39], v[156:159]
    ds_read_b64_tr_b16 v[16:17], v2 offset:96
    v_mfma_f32_16x16x32_bf16 v[156:159], v[92:95], v[124:127], v[156:159]
    ds_read_b64_tr_b16 v[18:19], v2 offset:352
    v_mfma_f32_16x16x32_bf16 v[152:155], v[92:95], v[120:123], v[152:155]
    ds_read_b64_tr_b16 v[20:21], v2 offset:4320
    v_mfma_f32_16x16x32_bf16 v[152:155], v[88:91], v[32:35], v[152:155]
    ds_read_b64_tr_b16 v[22:23], v2 offset:4576
    v_mfma_f32_16x16x32_bf16 v[148:151], v[88:91], v[28:31], v[148:151]
    v_mfma_f32_16x16x32_bf16 v[148:151], v[92:95], v[116:119], v[148:151]
    v_add_u32 v2, 4294849024, v2
    s_barrier
    v_mfma_f32_16x16x32_bf16 v[144:147], v[92:95], v[112:115], v[144:147]
    v_mfma_f32_16x16x32_bf16 v[144:147], v[88:91], v[24:27], v[144:147]
    s_waitcnt lgkmcnt(4)
    v_mfma_f32_16x16x32_bf16 v[160:163], v[8:11], v[24:27], v[160:163]
    ds_read_b64_tr_b16 v[88:89], v2 offset:8448
    v_mfma_f32_16x16x32_bf16 v[160:163], v[12:15], v[112:115], v[160:163]
    ds_read_b64_tr_b16 v[90:91], v2 offset:8704
    v_mfma_f32_16x16x32_bf16 v[164:167], v[12:15], v[116:119], v[164:167]
    ds_read_b64_tr_b16 v[92:93], v2 offset:12672
    v_mfma_f32_16x16x32_bf16 v[164:167], v[8:11], v[28:31], v[164:167]
    ds_read_b64_tr_b16 v[94:95], v2 offset:12928
    v_mfma_f32_16x16x32_bf16 v[168:171], v[8:11], v[32:35], v[168:171]
    v_mfma_f32_16x16x32_bf16 v[168:171], v[12:15], v[120:123], v[168:171]
    v_mfma_f32_16x16x32_bf16 v[172:175], v[12:15], v[124:127], v[172:175]
    v_mfma_f32_16x16x32_bf16 v[172:175], v[8:11], v[36:39], v[172:175]
    s_waitcnt lgkmcnt(4)
    v_mfma_f32_16x16x32_bf16 v[188:191], v[16:19], v[36:39], v[188:191]
    ds_read_b64_tr_b16 v[8:9], v2 offset:8480
    v_mfma_f32_16x16x32_bf16 v[188:191], v[20:23], v[124:127], v[188:191]
    ds_read_b64_tr_b16 v[10:11], v2 offset:8736
    v_mfma_f32_16x16x32_bf16 v[184:187], v[20:23], v[120:123], v[184:187]
    ds_read_b64_tr_b16 v[12:13], v2 offset:12704
    v_mfma_f32_16x16x32_bf16 v[184:187], v[16:19], v[32:35], v[184:187]
    ds_read_b64_tr_b16 v[14:15], v2 offset:12960
    v_mfma_f32_16x16x32_bf16 v[180:183], v[16:19], v[28:31], v[180:183]
    v_mfma_f32_16x16x32_bf16 v[180:183], v[20:23], v[116:119], v[180:183]
    v_mfma_f32_16x16x32_bf16 v[176:179], v[20:23], v[112:115], v[176:179]
    v_mfma_f32_16x16x32_bf16 v[176:179], v[16:19], v[24:27], v[176:179]
    s_waitcnt vmcnt(8)
    s_waitcnt lgkmcnt(4)
    v_mfma_f32_16x16x32_bf16 v[192:195], v[88:91], v[96:99], v[192:195]
    ds_read_b64_tr_b16 v[16:17], v2 offset:8512
    s_bfe_u32 s54, s5, 0x40000
    v_mfma_f32_16x16x32_bf16 v[192:195], v[92:95], v[72:75], v[192:195]
    ds_read_b64_tr_b16 v[18:19], v2 offset:8768
    s_lshl_b32 s54, s54, 17
    v_mfma_f32_16x16x32_bf16 v[196:199], v[92:95], v[76:79], v[196:199]
    ds_read_b64_tr_b16 v[20:21], v2 offset:12736
    s_add_u32 s54, s54, s46
    v_mfma_f32_16x16x32_bf16 v[196:199], v[88:91], v[100:103], v[196:199]
    ds_read_b64_tr_b16 v[22:23], v2 offset:12992
    s_add_u32 s53, s54, 4096
    v_mfma_f32_16x16x32_bf16 v[200:203], v[88:91], v[104:107], v[200:203]
    buffer_load_dwordx4 v[24:27], v1, s[20:23], s54 offen offset:0 sc1
    v_mfma_f32_16x16x32_bf16 v[200:203], v[92:95], v[80:83], v[200:203]
    v_mfma_f32_16x16x32_bf16 v[204:207], v[92:95], v[84:87], v[204:207]
    buffer_load_dwordx4 v[28:31], v1, s[20:23], s53 offen offset:0 sc1
    v_mfma_f32_16x16x32_bf16 v[204:207], v[88:91], v[108:111], v[204:207]
    s_waitcnt lgkmcnt(4)
    v_mfma_f32_16x16x32_bf16 v[220:223], v[8:11], v[108:111], v[220:223]
    ds_read_b64_tr_b16 v[88:89], v2 offset:8544
    v_mfma_f32_16x16x32_bf16 v[220:223], v[12:15], v[84:87], v[220:223]
    ds_read_b64_tr_b16 v[90:91], v2 offset:8800
    v_mfma_f32_16x16x32_bf16 v[216:219], v[12:15], v[80:83], v[216:219]
    ds_read_b64_tr_b16 v[92:93], v2 offset:12768
    v_mfma_f32_16x16x32_bf16 v[216:219], v[8:11], v[104:107], v[216:219]
    ds_read_b64_tr_b16 v[94:95], v2 offset:13024
    v_mfma_f32_16x16x32_bf16 v[212:215], v[8:11], v[100:103], v[212:215]
    buffer_load_dwordx4 v[32:35], v3, s[20:23], s54 offen offset:0 sc1
    v_mfma_f32_16x16x32_bf16 v[212:215], v[12:15], v[76:79], v[212:215]
    v_mfma_f32_16x16x32_bf16 v[208:211], v[12:15], v[72:75], v[208:211]
    buffer_load_dwordx4 v[36:39], v3, s[20:23], s53 offen offset:0 sc1
    v_mfma_f32_16x16x32_bf16 v[208:211], v[8:11], v[96:99], v[208:211]
    s_waitcnt lgkmcnt(4)
    v_mfma_f32_16x16x32_bf16 v[224:227], v[16:19], v[96:99], v[224:227]
    ds_read_b64_tr_b16 v[8:9], v2 offset:0
    v_mfma_f32_16x16x32_bf16 v[224:227], v[20:23], v[72:75], v[224:227]
    ds_read_b64_tr_b16 v[10:11], v2 offset:256
    v_mfma_f32_16x16x32_bf16 v[228:231], v[20:23], v[76:79], v[228:231]
    ds_read_b64_tr_b16 v[12:13], v2 offset:4224
    v_mfma_f32_16x16x32_bf16 v[228:231], v[16:19], v[100:103], v[228:231]
    ds_read_b64_tr_b16 v[14:15], v2 offset:4480
    v_mfma_f32_16x16x32_bf16 v[232:235], v[16:19], v[104:107], v[232:235]
    buffer_load_dwordx4 v[112:115], v1, s[20:23], s54 offen offset:2048 sc1
    v_mfma_f32_16x16x32_bf16 v[232:235], v[20:23], v[80:83], v[232:235]
    v_mfma_f32_16x16x32_bf16 v[236:239], v[20:23], v[84:87], v[236:239]
    buffer_load_dwordx4 v[116:119], v1, s[20:23], s53 offen offset:2048 sc1
    v_mfma_f32_16x16x32_bf16 v[236:239], v[16:19], v[108:111], v[236:239]
    s_waitcnt lgkmcnt(4)
    v_mfma_f32_16x16x32_bf16 v[252:255], v[88:91], v[108:111], v[252:255]
    ds_read_b64_tr_b16 v[16:17], v2 offset:32
    v_mfma_f32_16x16x32_bf16 v[252:255], v[92:95], v[84:87], v[252:255]
    ds_read_b64_tr_b16 v[18:19], v2 offset:288
    v_mfma_f32_16x16x32_bf16 v[248:251], v[92:95], v[80:83], v[248:251]
    ds_read_b64_tr_b16 v[20:21], v2 offset:4256
    v_mfma_f32_16x16x32_bf16 v[248:251], v[88:91], v[104:107], v[248:251]
    ds_read_b64_tr_b16 v[22:23], v2 offset:4512
    v_mfma_f32_16x16x32_bf16 v[244:247], v[88:91], v[100:103], v[244:247]
    buffer_load_dwordx4 v[120:123], v3, s[20:23], s54 offen offset:2048 sc1
    v_mfma_f32_16x16x32_bf16 v[244:247], v[92:95], v[76:79], v[244:247]
    v_mfma_f32_16x16x32_bf16 v[240:243], v[92:95], v[72:75], v[240:243]
    buffer_load_dwordx4 v[124:127], v3, s[20:23], s53 offen offset:2048 sc1
    v_mfma_f32_16x16x32_bf16 v[240:243], v[88:91], v[96:99], v[240:243]
    s_waitcnt lgkmcnt(4)
    v_mfma_f32_16x16x32_bf16 v[128:131], v[8:11], v[96:99], v[128:131]
    ds_read_b64_tr_b16 v[88:89], v2 offset:64
    v_mfma_f32_16x16x32_bf16 v[128:131], v[12:15], v[72:75], v[128:131]
    ds_read_b64_tr_b16 v[90:91], v2 offset:320
    v_mfma_f32_16x16x32_bf16 v[132:135], v[12:15], v[76:79], v[132:135]
    ds_read_b64_tr_b16 v[92:93], v2 offset:4288
    v_mfma_f32_16x16x32_bf16 v[132:135], v[8:11], v[100:103], v[132:135]
    ds_read_b64_tr_b16 v[94:95], v2 offset:4544
    v_mfma_f32_16x16x32_bf16 v[136:139], v[8:11], v[104:107], v[136:139]
    v_mfma_f32_16x16x32_bf16 v[136:139], v[12:15], v[80:83], v[136:139]
    v_mfma_f32_16x16x32_bf16 v[140:143], v[12:15], v[84:87], v[140:143]
    v_mfma_f32_16x16x32_bf16 v[140:143], v[8:11], v[108:111], v[140:143]
    s_waitcnt lgkmcnt(4)
    v_mfma_f32_16x16x32_bf16 v[156:159], v[16:19], v[108:111], v[156:159]
    ds_read_b64_tr_b16 v[8:9], v2 offset:96
    v_mfma_f32_16x16x32_bf16 v[156:159], v[20:23], v[84:87], v[156:159]
    ds_read_b64_tr_b16 v[10:11], v2 offset:352
    v_mfma_f32_16x16x32_bf16 v[152:155], v[20:23], v[80:83], v[152:155]
    ds_read_b64_tr_b16 v[12:13], v2 offset:4320
    v_mfma_f32_16x16x32_bf16 v[152:155], v[16:19], v[104:107], v[152:155]
    ds_read_b64_tr_b16 v[14:15], v2 offset:4576
    v_mfma_f32_16x16x32_bf16 v[148:151], v[16:19], v[100:103], v[148:151]
    v_mfma_f32_16x16x32_bf16 v[148:151], v[20:23], v[76:79], v[148:151]
    v_add_u32 v2, 16896, v2
    s_barrier
    v_mfma_f32_16x16x32_bf16 v[144:147], v[20:23], v[72:75], v[144:147]
    v_mfma_f32_16x16x32_bf16 v[144:147], v[16:19], v[96:99], v[144:147]
    s_waitcnt lgkmcnt(4)
    v_mfma_f32_16x16x32_bf16 v[160:163], v[88:91], v[96:99], v[160:163]
    ds_read_b64_tr_b16 v[16:17], v2 offset:8448
    v_mfma_f32_16x16x32_bf16 v[160:163], v[92:95], v[72:75], v[160:163]
    ds_read_b64_tr_b16 v[18:19], v2 offset:8704
    v_mfma_f32_16x16x32_bf16 v[164:167], v[92:95], v[76:79], v[164:167]
    ds_read_b64_tr_b16 v[20:21], v2 offset:12672
    v_mfma_f32_16x16x32_bf16 v[164:167], v[88:91], v[100:103], v[164:167]
    ds_read_b64_tr_b16 v[22:23], v2 offset:12928
    v_mfma_f32_16x16x32_bf16 v[168:171], v[88:91], v[104:107], v[168:171]
    v_mfma_f32_16x16x32_bf16 v[168:171], v[92:95], v[80:83], v[168:171]
    v_mfma_f32_16x16x32_bf16 v[172:175], v[92:95], v[84:87], v[172:175]
    v_mfma_f32_16x16x32_bf16 v[172:175], v[88:91], v[108:111], v[172:175]
    s_waitcnt lgkmcnt(4)
    v_mfma_f32_16x16x32_bf16 v[188:191], v[8:11], v[108:111], v[188:191]
    ds_read_b64_tr_b16 v[88:89], v2 offset:8480
    v_mfma_f32_16x16x32_bf16 v[188:191], v[12:15], v[84:87], v[188:191]
    ds_read_b64_tr_b16 v[90:91], v2 offset:8736
    v_mfma_f32_16x16x32_bf16 v[184:187], v[12:15], v[80:83], v[184:187]
    ds_read_b64_tr_b16 v[92:93], v2 offset:12704
    v_mfma_f32_16x16x32_bf16 v[184:187], v[8:11], v[104:107], v[184:187]
    ds_read_b64_tr_b16 v[94:95], v2 offset:12960
    v_mfma_f32_16x16x32_bf16 v[180:183], v[8:11], v[100:103], v[180:183]
    v_mfma_f32_16x16x32_bf16 v[180:183], v[12:15], v[76:79], v[180:183]
    v_mfma_f32_16x16x32_bf16 v[176:179], v[12:15], v[72:75], v[176:179]
    v_mfma_f32_16x16x32_bf16 v[176:179], v[8:11], v[96:99], v[176:179]
    s_waitcnt vmcnt(8)
    s_waitcnt lgkmcnt(4)
    v_mfma_f32_16x16x32_bf16 v[192:195], v[16:19], v[40:43], v[192:195]
    ds_read_b64_tr_b16 v[8:9], v2 offset:8512
    s_bfe_u32 s54, s5, 0x40004
    v_mfma_f32_16x16x32_bf16 v[192:195], v[20:23], v[56:59], v[192:195]
    ds_read_b64_tr_b16 v[10:11], v2 offset:8768
    s_lshl_b32 s54, s54, 17
    v_mfma_f32_16x16x32_bf16 v[196:199], v[20:23], v[60:63], v[196:199]
    ds_read_b64_tr_b16 v[12:13], v2 offset:12736
    s_add_u32 s54, s54, s46
    v_mfma_f32_16x16x32_bf16 v[196:199], v[16:19], v[44:47], v[196:199]
    ds_read_b64_tr_b16 v[14:15], v2 offset:12992
    s_add_u32 s53, s54, 4096
    v_mfma_f32_16x16x32_bf16 v[200:203], v[16:19], v[48:51], v[200:203]
    buffer_load_dwordx4 v[96:99], v1, s[20:23], s54 offen offset:0 sc1
    v_mfma_f32_16x16x32_bf16 v[200:203], v[20:23], v[64:67], v[200:203]
    v_mfma_f32_16x16x32_bf16 v[204:207], v[20:23], v[68:71], v[204:207]
    buffer_load_dwordx4 v[100:103], v1, s[20:23], s53 offen offset:0 sc1
    v_mfma_f32_16x16x32_bf16 v[204:207], v[16:19], v[52:55], v[204:207]
    s_waitcnt lgkmcnt(4)
    v_mfma_f32_16x16x32_bf16 v[220:223], v[88:91], v[52:55], v[220:223]
    ds_read_b64_tr_b16 v[16:17], v2 offset:8544
    v_mfma_f32_16x16x32_bf16 v[220:223], v[92:95], v[68:71], v[220:223]
    ds_read_b64_tr_b16 v[18:19], v2 offset:8800
    v_mfma_f32_16x16x32_bf16 v[216:219], v[92:95], v[64:67], v[216:219]
    ds_read_b64_tr_b16 v[20:21], v2 offset:12768
    v_mfma_f32_16x16x32_bf16 v[216:219], v[88:91], v[48:51], v[216:219]
    ds_read_b64_tr_b16 v[22:23], v2 offset:13024
    v_mfma_f32_16x16x32_bf16 v[212:215], v[88:91], v[44:47], v[212:215]
    buffer_load_dwordx4 v[104:107], v3, s[20:23], s54 offen offset:0 sc1
    v_mfma_f32_16x16x32_bf16 v[212:215], v[92:95], v[60:63], v[212:215]
    v_mfma_f32_16x16x32_bf16 v[208:211], v[92:95], v[56:59], v[208:211]
    buffer_load_dwordx4 v[108:111], v3, s[20:23], s53 offen offset:0 sc1
    v_mfma_f32_16x16x32_bf16 v[208:211], v[88:91], v[40:43], v[208:211]
    s_waitcnt lgkmcnt(4)
    v_mfma_f32_16x16x32_bf16 v[224:227], v[8:11], v[40:43], v[224:227]
    ds_read_b64_tr_b16 v[88:89], v2 offset:0
    v_mfma_f32_16x16x32_bf16 v[224:227], v[12:15], v[56:59], v[224:227]
    ds_read_b64_tr_b16 v[90:91], v2 offset:256
    v_mfma_f32_16x16x32_bf16 v[228:231], v[12:15], v[60:63], v[228:231]
    ds_read_b64_tr_b16 v[92:93], v2 offset:4224
    v_mfma_f32_16x16x32_bf16 v[228:231], v[8:11], v[44:47], v[228:231]
    ds_read_b64_tr_b16 v[94:95], v2 offset:4480
    v_mfma_f32_16x16x32_bf16 v[232:235], v[8:11], v[48:51], v[232:235]
    buffer_load_dwordx4 v[72:75], v1, s[20:23], s54 offen offset:2048 sc1
    v_mfma_f32_16x16x32_bf16 v[232:235], v[12:15], v[64:67], v[232:235]
    v_mfma_f32_16x16x32_bf16 v[236:239], v[12:15], v[68:71], v[236:239]
    buffer_load_dwordx4 v[76:79], v1, s[20:23], s53 offen offset:2048 sc1
    v_mfma_f32_16x16x32_bf16 v[236:239], v[8:11], v[52:55], v[236:239]
    s_waitcnt lgkmcnt(4)
    v_mfma_f32_16x16x32_bf16 v[252:255], v[16:19], v[52:55], v[252:255]
    ds_read_b64_tr_b16 v[8:9], v2 offset:32
    v_mfma_f32_16x16x32_bf16 v[252:255], v[20:23], v[68:71], v[252:255]
    ds_read_b64_tr_b16 v[10:11], v2 offset:288
    v_mfma_f32_16x16x32_bf16 v[248:251], v[20:23], v[64:67], v[248:251]
    ds_read_b64_tr_b16 v[12:13], v2 offset:4256
    v_mfma_f32_16x16x32_bf16 v[248:251], v[16:19], v[48:51], v[248:251]
    ds_read_b64_tr_b16 v[14:15], v2 offset:4512
    v_mfma_f32_16x16x32_bf16 v[244:247], v[16:19], v[44:47], v[244:247]
    buffer_load_dwordx4 v[80:83], v3, s[20:23], s54 offen offset:2048 sc1
    v_mfma_f32_16x16x32_bf16 v[244:247], v[20:23], v[60:63], v[244:247]
    v_mfma_f32_16x16x32_bf16 v[240:243], v[20:23], v[56:59], v[240:243]
    buffer_load_dwordx4 v[84:87], v3, s[20:23], s53 offen offset:2048 sc1
    v_mfma_f32_16x16x32_bf16 v[240:243], v[16:19], v[40:43], v[240:243]
    s_waitcnt lgkmcnt(4)
    v_mfma_f32_16x16x32_bf16 v[128:131], v[88:91], v[40:43], v[128:131]
    ds_read_b64_tr_b16 v[16:17], v2 offset:64
    v_mfma_f32_16x16x32_bf16 v[128:131], v[92:95], v[56:59], v[128:131]
    ds_read_b64_tr_b16 v[18:19], v2 offset:320
    v_mfma_f32_16x16x32_bf16 v[132:135], v[92:95], v[60:63], v[132:135]
    ds_read_b64_tr_b16 v[20:21], v2 offset:4288
    v_mfma_f32_16x16x32_bf16 v[132:135], v[88:91], v[44:47], v[132:135]
    ds_read_b64_tr_b16 v[22:23], v2 offset:4544
    v_mfma_f32_16x16x32_bf16 v[136:139], v[88:91], v[48:51], v[136:139]
    v_mfma_f32_16x16x32_bf16 v[136:139], v[92:95], v[64:67], v[136:139]
    v_mfma_f32_16x16x32_bf16 v[140:143], v[92:95], v[68:71], v[140:143]
    v_mfma_f32_16x16x32_bf16 v[140:143], v[88:91], v[52:55], v[140:143]
    s_waitcnt lgkmcnt(4)
    v_mfma_f32_16x16x32_bf16 v[156:159], v[8:11], v[52:55], v[156:159]
    ds_read_b64_tr_b16 v[88:89], v2 offset:96
    v_mfma_f32_16x16x32_bf16 v[156:159], v[12:15], v[68:71], v[156:159]
    ds_read_b64_tr_b16 v[90:91], v2 offset:352
    v_mfma_f32_16x16x32_bf16 v[152:155], v[12:15], v[64:67], v[152:155]
    ds_read_b64_tr_b16 v[92:93], v2 offset:4320
    v_mfma_f32_16x16x32_bf16 v[152:155], v[8:11], v[48:51], v[152:155]
    ds_read_b64_tr_b16 v[94:95], v2 offset:4576
    v_mfma_f32_16x16x32_bf16 v[148:151], v[8:11], v[44:47], v[148:151]
    v_mfma_f32_16x16x32_bf16 v[148:151], v[12:15], v[60:63], v[148:151]
    v_add_u32 v2, 16896, v2
    s_barrier
    v_mfma_f32_16x16x32_bf16 v[144:147], v[12:15], v[56:59], v[144:147]
    v_mfma_f32_16x16x32_bf16 v[144:147], v[8:11], v[40:43], v[144:147]
    s_waitcnt lgkmcnt(4)
    v_mfma_f32_16x16x32_bf16 v[160:163], v[16:19], v[40:43], v[160:163]
    ds_read_b64_tr_b16 v[8:9], v2 offset:8448
    v_mfma_f32_16x16x32_bf16 v[160:163], v[20:23], v[56:59], v[160:163]
    ds_read_b64_tr_b16 v[10:11], v2 offset:8704
    v_mfma_f32_16x16x32_bf16 v[164:167], v[20:23], v[60:63], v[164:167]
    ds_read_b64_tr_b16 v[12:13], v2 offset:12672
    v_mfma_f32_16x16x32_bf16 v[164:167], v[16:19], v[44:47], v[164:167]
    ds_read_b64_tr_b16 v[14:15], v2 offset:12928
    v_mfma_f32_16x16x32_bf16 v[168:171], v[16:19], v[48:51], v[168:171]
    v_mfma_f32_16x16x32_bf16 v[168:171], v[20:23], v[64:67], v[168:171]
    v_mfma_f32_16x16x32_bf16 v[172:175], v[20:23], v[68:71], v[172:175]
    v_mfma_f32_16x16x32_bf16 v[172:175], v[16:19], v[52:55], v[172:175]
    s_waitcnt lgkmcnt(4)
    v_mfma_f32_16x16x32_bf16 v[188:191], v[88:91], v[52:55], v[188:191]
    ds_read_b64_tr_b16 v[16:17], v2 offset:8480
    v_mfma_f32_16x16x32_bf16 v[188:191], v[92:95], v[68:71], v[188:191]
    ds_read_b64_tr_b16 v[18:19], v2 offset:8736
    v_mfma_f32_16x16x32_bf16 v[184:187], v[92:95], v[64:67], v[184:187]
    ds_read_b64_tr_b16 v[20:21], v2 offset:12704
    v_mfma_f32_16x16x32_bf16 v[184:187], v[88:91], v[48:51], v[184:187]
    ds_read_b64_tr_b16 v[22:23], v2 offset:12960
    v_mfma_f32_16x16x32_bf16 v[180:183], v[88:91], v[44:47], v[180:183]
    v_mfma_f32_16x16x32_bf16 v[180:183], v[92:95], v[60:63], v[180:183]
    v_mfma_f32_16x16x32_bf16 v[176:179], v[92:95], v[56:59], v[176:179]
    v_mfma_f32_16x16x32_bf16 v[176:179], v[88:91], v[40:43], v[176:179]
    s_waitcnt vmcnt(8)
    s_waitcnt lgkmcnt(4)
    v_mfma_f32_16x16x32_bf16 v[192:195], v[8:11], v[24:27], v[192:195]
    ds_read_b64_tr_b16 v[88:89], v2 offset:8512
    s_bfe_u32 s54, s5, 0x40008
    v_mfma_f32_16x16x32_bf16 v[192:195], v[12:15], v[112:115], v[192:195]
    ds_read_b64_tr_b16 v[90:91], v2 offset:8768
    s_lshl_b32 s54, s54, 17
    v_mfma_f32_16x16x32_bf16 v[196:199], v[12:15], v[116:119], v[196:199]
    ds_read_b64_tr_b16 v[92:93], v2 offset:12736
    s_add_u32 s54, s54, s46
    v_mfma_f32_16x16x32_bf16 v[196:199], v[8:11], v[28:31], v[196:199]
    ds_read_b64_tr_b16 v[94:95], v2 offset:12992
    s_add_u32 s53, s54, 4096
    v_mfma_f32_16x16x32_bf16 v[200:203], v[8:11], v[32:35], v[200:203]
    buffer_load_dwordx4 v[40:43], v1, s[20:23], s54 offen offset:0 sc1
    v_mfma_f32_16x16x32_bf16 v[200:203], v[12:15], v[120:123], v[200:203]
    v_mfma_f32_16x16x32_bf16 v[204:207], v[12:15], v[124:127], v[204:207]
    buffer_load_dwordx4 v[44:47], v1, s[20:23], s53 offen offset:0 sc1
    v_mfma_f32_16x16x32_bf16 v[204:207], v[8:11], v[36:39], v[204:207]
    s_waitcnt lgkmcnt(4)
    v_mfma_f32_16x16x32_bf16 v[220:223], v[16:19], v[36:39], v[220:223]
    ds_read_b64_tr_b16 v[8:9], v2 offset:8544
    v_mfma_f32_16x16x32_bf16 v[220:223], v[20:23], v[124:127], v[220:223]
    ds_read_b64_tr_b16 v[10:11], v2 offset:8800
    v_mfma_f32_16x16x32_bf16 v[216:219], v[20:23], v[120:123], v[216:219]
    ds_read_b64_tr_b16 v[12:13], v2 offset:12768
    v_mfma_f32_16x16x32_bf16 v[216:219], v[16:19], v[32:35], v[216:219]
    ds_read_b64_tr_b16 v[14:15], v2 offset:13024
    v_mfma_f32_16x16x32_bf16 v[212:215], v[16:19], v[28:31], v[212:215]
    buffer_load_dwordx4 v[48:51], v3, s[20:23], s54 offen offset:0 sc1
    v_mfma_f32_16x16x32_bf16 v[212:215], v[20:23], v[116:119], v[212:215]
    v_mfma_f32_16x16x32_bf16 v[208:211], v[20:23], v[112:115], v[208:211]
    buffer_load_dwordx4 v[52:55], v3, s[20:23], s53 offen offset:0 sc1
    v_mfma_f32_16x16x32_bf16 v[208:211], v[16:19], v[24:27], v[208:211]
    s_waitcnt lgkmcnt(4)
    v_mfma_f32_16x16x32_bf16 v[224:227], v[88:91], v[24:27], v[224:227]
    ds_read_b64_tr_b16 v[16:17], v2 offset:0
    v_mfma_f32_16x16x32_bf16 v[224:227], v[92:95], v[112:115], v[224:227]
    ds_read_b64_tr_b16 v[18:19], v2 offset:256
    v_mfma_f32_16x16x32_bf16 v[228:231], v[92:95], v[116:119], v[228:231]
    ds_read_b64_tr_b16 v[20:21], v2 offset:4224
    v_mfma_f32_16x16x32_bf16 v[228:231], v[88:91], v[28:31], v[228:231]
    ds_read_b64_tr_b16 v[22:23], v2 offset:4480
    v_mfma_f32_16x16x32_bf16 v[232:235], v[88:91], v[32:35], v[232:235]
    buffer_load_dwordx4 v[56:59], v1, s[20:23], s54 offen offset:2048 sc1
    v_mfma_f32_16x16x32_bf16 v[232:235], v[92:95], v[120:123], v[232:235]
    v_mfma_f32_16x16x32_bf16 v[236:239], v[92:95], v[124:127], v[236:239]
    buffer_load_dwordx4 v[60:63], v1, s[20:23], s53 offen offset:2048 sc1
    v_mfma_f32_16x16x32_bf16 v[236:239], v[88:91], v[36:39], v[236:239]
    s_waitcnt lgkmcnt(4)
    v_mfma_f32_16x16x32_bf16 v[252:255], v[8:11], v[36:39], v[252:255]
    ds_read_b64_tr_b16 v[88:89], v2 offset:32
    v_mfma_f32_16x16x32_bf16 v[252:255], v[12:15], v[124:127], v[252:255]
    ds_read_b64_tr_b16 v[90:91], v2 offset:288
    v_mfma_f32_16x16x32_bf16 v[248:251], v[12:15], v[120:123], v[248:251]
    ds_read_b64_tr_b16 v[92:93], v2 offset:4256
    v_mfma_f32_16x16x32_bf16 v[248:251], v[8:11], v[32:35], v[248:251]
    ds_read_b64_tr_b16 v[94:95], v2 offset:4512
    v_mfma_f32_16x16x32_bf16 v[244:247], v[8:11], v[28:31], v[244:247]
    buffer_load_dwordx4 v[64:67], v3, s[20:23], s54 offen offset:2048 sc1
    v_mfma_f32_16x16x32_bf16 v[244:247], v[12:15], v[116:119], v[244:247]
    v_mfma_f32_16x16x32_bf16 v[240:243], v[12:15], v[112:115], v[240:243]
    buffer_load_dwordx4 v[68:71], v3, s[20:23], s53 offen offset:2048 sc1
    v_mfma_f32_16x16x32_bf16 v[240:243], v[8:11], v[24:27], v[240:243]
    s_waitcnt lgkmcnt(4)
    v_mfma_f32_16x16x32_bf16 v[128:131], v[16:19], v[24:27], v[128:131]
    ds_read_b64_tr_b16 v[8:9], v2 offset:64
    v_mfma_f32_16x16x32_bf16 v[128:131], v[20:23], v[112:115], v[128:131]
    ds_read_b64_tr_b16 v[10:11], v2 offset:320
    v_mfma_f32_16x16x32_bf16 v[132:135], v[20:23], v[116:119], v[132:135]
    ds_read_b64_tr_b16 v[12:13], v2 offset:4288
    v_mfma_f32_16x16x32_bf16 v[132:135], v[16:19], v[28:31], v[132:135]
    ds_read_b64_tr_b16 v[14:15], v2 offset:4544
    v_mfma_f32_16x16x32_bf16 v[136:139], v[16:19], v[32:35], v[136:139]
    v_mfma_f32_16x16x32_bf16 v[136:139], v[20:23], v[120:123], v[136:139]
    v_mfma_f32_16x16x32_bf16 v[140:143], v[20:23], v[124:127], v[140:143]
    v_mfma_f32_16x16x32_bf16 v[140:143], v[16:19], v[36:39], v[140:143]
    s_waitcnt lgkmcnt(4)
    v_mfma_f32_16x16x32_bf16 v[156:159], v[88:91], v[36:39], v[156:159]
    ds_read_b64_tr_b16 v[16:17], v2 offset:96
    v_mfma_f32_16x16x32_bf16 v[156:159], v[92:95], v[124:127], v[156:159]
    ds_read_b64_tr_b16 v[18:19], v2 offset:352
    v_mfma_f32_16x16x32_bf16 v[152:155], v[92:95], v[120:123], v[152:155]
    ds_read_b64_tr_b16 v[20:21], v2 offset:4320
    v_mfma_f32_16x16x32_bf16 v[152:155], v[88:91], v[32:35], v[152:155]
    ds_read_b64_tr_b16 v[22:23], v2 offset:4576
    v_mfma_f32_16x16x32_bf16 v[148:151], v[88:91], v[28:31], v[148:151]
    v_mfma_f32_16x16x32_bf16 v[148:151], v[92:95], v[116:119], v[148:151]
    v_add_u32 v2, 16896, v2
    s_barrier
    v_mfma_f32_16x16x32_bf16 v[144:147], v[92:95], v[112:115], v[144:147]
    v_mfma_f32_16x16x32_bf16 v[144:147], v[88:91], v[24:27], v[144:147]
    s_waitcnt lgkmcnt(4)
    v_mfma_f32_16x16x32_bf16 v[160:163], v[8:11], v[24:27], v[160:163]
    ds_read_b64_tr_b16 v[88:89], v2 offset:8448
    v_mfma_f32_16x16x32_bf16 v[160:163], v[12:15], v[112:115], v[160:163]
    ds_read_b64_tr_b16 v[90:91], v2 offset:8704
    v_mfma_f32_16x16x32_bf16 v[164:167], v[12:15], v[116:119], v[164:167]
    ds_read_b64_tr_b16 v[92:93], v2 offset:12672
    v_mfma_f32_16x16x32_bf16 v[164:167], v[8:11], v[28:31], v[164:167]
    ds_read_b64_tr_b16 v[94:95], v2 offset:12928
    v_mfma_f32_16x16x32_bf16 v[168:171], v[8:11], v[32:35], v[168:171]
    v_mfma_f32_16x16x32_bf16 v[168:171], v[12:15], v[120:123], v[168:171]
    v_mfma_f32_16x16x32_bf16 v[172:175], v[12:15], v[124:127], v[172:175]
    v_mfma_f32_16x16x32_bf16 v[172:175], v[8:11], v[36:39], v[172:175]
    s_waitcnt lgkmcnt(4)
    v_mfma_f32_16x16x32_bf16 v[188:191], v[16:19], v[36:39], v[188:191]
    ds_read_b64_tr_b16 v[8:9], v2 offset:8480
    v_mfma_f32_16x16x32_bf16 v[188:191], v[20:23], v[124:127], v[188:191]
    ds_read_b64_tr_b16 v[10:11], v2 offset:8736
    v_mfma_f32_16x16x32_bf16 v[184:187], v[20:23], v[120:123], v[184:187]
    ds_read_b64_tr_b16 v[12:13], v2 offset:12704
    v_mfma_f32_16x16x32_bf16 v[184:187], v[16:19], v[32:35], v[184:187]
    ds_read_b64_tr_b16 v[14:15], v2 offset:12960
    v_mfma_f32_16x16x32_bf16 v[180:183], v[16:19], v[28:31], v[180:183]
    v_mfma_f32_16x16x32_bf16 v[180:183], v[20:23], v[116:119], v[180:183]
    v_mfma_f32_16x16x32_bf16 v[176:179], v[20:23], v[112:115], v[176:179]
    v_mfma_f32_16x16x32_bf16 v[176:179], v[16:19], v[24:27], v[176:179]
    s_waitcnt vmcnt(8)
    s_waitcnt lgkmcnt(4)
    v_mfma_f32_16x16x32_bf16 v[192:195], v[88:91], v[96:99], v[192:195]
    ds_read_b64_tr_b16 v[16:17], v2 offset:8512
    s_bfe_u32 s54, s5, 0x4000c
    v_mfma_f32_16x16x32_bf16 v[192:195], v[92:95], v[72:75], v[192:195]
    ds_read_b64_tr_b16 v[18:19], v2 offset:8768
    s_lshl_b32 s54, s54, 17
    v_mfma_f32_16x16x32_bf16 v[196:199], v[92:95], v[76:79], v[196:199]
    ds_read_b64_tr_b16 v[20:21], v2 offset:12736
    s_add_u32 s54, s54, s46
    v_mfma_f32_16x16x32_bf16 v[196:199], v[88:91], v[100:103], v[196:199]
    ds_read_b64_tr_b16 v[22:23], v2 offset:12992
    s_add_u32 s53, s54, 4096
    v_mfma_f32_16x16x32_bf16 v[200:203], v[88:91], v[104:107], v[200:203]
    buffer_load_dwordx4 v[24:27], v1, s[20:23], s54 offen offset:0 sc1
    v_mfma_f32_16x16x32_bf16 v[200:203], v[92:95], v[80:83], v[200:203]
    v_mfma_f32_16x16x32_bf16 v[204:207], v[92:95], v[84:87], v[204:207]
    buffer_load_dwordx4 v[28:31], v1, s[20:23], s53 offen offset:0 sc1
    v_mfma_f32_16x16x32_bf16 v[204:207], v[88:91], v[108:111], v[204:207]
    s_waitcnt lgkmcnt(4)
    v_mfma_f32_16x16x32_bf16 v[220:223], v[8:11], v[108:111], v[220:223]
    ds_read_b64_tr_b16 v[88:89], v2 offset:8544
    v_mfma_f32_16x16x32_bf16 v[220:223], v[12:15], v[84:87], v[220:223]
    ds_read_b64_tr_b16 v[90:91], v2 offset:8800
    v_mfma_f32_16x16x32_bf16 v[216:219], v[12:15], v[80:83], v[216:219]
    ds_read_b64_tr_b16 v[92:93], v2 offset:12768
    v_mfma_f32_16x16x32_bf16 v[216:219], v[8:11], v[104:107], v[216:219]
    ds_read_b64_tr_b16 v[94:95], v2 offset:13024
    v_mfma_f32_16x16x32_bf16 v[212:215], v[8:11], v[100:103], v[212:215]
    buffer_load_dwordx4 v[32:35], v3, s[20:23], s54 offen offset:0 sc1
    v_mfma_f32_16x16x32_bf16 v[212:215], v[12:15], v[76:79], v[212:215]
    v_mfma_f32_16x16x32_bf16 v[208:211], v[12:15], v[72:75], v[208:211]
    buffer_load_dwordx4 v[36:39], v3, s[20:23], s53 offen offset:0 sc1
    v_mfma_f32_16x16x32_bf16 v[208:211], v[8:11], v[96:99], v[208:211]
    s_waitcnt lgkmcnt(4)
    v_mfma_f32_16x16x32_bf16 v[224:227], v[16:19], v[96:99], v[224:227]
    ds_read_b64_tr_b16 v[8:9], v2 offset:0
    v_mfma_f32_16x16x32_bf16 v[224:227], v[20:23], v[72:75], v[224:227]
    ds_read_b64_tr_b16 v[10:11], v2 offset:256
    v_mfma_f32_16x16x32_bf16 v[228:231], v[20:23], v[76:79], v[228:231]
    ds_read_b64_tr_b16 v[12:13], v2 offset:4224
    v_mfma_f32_16x16x32_bf16 v[228:231], v[16:19], v[100:103], v[228:231]
    ds_read_b64_tr_b16 v[14:15], v2 offset:4480
    v_mfma_f32_16x16x32_bf16 v[232:235], v[16:19], v[104:107], v[232:235]
    buffer_load_dwordx4 v[112:115], v1, s[20:23], s54 offen offset:2048 sc1
    v_mfma_f32_16x16x32_bf16 v[232:235], v[20:23], v[80:83], v[232:235]
    v_mfma_f32_16x16x32_bf16 v[236:239], v[20:23], v[84:87], v[236:239]
    buffer_load_dwordx4 v[116:119], v1, s[20:23], s53 offen offset:2048 sc1
    v_mfma_f32_16x16x32_bf16 v[236:239], v[16:19], v[108:111], v[236:239]
    s_waitcnt lgkmcnt(4)
    v_mfma_f32_16x16x32_bf16 v[252:255], v[88:91], v[108:111], v[252:255]
    ds_read_b64_tr_b16 v[16:17], v2 offset:32
    v_mfma_f32_16x16x32_bf16 v[252:255], v[92:95], v[84:87], v[252:255]
    ds_read_b64_tr_b16 v[18:19], v2 offset:288
    v_mfma_f32_16x16x32_bf16 v[248:251], v[92:95], v[80:83], v[248:251]
    ds_read_b64_tr_b16 v[20:21], v2 offset:4256
    v_mfma_f32_16x16x32_bf16 v[248:251], v[88:91], v[104:107], v[248:251]
    ds_read_b64_tr_b16 v[22:23], v2 offset:4512
    v_mfma_f32_16x16x32_bf16 v[244:247], v[88:91], v[100:103], v[244:247]
    buffer_load_dwordx4 v[120:123], v3, s[20:23], s54 offen offset:2048 sc1
    v_mfma_f32_16x16x32_bf16 v[244:247], v[92:95], v[76:79], v[244:247]
    v_mfma_f32_16x16x32_bf16 v[240:243], v[92:95], v[72:75], v[240:243]
    buffer_load_dwordx4 v[124:127], v3, s[20:23], s53 offen offset:2048 sc1
    v_mfma_f32_16x16x32_bf16 v[240:243], v[88:91], v[96:99], v[240:243]
    s_waitcnt lgkmcnt(4)
    v_mfma_f32_16x16x32_bf16 v[128:131], v[8:11], v[96:99], v[128:131]
    ds_read_b64_tr_b16 v[88:89], v2 offset:64
    v_mfma_f32_16x16x32_bf16 v[128:131], v[12:15], v[72:75], v[128:131]
    ds_read_b64_tr_b16 v[90:91], v2 offset:320
    v_mfma_f32_16x16x32_bf16 v[132:135], v[12:15], v[76:79], v[132:135]
    ds_read_b64_tr_b16 v[92:93], v2 offset:4288
    v_mfma_f32_16x16x32_bf16 v[132:135], v[8:11], v[100:103], v[132:135]
    ds_read_b64_tr_b16 v[94:95], v2 offset:4544
    v_mfma_f32_16x16x32_bf16 v[136:139], v[8:11], v[104:107], v[136:139]
    v_mfma_f32_16x16x32_bf16 v[136:139], v[12:15], v[80:83], v[136:139]
    v_mfma_f32_16x16x32_bf16 v[140:143], v[12:15], v[84:87], v[140:143]
    v_mfma_f32_16x16x32_bf16 v[140:143], v[8:11], v[108:111], v[140:143]
    s_waitcnt lgkmcnt(4)
    v_mfma_f32_16x16x32_bf16 v[156:159], v[16:19], v[108:111], v[156:159]
    ds_read_b64_tr_b16 v[8:9], v2 offset:96
    v_mfma_f32_16x16x32_bf16 v[156:159], v[20:23], v[84:87], v[156:159]
    ds_read_b64_tr_b16 v[10:11], v2 offset:352
    v_mfma_f32_16x16x32_bf16 v[152:155], v[20:23], v[80:83], v[152:155]
    ds_read_b64_tr_b16 v[12:13], v2 offset:4320
    v_mfma_f32_16x16x32_bf16 v[152:155], v[16:19], v[104:107], v[152:155]
    ds_read_b64_tr_b16 v[14:15], v2 offset:4576
    v_mfma_f32_16x16x32_bf16 v[148:151], v[16:19], v[100:103], v[148:151]
    v_mfma_f32_16x16x32_bf16 v[148:151], v[20:23], v[76:79], v[148:151]
    v_add_u32 v2, 16896, v2
    s_barrier
    v_mfma_f32_16x16x32_bf16 v[144:147], v[20:23], v[72:75], v[144:147]
    v_mfma_f32_16x16x32_bf16 v[144:147], v[16:19], v[96:99], v[144:147]
    s_waitcnt lgkmcnt(4)
    v_mfma_f32_16x16x32_bf16 v[160:163], v[88:91], v[96:99], v[160:163]
    ds_read_b64_tr_b16 v[16:17], v2 offset:8448
    v_mfma_f32_16x16x32_bf16 v[160:163], v[92:95], v[72:75], v[160:163]
    ds_read_b64_tr_b16 v[18:19], v2 offset:8704
    v_mfma_f32_16x16x32_bf16 v[164:167], v[92:95], v[76:79], v[164:167]
    ds_read_b64_tr_b16 v[20:21], v2 offset:12672
    v_mfma_f32_16x16x32_bf16 v[164:167], v[88:91], v[100:103], v[164:167]
    ds_read_b64_tr_b16 v[22:23], v2 offset:12928
    v_mfma_f32_16x16x32_bf16 v[168:171], v[88:91], v[104:107], v[168:171]
    v_mfma_f32_16x16x32_bf16 v[168:171], v[92:95], v[80:83], v[168:171]
    v_mfma_f32_16x16x32_bf16 v[172:175], v[92:95], v[84:87], v[172:175]
    v_mfma_f32_16x16x32_bf16 v[172:175], v[88:91], v[108:111], v[172:175]
    s_waitcnt lgkmcnt(4)
    v_mfma_f32_16x16x32_bf16 v[188:191], v[8:11], v[108:111], v[188:191]
    ds_read_b64_tr_b16 v[88:89], v2 offset:8480
    v_mfma_f32_16x16x32_bf16 v[188:191], v[12:15], v[84:87], v[188:191]
    ds_read_b64_tr_b16 v[90:91], v2 offset:8736
    v_mfma_f32_16x16x32_bf16 v[184:187], v[12:15], v[80:83], v[184:187]
    ds_read_b64_tr_b16 v[92:93], v2 offset:12704
    v_mfma_f32_16x16x32_bf16 v[184:187], v[8:11], v[104:107], v[184:187]
    ds_read_b64_tr_b16 v[94:95], v2 offset:12960
    v_mfma_f32_16x16x32_bf16 v[180:183], v[8:11], v[100:103], v[180:183]
    v_mfma_f32_16x16x32_bf16 v[180:183], v[12:15], v[76:79], v[180:183]
    v_mfma_f32_16x16x32_bf16 v[176:179], v[12:15], v[72:75], v[176:179]
    v_mfma_f32_16x16x32_bf16 v[176:179], v[8:11], v[96:99], v[176:179]
    s_waitcnt vmcnt(8)
    s_waitcnt lgkmcnt(4)
    v_mfma_f32_16x16x32_bf16 v[192:195], v[16:19], v[40:43], v[192:195]
    ds_read_b64_tr_b16 v[8:9], v2 offset:8512
    s_add_u32 s54, s46, 786432
    v_mfma_f32_16x16x32_bf16 v[192:195], v[20:23], v[56:59], v[192:195]
    ds_read_b64_tr_b16 v[10:11], v2 offset:8768
    s_add_u32 s53, s46, 790528
    v_mfma_f32_16x16x32_bf16 v[196:199], v[20:23], v[60:63], v[196:199]
    ds_read_b64_tr_b16 v[12:13], v2 offset:12736
    v_mfma_f32_16x16x32_bf16 v[196:199], v[16:19], v[44:47], v[196:199]
    ds_read_b64_tr_b16 v[14:15], v2 offset:12992
    v_mfma_f32_16x16x32_bf16 v[200:203], v[16:19], v[48:51], v[200:203]
    buffer_load_dwordx4 v[96:99], v3, s[20:23], s54 offen offset:0 sc1
    v_mfma_f32_16x16x32_bf16 v[200:203], v[20:23], v[64:67], v[200:203]
    v_mfma_f32_16x16x32_bf16 v[204:207], v[20:23], v[68:71], v[204:207]
    buffer_load_dwordx4 v[100:103], v3, s[20:23], s53 offen offset:0 sc1
    v_mfma_f32_16x16x32_bf16 v[204:207], v[16:19], v[52:55], v[204:207]
    s_waitcnt lgkmcnt(4)
    v_mfma_f32_16x16x32_bf16 v[220:223], v[88:91], v[52:55], v[220:223]
    ds_read_b64_tr_b16 v[16:17], v2 offset:8544
    v_mfma_f32_16x16x32_bf16 v[220:223], v[92:95], v[68:71], v[220:223]
    ds_read_b64_tr_b16 v[18:19], v2 offset:8800
    v_mfma_f32_16x16x32_bf16 v[216:219], v[92:95], v[64:67], v[216:219]
    ds_read_b64_tr_b16 v[20:21], v2 offset:12768
    v_mfma_f32_16x16x32_bf16 v[216:219], v[88:91], v[48:51], v[216:219]
    ds_read_b64_tr_b16 v[22:23], v2 offset:13024
    v_mfma_f32_16x16x32_bf16 v[212:215], v[88:91], v[44:47], v[212:215]
    buffer_load_dwordx4 v[104:107], v3, s[20:23], s54 offen offset:2048 sc1
    v_mfma_f32_16x16x32_bf16 v[212:215], v[92:95], v[60:63], v[212:215]
    v_mfma_f32_16x16x32_bf16 v[208:211], v[92:95], v[56:59], v[208:211]
    buffer_load_dwordx4 v[108:111], v3, s[20:23], s53 offen offset:2048 sc1
    v_mfma_f32_16x16x32_bf16 v[208:211], v[88:91], v[40:43], v[208:211]
    s_add_u32 s54, s46, 1703936
    s_waitcnt lgkmcnt(4)
    v_mfma_f32_16x16x32_bf16 v[224:227], v[8:11], v[40:43], v[224:227]
    ds_read_b64_tr_b16 v[88:89], v2 offset:0
    s_add_u32 s53, s46, 1708032
    v_mfma_f32_16x16x32_bf16 v[224:227], v[12:15], v[56:59], v[224:227]
    ds_read_b64_tr_b16 v[90:91], v2 offset:256
    v_mfma_f32_16x16x32_bf16 v[228:231], v[12:15], v[60:63], v[228:231]
    ds_read_b64_tr_b16 v[92:93], v2 offset:4224
    v_mfma_f32_16x16x32_bf16 v[228:231], v[8:11], v[44:47], v[228:231]
    ds_read_b64_tr_b16 v[94:95], v2 offset:4480
    v_mfma_f32_16x16x32_bf16 v[232:235], v[8:11], v[48:51], v[232:235]
    buffer_load_dwordx4 v[72:75], v3, s[20:23], s54 offen offset:0 sc1
    v_mfma_f32_16x16x32_bf16 v[232:235], v[12:15], v[64:67], v[232:235]
    v_mfma_f32_16x16x32_bf16 v[236:239], v[12:15], v[68:71], v[236:239]
    buffer_load_dwordx4 v[76:79], v3, s[20:23], s53 offen offset:0 sc1
    v_mfma_f32_16x16x32_bf16 v[236:239], v[8:11], v[52:55], v[236:239]
    s_waitcnt lgkmcnt(4)
    v_mfma_f32_16x16x32_bf16 v[252:255], v[16:19], v[52:55], v[252:255]
    ds_read_b64_tr_b16 v[8:9], v2 offset:32
    v_mfma_f32_16x16x32_bf16 v[252:255], v[20:23], v[68:71], v[252:255]
    ds_read_b64_tr_b16 v[10:11], v2 offset:288
    v_mfma_f32_16x16x32_bf16 v[248:251], v[20:23], v[64:67], v[248:251]
    ds_read_b64_tr_b16 v[12:13], v2 offset:4256
    v_mfma_f32_16x16x32_bf16 v[248:251], v[16:19], v[48:51], v[248:251]
    ds_read_b64_tr_b16 v[14:15], v2 offset:4512
    v_mfma_f32_16x16x32_bf16 v[244:247], v[16:19], v[44:47], v[244:247]
    buffer_load_dwordx4 v[80:83], v3, s[20:23], s54 offen offset:2048 sc1
    v_mfma_f32_16x16x32_bf16 v[244:247], v[20:23], v[60:63], v[244:247]
    v_mfma_f32_16x16x32_bf16 v[240:243], v[20:23], v[56:59], v[240:243]
    buffer_load_dwordx4 v[84:87], v3, s[20:23], s53 offen offset:2048 sc1
    v_mfma_f32_16x16x32_bf16 v[240:243], v[16:19], v[40:43], v[240:243]
    s_waitcnt lgkmcnt(4)
    v_mfma_f32_16x16x32_bf16 v[128:131], v[88:91], v[40:43], v[128:131]
    ds_read_b64_tr_b16 v[16:17], v2 offset:64
    v_mfma_f32_16x16x32_bf16 v[128:131], v[92:95], v[56:59], v[128:131]
    ds_read_b64_tr_b16 v[18:19], v2 offset:320
    v_mfma_f32_16x16x32_bf16 v[132:135], v[92:95], v[60:63], v[132:135]
    ds_read_b64_tr_b16 v[20:21], v2 offset:4288
    v_mfma_f32_16x16x32_bf16 v[132:135], v[88:91], v[44:47], v[132:135]
    ds_read_b64_tr_b16 v[22:23], v2 offset:4544
    v_mfma_f32_16x16x32_bf16 v[136:139], v[88:91], v[48:51], v[136:139]
    v_mfma_f32_16x16x32_bf16 v[136:139], v[92:95], v[64:67], v[136:139]
    v_mfma_f32_16x16x32_bf16 v[140:143], v[92:95], v[68:71], v[140:143]
    v_mfma_f32_16x16x32_bf16 v[140:143], v[88:91], v[52:55], v[140:143]
    s_waitcnt lgkmcnt(4)
    v_mfma_f32_16x16x32_bf16 v[156:159], v[8:11], v[52:55], v[156:159]
    ds_read_b64_tr_b16 v[88:89], v2 offset:96
    v_mfma_f32_16x16x32_bf16 v[156:159], v[12:15], v[68:71], v[156:159]
    ds_read_b64_tr_b16 v[90:91], v2 offset:352
    v_mfma_f32_16x16x32_bf16 v[152:155], v[12:15], v[64:67], v[152:155]
    ds_read_b64_tr_b16 v[92:93], v2 offset:4320
    v_mfma_f32_16x16x32_bf16 v[152:155], v[8:11], v[48:51], v[152:155]
    ds_read_b64_tr_b16 v[94:95], v2 offset:4576
    v_mfma_f32_16x16x32_bf16 v[148:151], v[8:11], v[44:47], v[148:151]
    v_mfma_f32_16x16x32_bf16 v[148:151], v[12:15], v[60:63], v[148:151]
    v_add_u32 v2, 16896, v2
    s_barrier
    v_mfma_f32_16x16x32_bf16 v[144:147], v[12:15], v[56:59], v[144:147]
    v_mfma_f32_16x16x32_bf16 v[144:147], v[8:11], v[40:43], v[144:147]
    s_waitcnt lgkmcnt(4)
    v_mfma_f32_16x16x32_bf16 v[160:163], v[16:19], v[40:43], v[160:163]
    ds_read_b64_tr_b16 v[8:9], v2 offset:8448
    v_mfma_f32_16x16x32_bf16 v[160:163], v[20:23], v[56:59], v[160:163]
    ds_read_b64_tr_b16 v[10:11], v2 offset:8704
    v_mfma_f32_16x16x32_bf16 v[164:167], v[20:23], v[60:63], v[164:167]
    ds_read_b64_tr_b16 v[12:13], v2 offset:8480
    v_mfma_f32_16x16x32_bf16 v[164:167], v[16:19], v[44:47], v[164:167]
    ds_read_b64_tr_b16 v[14:15], v2 offset:8736
    v_mfma_f32_16x16x32_bf16 v[168:171], v[16:19], v[48:51], v[168:171]
    v_mfma_f32_16x16x32_bf16 v[168:171], v[20:23], v[64:67], v[168:171]
    v_mfma_f32_16x16x32_bf16 v[172:175], v[20:23], v[68:71], v[172:175]
    v_mfma_f32_16x16x32_bf16 v[172:175], v[16:19], v[52:55], v[172:175]
    s_waitcnt lgkmcnt(4)
    v_mfma_f32_16x16x32_bf16 v[188:191], v[88:91], v[52:55], v[188:191]
    ds_read_b64_tr_b16 v[16:17], v2 offset:8512
    v_mfma_f32_16x16x32_bf16 v[188:191], v[92:95], v[68:71], v[188:191]
    ds_read_b64_tr_b16 v[18:19], v2 offset:8768
    v_mfma_f32_16x16x32_bf16 v[184:187], v[92:95], v[64:67], v[184:187]
    v_mfma_f32_16x16x32_bf16 v[184:187], v[88:91], v[48:51], v[184:187]
    v_mfma_f32_16x16x32_bf16 v[180:183], v[88:91], v[44:47], v[180:183]
    v_mfma_f32_16x16x32_bf16 v[180:183], v[92:95], v[60:63], v[180:183]
    v_mfma_f32_16x16x32_bf16 v[176:179], v[92:95], v[56:59], v[176:179]
    v_mfma_f32_16x16x32_bf16 v[176:179], v[88:91], v[40:43], v[176:179]
    s_waitcnt vmcnt(12)
    s_waitcnt lgkmcnt(4)
    v_mfma_f32_16x16x32_bf16 v[192:195], v[8:11], v[24:27], v[192:195]
    ds_read_b64_tr_b16 v[20:21], v2 offset:8544
    v_and_b32 v94, 15, v0
    v_mfma_f32_16x16x32_bf16 v[196:199], v[8:11], v[28:31], v[196:199]
    ds_read_b64_tr_b16 v[22:23], v2 offset:8800
    v_lshrrev_b32 v95, 4, v0
    v_mfma_f32_16x16x32_bf16 v[200:203], v[8:11], v[32:35], v[200:203]
    v_lshlrev_b32 v95, 2, v95
    v_sub_u32 v94, v94, v95
    v_mfma_f32_16x16x32_bf16 v[204:207], v[8:11], v[36:39], v[204:207]
    v_and_b32 v95, 1, v0
    s_waitcnt lgkmcnt(4)
    v_mfma_f32_16x16x32_bf16 v[220:223], v[12:15], v[36:39], v[220:223]
    ds_read_b64_tr_b16 v[8:9], v2 offset:0
    v_lshlrev_b32 v95, 4, v95
    v_mfma_f32_16x16x32_bf16 v[216:219], v[12:15], v[32:35], v[216:219]
    ds_read_b64_tr_b16 v[10:11], v2 offset:256
    v_mov_b32 v88, 0x3f80
    v_mfma_f32_16x16x32_bf16 v[212:215], v[12:15], v[28:31], v[212:215]
    v_lshlrev_b32 v95, v95, v88
    v_lshrrev_b32 v94, 1, v94
    v_mfma_f32_16x16x32_bf16 v[208:211], v[12:15], v[24:27], v[208:211]
    v_cmp_eq_u32 vcc, 0, v94
    s_nop 1
    v_cndmask_b32 v90, 0, v95, vcc
    s_waitcnt lgkmcnt(4)
    v_mfma_f32_16x16x32_bf16 v[224:227], v[16:19], v[24:27], v[224:227]
    ds_read_b64_tr_b16 v[12:13], v2 offset:32
    v_cmp_eq_u32 vcc, 1, v94
    s_nop 1
    v_cndmask_b32 v91, 0, v95, vcc
    v_mfma_f32_16x16x32_bf16 v[228:231], v[16:19], v[28:31], v[228:231]
    ds_read_b64_tr_b16 v[14:15], v2 offset:288
    v_mov_b32 v88, 0
    v_mfma_f32_16x16x32_bf16 v[232:235], v[16:19], v[32:35], v[232:235]
    v_mov_b32 v89, 0
    v_mov_b32 v92, 0
    v_mfma_f32_16x16x32_bf16 v[236:239], v[16:19], v[36:39], v[236:239]
    v_mov_b32 v93, 0
    s_waitcnt lgkmcnt(4)
    v_mfma_f32_16x16x32_bf16 v[252:255], v[20:23], v[36:39], v[252:255]
    ds_read_b64_tr_b16 v[16:17], v2 offset:64
    v_mfma_f32_16x16x32_bf16 v[248:251], v[20:23], v[32:35], v[248:251]
    ds_read_b64_tr_b16 v[18:19], v2 offset:320
    v_mfma_f32_16x16x32_bf16 v[244:247], v[20:23], v[28:31], v[244:247]
    v_mfma_f32_16x16x32_bf16 v[240:243], v[20:23], v[24:27], v[240:243]
    s_waitcnt lgkmcnt(4)
    v_mfma_f32_16x16x32_bf16 v[128:131], v[8:11], v[24:27], v[128:131]
    ds_read_b64_tr_b16 v[20:21], v2 offset:96
    v_mfma_f32_16x16x32_bf16 v[132:135], v[8:11], v[28:31], v[132:135]
    ds_read_b64_tr_b16 v[22:23], v2 offset:352
    v_mfma_f32_16x16x32_bf16 v[136:139], v[8:11], v[32:35], v[136:139]
    v_mfma_f32_16x16x32_bf16 v[140:143], v[8:11], v[36:39], v[140:143]
    s_waitcnt lgkmcnt(4)
    v_mfma_f32_16x16x32_bf16 v[156:159], v[12:15], v[36:39], v[156:159]
    ds_read_b64_tr_b16 v[8:9], v2 offset:12672
    v_mfma_f32_16x16x32_bf16 v[152:155], v[12:15], v[32:35], v[152:155]
    ds_read_b64_tr_b16 v[10:11], v2 offset:12928
    v_mfma_f32_16x16x32_bf16 v[148:151], v[12:15], v[28:31], v[148:151]
    v_mfma_f32_16x16x32_bf16 v[144:147], v[12:15], v[24:27], v[144:147]
    s_waitcnt lgkmcnt(4)
    v_mfma_f32_16x16x32_bf16 v[160:163], v[16:19], v[24:27], v[160:163]
    ds_read_b64_tr_b16 v[12:13], v2 offset:12704
    v_mfma_f32_16x16x32_bf16 v[164:167], v[16:19], v[28:31], v[164:167]
    ds_read_b64_tr_b16 v[14:15], v2 offset:12960
    v_mfma_f32_16x16x32_bf16 v[168:171], v[16:19], v[32:35], v[168:171]
    v_mfma_f32_16x16x32_bf16 v[172:175], v[16:19], v[36:39], v[172:175]
    s_waitcnt lgkmcnt(4)
    v_mfma_f32_16x16x32_bf16 v[188:191], v[20:23], v[36:39], v[188:191]
    ds_read_b64_tr_b16 v[16:17], v2 offset:12736
    v_mfma_f32_16x16x32_bf16 v[184:187], v[20:23], v[32:35], v[184:187]
    ds_read_b64_tr_b16 v[18:19], v2 offset:12992
    v_mfma_f32_16x16x32_bf16 v[180:183], v[20:23], v[28:31], v[180:183]
    v_mfma_f32_16x16x32_bf16 v[176:179], v[20:23], v[24:27], v[176:179]
    s_waitcnt vmcnt(8)
    s_waitcnt lgkmcnt(4)
    v_mfma_f32_16x16x32_bf16 v[192:195], v[8:11], v[112:115], v[192:195]
    ds_read_b64_tr_b16 v[20:21], v2 offset:12768
    s_add_u32 s54, s45, 1048576
    v_mfma_f32_16x16x32_bf16 v[196:199], v[8:11], v[116:119], v[196:199]
    ds_read_b64_tr_b16 v[22:23], v2 offset:13024
    s_add_u32 s53, s45, 1052672
    v_mfma_f32_16x16x32_bf16 v[200:203], v[8:11], v[120:123], v[200:203]
    v_mfma_f32_16x16x32_bf16 v[204:207], v[8:11], v[124:127], v[204:207]
    s_waitcnt lgkmcnt(4)
    v_mfma_f32_16x16x32_bf16 v[220:223], v[12:15], v[124:127], v[220:223]
    ds_read_b64_tr_b16 v[8:9], v2 offset:4224
    v_mfma_f32_16x16x32_bf16 v[216:219], v[12:15], v[120:123], v[216:219]
    ds_read_b64_tr_b16 v[10:11], v2 offset:4480
    v_mfma_f32_16x16x32_bf16 v[212:215], v[12:15], v[116:119], v[212:215]
    v_add_u32 v5, 25344, v2
    s_barrier
    v_mfma_f32_16x16x32_bf16 v[208:211], v[12:15], v[112:115], v[208:211]
    s_waitcnt lgkmcnt(4)
    v_mfma_f32_16x16x32_bf16 v[224:227], v[16:19], v[112:115], v[224:227]
    ds_read_b64_tr_b16 v[12:13], v2 offset:4256
    buffer_load_dwordx4 v[24:27], v3, s[20:23], s54 offen offset:0 sc1
    v_mfma_f32_16x16x32_bf16 v[228:231], v[16:19], v[116:119], v[228:231]
    ds_read_b64_tr_b16 v[14:15], v2 offset:4512
    buffer_load_dwordx4 v[28:31], v3, s[20:23], s53 offen offset:0 sc1
    v_mfma_f32_16x16x32_bf16 v[232:235], v[16:19], v[120:123], v[232:235]
    ds_read_b64_tr_b16 v[56:57], v5 offset:4224
    v_mfma_f32_16x16x32_bf16 v[236:239], v[16:19], v[124:127], v[236:239]
    ds_read_b64_tr_b16 v[58:59], v5 offset:4480
    s_waitcnt lgkmcnt(6)
    v_mfma_f32_16x16x32_bf16 v[252:255], v[20:23], v[124:127], v[252:255]
    ds_read_b64_tr_b16 v[16:17], v2 offset:4288
    buffer_load_dwordx4 v[32:35], v3, s[20:23], s54 offen offset:2048 sc1
    v_mfma_f32_16x16x32_bf16 v[248:251], v[20:23], v[120:123], v[248:251]
    ds_read_b64_tr_b16 v[18:19], v2 offset:4544
    buffer_load_dwordx4 v[36:39], v3, s[20:23], s53 offen offset:2048 sc1
    v_mfma_f32_16x16x32_bf16 v[244:247], v[20:23], v[116:119], v[244:247]
    ds_read_b64_tr_b16 v[40:41], v5 offset:0
    v_mfma_f32_16x16x32_bf16 v[240:243], v[20:23], v[112:115], v[240:243]
    ds_read_b64_tr_b16 v[42:43], v5 offset:256
    s_waitcnt lgkmcnt(8)
    v_mfma_f32_16x16x32_bf16 v[128:131], v[8:11], v[112:115], v[128:131]
    ds_read_b64_tr_b16 v[20:21], v2 offset:4320
    v_mfma_f32_16x16x32_bf16 v[132:135], v[8:11], v[116:119], v[132:135]
    ds_read_b64_tr_b16 v[22:23], v2 offset:4576
    v_mfma_f32_16x16x32_bf16 v[136:139], v[8:11], v[120:123], v[136:139]
    ds_read_b64_tr_b16 v[60:61], v5 offset:4256
    v_mfma_f32_16x16x32_bf16 v[140:143], v[8:11], v[124:127], v[140:143]
    ds_read_b64_tr_b16 v[62:63], v5 offset:4512
    s_waitcnt lgkmcnt(10)
    v_mfma_f32_16x16x32_bf16 v[156:159], v[12:15], v[124:127], v[156:159]
    ds_read_b64_tr_b16 v[44:45], v5 offset:32
    v_mfma_f32_16x16x32_bf16 v[152:155], v[12:15], v[120:123], v[152:155]
    ds_read_b64_tr_b16 v[46:47], v5 offset:288
    v_mfma_f32_16x16x32_bf16 v[148:151], v[12:15], v[116:119], v[148:151]
    ds_read_b64_tr_b16 v[64:65], v5 offset:4288
    v_mfma_f32_16x16x32_bf16 v[144:147], v[12:15], v[112:115], v[144:147]
    ds_read_b64_tr_b16 v[66:67], v5 offset:4544
    s_waitcnt lgkmcnt(10)
    v_mfma_f32_16x16x32_bf16 v[160:163], v[16:19], v[112:115], v[160:163]
    ds_read_b64_tr_b16 v[48:49], v5 offset:64
    v_mfma_f32_16x16x32_bf16 v[164:167], v[16:19], v[116:119], v[164:167]
    ds_read_b64_tr_b16 v[50:51], v5 offset:320
    v_mfma_f32_16x16x32_bf16 v[168:171], v[16:19], v[120:123], v[168:171]
    ds_read_b64_tr_b16 v[68:69], v5 offset:4320
    v_mfma_f32_16x16x32_bf16 v[172:175], v[16:19], v[124:127], v[172:175]
    ds_read_b64_tr_b16 v[70:71], v5 offset:4576
    s_waitcnt lgkmcnt(10)
    v_mfma_f32_16x16x32_bf16 v[188:191], v[20:23], v[124:127], v[188:191]
    ds_read_b64_tr_b16 v[52:53], v5 offset:96
    v_mfma_f32_16x16x32_bf16 v[184:187], v[20:23], v[120:123], v[184:187]
    ds_read_b64_tr_b16 v[54:55], v5 offset:352
    v_mfma_f32_16x16x32_bf16 v[180:183], v[20:23], v[116:119], v[180:183]
    v_mfma_f32_16x16x32_bf16 v[176:179], v[20:23], v[112:115], v[176:179]
    s_waitcnt vmcnt(8)
    v_mfma_f32_16x16x32_bf16 v[200:203], v[40:43], v[96:99], v[200:203]
    v_add_u32 v5, 16896, v5
    v_mfma_f32_16x16x32_bf16 v[200:203], v[56:59], v[104:107], v[200:203]
    s_add_u32 s54, s45, 1179648
    v_mfma_f32_16x16x32_bf16 v[204:207], v[56:59], v[108:111], v[204:207]
    ds_read_b64_tr_b16 v[56:57], v5 offset:4224
    s_add_u32 s53, s45, 1183744
    v_mfma_f32_16x16x32_bf16 v[204:207], v[40:43], v[100:103], v[204:207]
    ds_read_b64_tr_b16 v[58:59], v5 offset:4480
    s_waitcnt lgkmcnt(10)
    v_mfma_f32_16x16x32_bf16 v[220:223], v[44:47], v[100:103], v[220:223]
    ds_read_b64_tr_b16 v[40:41], v5 offset:0
    buffer_load_dwordx4 v[112:115], v3, s[20:23], s54 offen offset:0 sc1
    v_mfma_f32_16x16x32_bf16 v[220:223], v[60:63], v[108:111], v[220:223]
    ds_read_b64_tr_b16 v[42:43], v5 offset:256
    v_mfma_f32_16x16x32_bf16 v[216:219], v[60:63], v[104:107], v[216:219]
    ds_read_b64_tr_b16 v[60:61], v5 offset:4256
    buffer_load_dwordx4 v[116:119], v3, s[20:23], s53 offen offset:0 sc1
    v_mfma_f32_16x16x32_bf16 v[216:219], v[44:47], v[96:99], v[216:219]
    ds_read_b64_tr_b16 v[62:63], v5 offset:4512
    s_waitcnt lgkmcnt(10)
    v_mfma_f32_16x16x32_bf16 v[232:235], v[48:51], v[96:99], v[232:235]
    ds_read_b64_tr_b16 v[44:45], v5 offset:32
    v_mfma_f32_16x16x32_bf16 v[232:235], v[64:67], v[104:107], v[232:235]
    ds_read_b64_tr_b16 v[46:47], v5 offset:288
    buffer_load_dwordx4 v[120:123], v3, s[20:23], s54 offen offset:2048 sc1
    v_mfma_f32_16x16x32_bf16 v[236:239], v[64:67], v[108:111], v[236:239]
    ds_read_b64_tr_b16 v[64:65], v5 offset:4288
    v_mfma_f32_16x16x32_bf16 v[236:239], v[48:51], v[100:103], v[236:239]
    ds_read_b64_tr_b16 v[66:67], v5 offset:4544
    s_waitcnt lgkmcnt(10)
    v_mfma_f32_16x16x32_bf16 v[252:255], v[52:55], v[100:103], v[252:255]
    ds_read_b64_tr_b16 v[48:49], v5 offset:64
    v_mfma_f32_16x16x32_bf16 v[252:255], v[68:71], v[108:111], v[252:255]
    ds_read_b64_tr_b16 v[50:51], v5 offset:320
    buffer_load_dwordx4 v[124:127], v3, s[20:23], s53 offen offset:2048 sc1
    v_mfma_f32_16x16x32_bf16 v[248:251], v[68:71], v[104:107], v[248:251]
    ds_read_b64_tr_b16 v[68:69], v5 offset:4320
    ds_read_b64_tr_b16 v[70:71], v5 offset:4576
    v_mfma_f32_16x16x32_bf16 v[248:251], v[52:55], v[96:99], v[248:251]
    ds_read_b64_tr_b16 v[52:53], v5 offset:96
    ds_read_b64_tr_b16 v[54:55], v5 offset:352
    s_waitcnt vmcnt(8)
    s_waitcnt lgkmcnt(12)
    v_mfma_f32_16x16x32_bf16 v[200:203], v[40:43], v[72:75], v[200:203]
    v_add_u32 v5, 4294849024, v5
    v_add_u32 v2, s68, v4
    v_add_u32 v3, s69, v4
    v_mfma_f32_16x16x32_bf16 v[200:203], v[56:59], v[80:83], v[200:203]
    v_and_b32 v4, 15, v0
    v_lshl_add_u32 v94, v4, 2, s50
    v_lshrrev_b32 v4, 3, v0
    v_mfma_f32_16x16x32_bf16 v[204:207], v[56:59], v[84:87], v[204:207]
    ds_read_b64_tr_b16 v[56:57], v5 offset:4224
    v_and_b32 v95, 7, v0
    v_lshlrev_b32 v95, 4, v95
    v_mfma_f32_16x16x32_bf16 v[204:207], v[40:43], v[76:79], v[204:207]
    ds_read_b64_tr_b16 v[58:59], v5 offset:4480
    v_lshl_add_u32 v4, v4, 11, v95
    s_waitcnt lgkmcnt(10)
    v_mfma_f32_16x16x32_bf16 v[220:223], v[44:47], v[76:79], v[220:223]
    ds_read_b64_tr_b16 v[40:41], v5 offset:0
    ds_read_b32 v95, v94 offset:64
    ds_read_b32 v94, v94
    v_mfma_f32_16x16x32_bf16 v[220:223], v[60:63], v[84:87], v[220:223]
    ds_read_b64_tr_b16 v[42:43], v5 offset:256
    v_mfma_f32_16x16x32_bf16 v[216:219], v[60:63], v[80:83], v[216:219]
    ds_read_b64_tr_b16 v[60:61], v5 offset:4256
    v_mfma_f32_16x16x32_bf16 v[216:219], v[44:47], v[72:75], v[216:219]
    ds_read_b64_tr_b16 v[62:63], v5 offset:4512
    s_waitcnt lgkmcnt(12)
    v_mfma_f32_16x16x32_bf16 v[232:235], v[48:51], v[72:75], v[232:235]
    ds_read_b64_tr_b16 v[44:45], v5 offset:32
    v_mfma_f32_16x16x32_bf16 v[232:235], v[64:67], v[80:83], v[232:235]
    ds_read_b64_tr_b16 v[46:47], v5 offset:288
    v_mfma_f32_16x16x32_bf16 v[236:239], v[64:67], v[84:87], v[236:239]
    ds_read_b64_tr_b16 v[64:65], v5 offset:4288
    v_mfma_f32_16x16x32_bf16 v[236:239], v[48:51], v[76:79], v[236:239]
    ds_read_b64_tr_b16 v[66:67], v5 offset:4544
    s_waitcnt lgkmcnt(12)
    v_mfma_f32_16x16x32_bf16 v[252:255], v[52:55], v[76:79], v[252:255]
    ds_read_b64_tr_b16 v[48:49], v5 offset:64
    v_mfma_f32_16x16x32_bf16 v[252:255], v[68:71], v[84:87], v[252:255]
    ds_read_b64_tr_b16 v[50:51], v5 offset:320
    v_mfma_f32_16x16x32_bf16 v[248:251], v[68:71], v[80:83], v[248:251]
    ds_read_b64_tr_b16 v[68:69], v5 offset:4320
    ds_read_b64_tr_b16 v[70:71], v5 offset:4576
    v_mfma_f32_16x16x32_bf16 v[248:251], v[52:55], v[72:75], v[248:251]
    ds_read_b64_tr_b16 v[52:53], v5 offset:96
    ds_read_b64_tr_b16 v[54:55], v5 offset:352
    s_waitcnt vmcnt(4)
    s_waitcnt lgkmcnt(12)
    v_mfma_f32_16x16x32_bf16 v[200:203], v[40:43], v[24:27], v[200:203]
    v_add_u32 v5, 16896, v5
    v_add_f32 v94, 1.0, v94
    v_add_f32 v95, 1.0, v95
    v_mfma_f32_16x16x32_bf16 v[200:203], v[56:59], v[32:35], v[200:203]
    s_add_u32 s54, s46, 786432
    v_rcp_f32 v94, v94
    v_mfma_f32_16x16x32_bf16 v[204:207], v[56:59], v[36:39], v[204:207]
    ds_read_b64_tr_b16 v[56:57], v5 offset:4224
    s_add_u32 s53, s46, 790528
    v_rcp_f32 v95, v95
    v_mfma_f32_16x16x32_bf16 v[204:207], v[40:43], v[28:31], v[204:207]
    ds_read_b64_tr_b16 v[58:59], v5 offset:4480
    s_waitcnt lgkmcnt(10)
    v_mfma_f32_16x16x32_bf16 v[220:223], v[44:47], v[28:31], v[220:223]
    ds_read_b64_tr_b16 v[40:41], v5 offset:0
    buffer_load_dwordx4 v[8:11], v1, s[20:23], s54 offen offset:0 sc1
    v_mfma_f32_16x16x32_bf16 v[220:223], v[60:63], v[36:39], v[220:223]
    ds_read_b64_tr_b16 v[42:43], v5 offset:256
    v_mfma_f32_16x16x32_bf16 v[216:219], v[60:63], v[32:35], v[216:219]
    ds_read_b64_tr_b16 v[60:61], v5 offset:4256
    buffer_load_dwordx4 v[12:15], v1, s[20:23], s53 offen offset:0 sc1
    v_mfma_f32_16x16x32_bf16 v[216:219], v[44:47], v[24:27], v[216:219]
    ds_read_b64_tr_b16 v[62:63], v5 offset:4512
    s_waitcnt lgkmcnt(10)
    v_mfma_f32_16x16x32_bf16 v[232:235], v[48:51], v[24:27], v[232:235]
    ds_read_b64_tr_b16 v[44:45], v5 offset:32
    v_mfma_f32_16x16x32_bf16 v[232:235], v[64:67], v[32:35], v[232:235]
    ds_read_b64_tr_b16 v[46:47], v5 offset:288
    buffer_load_dwordx4 v[16:19], v1, s[20:23], s54 offen offset:2048 sc1
    v_mfma_f32_16x16x32_bf16 v[236:239], v[64:67], v[36:39], v[236:239]
    ds_read_b64_tr_b16 v[64:65], v5 offset:4288
    v_mfma_f32_16x16x32_bf16 v[236:239], v[48:51], v[28:31], v[236:239]
    ds_read_b64_tr_b16 v[66:67], v5 offset:4544
    s_waitcnt lgkmcnt(10)
    v_mfma_f32_16x16x32_bf16 v[252:255], v[52:55], v[28:31], v[252:255]
    ds_read_b64_tr_b16 v[48:49], v5 offset:64
    v_mfma_f32_16x16x32_bf16 v[252:255], v[68:71], v[36:39], v[252:255]
    ds_read_b64_tr_b16 v[50:51], v5 offset:320
    buffer_load_dwordx4 v[20:23], v1, s[20:23], s53 offen offset:2048 sc1
    v_mfma_f32_16x16x32_bf16 v[248:251], v[68:71], v[32:35], v[248:251]
    ds_read_b64_tr_b16 v[68:69], v5 offset:4320
    ds_read_b64_tr_b16 v[70:71], v5 offset:4576
    v_mfma_f32_16x16x32_bf16 v[248:251], v[52:55], v[24:27], v[248:251]
    ds_read_b64_tr_b16 v[52:53], v5 offset:96
    ds_read_b64_tr_b16 v[54:55], v5 offset:352
    s_waitcnt vmcnt(4)
    s_waitcnt lgkmcnt(12)
    v_mfma_f32_16x16x32_bf16 v[200:203], v[40:43], v[112:115], v[200:203]
    v_add_u32 v5, 76032, v5
    s_barrier
    v_mfma_f32_16x16x32_bf16 v[200:203], v[56:59], v[120:123], v[200:203]
    v_mfma_f32_16x16x32_bf16 v[204:207], v[56:59], v[124:127], v[204:207]
    ds_read_b64_tr_b16 v[56:57], v5 offset:4224
    v_mfma_f32_16x16x32_bf16 v[204:207], v[40:43], v[116:119], v[204:207]
    ds_read_b64_tr_b16 v[58:59], v5 offset:4480
    s_waitcnt lgkmcnt(10)
    v_mfma_f32_16x16x32_bf16 v[220:223], v[44:47], v[116:119], v[220:223]
    ds_read_b64_tr_b16 v[40:41], v5 offset:0
    v_mfma_f32_16x16x32_bf16 v[220:223], v[60:63], v[124:127], v[220:223]
    ds_read_b64_tr_b16 v[42:43], v5 offset:256
    v_mfma_f32_16x16x32_bf16 v[216:219], v[60:63], v[120:123], v[216:219]
    ds_read_b64_tr_b16 v[60:61], v5 offset:4256
    v_mfma_f32_16x16x32_bf16 v[216:219], v[44:47], v[112:115], v[216:219]
    ds_read_b64_tr_b16 v[62:63], v5 offset:4512
    s_waitcnt lgkmcnt(10)
    v_mfma_f32_16x16x32_bf16 v[232:235], v[48:51], v[112:115], v[232:235]
    ds_read_b64_tr_b16 v[44:45], v5 offset:32
    v_mfma_f32_16x16x32_bf16 v[232:235], v[64:67], v[120:123], v[232:235]
    ds_read_b64_tr_b16 v[46:47], v5 offset:288
    v_mfma_f32_16x16x32_bf16 v[236:239], v[64:67], v[124:127], v[236:239]
    ds_read_b64_tr_b16 v[64:65], v5 offset:4288
    v_mfma_f32_16x16x32_bf16 v[236:239], v[48:51], v[116:119], v[236:239]
    ds_read_b64_tr_b16 v[66:67], v5 offset:4544
    s_waitcnt lgkmcnt(10)
    v_mfma_f32_16x16x32_bf16 v[252:255], v[52:55], v[116:119], v[252:255]
    ds_read_b64_tr_b16 v[48:49], v5 offset:64
    v_mfma_f32_16x16x32_bf16 v[252:255], v[68:71], v[124:127], v[252:255]
    ds_read_b64_tr_b16 v[50:51], v5 offset:320
    v_mfma_f32_16x16x32_bf16 v[248:251], v[68:71], v[120:123], v[248:251]
    ds_read_b64_tr_b16 v[68:69], v5 offset:4320
    ds_read_b64_tr_b16 v[70:71], v5 offset:4576
    v_mfma_f32_16x16x32_bf16 v[248:251], v[52:55], v[112:115], v[248:251]
    ds_read_b64_tr_b16 v[52:53], v5 offset:96
    ds_read_b64_tr_b16 v[54:55], v5 offset:352
    s_waitcnt lgkmcnt(12)
    v_mfma_f32_16x16x32_bf16 v[136:139], v[40:43], v[96:99], v[136:139]
    v_add_u32 v5, 16896, v5
    v_mfma_f32_16x16x32_bf16 v[136:139], v[56:59], v[104:107], v[136:139]
    v_mfma_f32_16x16x32_bf16 v[140:143], v[56:59], v[108:111], v[140:143]
    ds_read_b64_tr_b16 v[56:57], v5 offset:4224
    v_cvt_pk_bf16_f32 v200, v200, v201
    v_cvt_pk_bf16_f32 v201, v202, v203
    v_mfma_f32_16x16x32_bf16 v[140:143], v[40:43], v[100:103], v[140:143]
    ds_read_b64_tr_b16 v[58:59], v5 offset:4480
    v_cvt_pk_bf16_f32 v202, v216, v217
    s_waitcnt lgkmcnt(10)
    v_mfma_f32_16x16x32_bf16 v[156:159], v[44:47], v[100:103], v[156:159]
    ds_read_b64_tr_b16 v[40:41], v5 offset:0
    v_cvt_pk_bf16_f32 v203, v218, v219
    buffer_store_dwordx4 v[200:203], v7, s[20:23], s64 offen offset:0 sc1
    v_mfma_f32_16x16x32_bf16 v[156:159], v[60:63], v[108:111], v[156:159]
    ds_read_b64_tr_b16 v[42:43], v5 offset:256
    v_cvt_pk_bf16_f32 v204, v204, v205
    v_cvt_pk_bf16_f32 v205, v206, v207
    v_mfma_f32_16x16x32_bf16 v[152:155], v[60:63], v[104:107], v[152:155]
    ds_read_b64_tr_b16 v[60:61], v5 offset:4256
    v_cvt_pk_bf16_f32 v206, v220, v221
    v_cvt_pk_bf16_f32 v207, v222, v223
    v_mfma_f32_16x16x32_bf16 v[152:155], v[44:47], v[96:99], v[152:155]
    ds_read_b64_tr_b16 v[62:63], v5 offset:4512
    s_waitcnt lgkmcnt(10)
    v_mfma_f32_16x16x32_bf16 v[168:171], v[48:51], v[96:99], v[168:171]
    ds_read_b64_tr_b16 v[44:45], v5 offset:32
    v_mfma_f32_16x16x32_bf16 v[168:171], v[64:67], v[104:107], v[168:171]
    ds_read_b64_tr_b16 v[46:47], v5 offset:288
    v_mfma_f32_16x16x32_bf16 v[172:175], v[64:67], v[108:111], v[172:175]
    ds_read_b64_tr_b16 v[64:65], v5 offset:4288
    v_mfma_f32_16x16x32_bf16 v[172:175], v[48:51], v[100:103], v[172:175]
    ds_read_b64_tr_b16 v[66:67], v5 offset:4544
    s_waitcnt lgkmcnt(10)
    v_mfma_f32_16x16x32_bf16 v[188:191], v[52:55], v[100:103], v[188:191]
    ds_read_b64_tr_b16 v[48:49], v5 offset:64
    v_mfma_f32_16x16x32_bf16 v[188:191], v[68:71], v[108:111], v[188:191]
    ds_read_b64_tr_b16 v[50:51], v5 offset:320
    v_mfma_f32_16x16x32_bf16 v[184:187], v[68:71], v[104:107], v[184:187]
    ds_read_b64_tr_b16 v[68:69], v5 offset:4320
    ds_read_b64_tr_b16 v[70:71], v5 offset:4576
    v_mfma_f32_16x16x32_bf16 v[184:187], v[52:55], v[96:99], v[184:187]
    ds_read_b64_tr_b16 v[52:53], v5 offset:96
    ds_read_b64_tr_b16 v[54:55], v5 offset:352
    s_waitcnt lgkmcnt(12)
    v_mfma_f32_16x16x32_bf16 v[136:139], v[40:43], v[72:75], v[136:139]
    v_add_u32 v5, 4294849024, v5
    v_cvt_pk_bf16_f32 v232, v232, v233
    v_cvt_pk_bf16_f32 v233, v234, v235
    v_mfma_f32_16x16x32_bf16 v[136:139], v[56:59], v[80:83], v[136:139]
    s_add_u32 s54, s46, 1703936
    v_cvt_pk_bf16_f32 v234, v248, v249
    v_cvt_pk_bf16_f32 v235, v250, v251
    v_mfma_f32_16x16x32_bf16 v[140:143], v[56:59], v[84:87], v[140:143]
    ds_read_b64_tr_b16 v[56:57], v5 offset:4224
    s_add_u32 s53, s46, 1708032
    buffer_store_dwordx4 v[204:207], v7, s[20:23], s67 offen offset:0 sc1
    v_mfma_f32_16x16x32_bf16 v[140:143], v[40:43], v[76:79], v[140:143]
    ds_read_b64_tr_b16 v[58:59], v5 offset:4480
    v_cvt_pk_bf16_f32 v236, v236, v237
    s_waitcnt lgkmcnt(10)
    v_mfma_f32_16x16x32_bf16 v[156:159], v[44:47], v[76:79], v[156:159]
    ds_read_b64_tr_b16 v[40:41], v5 offset:0
    buffer_load_dwordx4 v[96:99], v1, s[20:23], s54 offen offset:0 sc1
    v_cvt_pk_bf16_f32 v237, v238, v239
    v_mfma_f32_16x16x32_bf16 v[156:159], v[60:63], v[84:87], v[156:159]
    ds_read_b64_tr_b16 v[42:43], v5 offset:256
    v_cvt_pk_bf16_f32 v238, v252, v253
    v_cvt_pk_bf16_f32 v239, v254, v255
    v_mfma_f32_16x16x32_bf16 v[152:155], v[60:63], v[80:83], v[152:155]
    ds_read_b64_tr_b16 v[60:61], v5 offset:4256
    buffer_load_dwordx4 v[100:103], v1, s[20:23], s53 offen offset:0 sc1
    v_mfma_f32_16x16x32_bf16 v[152:155], v[44:47], v[72:75], v[152:155]
    ds_read_b64_tr_b16 v[62:63], v5 offset:4512
    s_waitcnt lgkmcnt(10)
    v_mfma_f32_16x16x32_bf16 v[168:171], v[48:51], v[72:75], v[168:171]
    ds_read_b64_tr_b16 v[44:45], v5 offset:32
    v_mfma_f32_16x16x32_bf16 v[168:171], v[64:67], v[80:83], v[168:171]
    ds_read_b64_tr_b16 v[46:47], v5 offset:288
    buffer_load_dwordx4 v[104:107], v1, s[20:23], s54 offen offset:2048 sc1
    v_mfma_f32_16x16x32_bf16 v[172:175], v[64:67], v[84:87], v[172:175]
    ds_read_b64_tr_b16 v[64:65], v5 offset:4288
    v_mfma_f32_16x16x32_bf16 v[172:175], v[48:51], v[76:79], v[172:175]
    ds_read_b64_tr_b16 v[66:67], v5 offset:4544
    s_waitcnt lgkmcnt(10)
    v_mfma_f32_16x16x32_bf16 v[188:191], v[52:55], v[76:79], v[188:191]
    ds_read_b64_tr_b16 v[48:49], v5 offset:64
    v_mfma_f32_16x16x32_bf16 v[188:191], v[68:71], v[84:87], v[188:191]
    ds_read_b64_tr_b16 v[50:51], v5 offset:320
    buffer_load_dwordx4 v[108:111], v1, s[20:23], s53 offen offset:2048 sc1
    v_mfma_f32_16x16x32_bf16 v[184:187], v[68:71], v[80:83], v[184:187]
    ds_read_b64_tr_b16 v[68:69], v5 offset:4320
    ds_read_b64_tr_b16 v[70:71], v5 offset:4576
    v_mfma_f32_16x16x32_bf16 v[184:187], v[52:55], v[72:75], v[184:187]
    ds_read_b64_tr_b16 v[52:53], v5 offset:96
    ds_read_b64_tr_b16 v[54:55], v5 offset:352
    s_waitcnt lgkmcnt(12)
    v_mfma_f32_16x16x32_bf16 v[136:139], v[40:43], v[24:27], v[136:139]
    v_add_u32 v5, 16896, v5
    buffer_store_dwordx4 v[232:235], v7, s[20:23], s64 offen offset:2048 sc1
    v_mfma_f32_16x16x32_bf16 v[136:139], v[56:59], v[32:35], v[136:139]
    s_add_u32 s54, s45, 1048576
    v_mfma_f32_16x16x32_bf16 v[140:143], v[56:59], v[36:39], v[140:143]
    ds_read_b64_tr_b16 v[56:57], v5 offset:4224
    s_add_u32 s53, s45, 1052672
    v_mfma_f32_16x16x32_bf16 v[140:143], v[40:43], v[28:31], v[140:143]
    ds_read_b64_tr_b16 v[58:59], v5 offset:4480
    s_waitcnt lgkmcnt(10)
    v_mfma_f32_16x16x32_bf16 v[156:159], v[44:47], v[28:31], v[156:159]
    ds_read_b64_tr_b16 v[40:41], v5 offset:0
    buffer_load_dwordx4 v[72:75], v1, s[20:23], s54 offen offset:0 sc1
    v_mfma_f32_16x16x32_bf16 v[156:159], v[60:63], v[36:39], v[156:159]
    ds_read_b64_tr_b16 v[42:43], v5 offset:256
    v_mfma_f32_16x16x32_bf16 v[152:155], v[60:63], v[32:35], v[152:155]
    ds_read_b64_tr_b16 v[60:61], v5 offset:4256
    buffer_load_dwordx4 v[76:79], v1, s[20:23], s53 offen offset:0 sc1
    v_mfma_f32_16x16x32_bf16 v[152:155], v[44:47], v[24:27], v[152:155]
    ds_read_b64_tr_b16 v[62:63], v5 offset:4512
    s_waitcnt lgkmcnt(10)
    v_mfma_f32_16x16x32_bf16 v[168:171], v[48:51], v[24:27], v[168:171]
    ds_read_b64_tr_b16 v[44:45], v5 offset:32
    v_mfma_f32_16x16x32_bf16 v[168:171], v[64:67], v[32:35], v[168:171]
    ds_read_b64_tr_b16 v[46:47], v5 offset:288
    buffer_load_dwordx4 v[80:83], v1, s[20:23], s54 offen offset:2048 sc1
    v_mfma_f32_16x16x32_bf16 v[172:175], v[64:67], v[36:39], v[172:175]
    ds_read_b64_tr_b16 v[64:65], v5 offset:4288
    v_mfma_f32_16x16x32_bf16 v[172:175], v[48:51], v[28:31], v[172:175]
    ds_read_b64_tr_b16 v[66:67], v5 offset:4544
    s_waitcnt lgkmcnt(10)
    v_mfma_f32_16x16x32_bf16 v[188:191], v[52:55], v[28:31], v[188:191]
    ds_read_b64_tr_b16 v[48:49], v5 offset:64
    v_mfma_f32_16x16x32_bf16 v[188:191], v[68:71], v[36:39], v[188:191]
    ds_read_b64_tr_b16 v[50:51], v5 offset:320
    buffer_load_dwordx4 v[84:87], v1, s[20:23], s53 offen offset:2048 sc1
    v_mfma_f32_16x16x32_bf16 v[184:187], v[68:71], v[32:35], v[184:187]
    ds_read_b64_tr_b16 v[68:69], v5 offset:4320
    ds_read_b64_tr_b16 v[70:71], v5 offset:4576
    v_mfma_f32_16x16x32_bf16 v[184:187], v[52:55], v[24:27], v[184:187]
    ds_read_b64_tr_b16 v[52:53], v5 offset:96
    ds_read_b64_tr_b16 v[54:55], v5 offset:352
    s_waitcnt lgkmcnt(12)
    v_mfma_f32_16x16x32_bf16 v[136:139], v[40:43], v[112:115], v[136:139]
    v_add_u32 v5, 92928, v5
    buffer_store_dwordx4 v[236:239], v7, s[20:23], s67 offen offset:2048 sc1
    v_mfma_f32_16x16x32_bf16 v[136:139], v[56:59], v[120:123], v[136:139]
    s_add_u32 s54, s45, 1179648
    v_mfma_f32_16x16x32_bf16 v[140:143], v[56:59], v[124:127], v[140:143]
    ds_read_b64_tr_b16 v[56:57], v5 offset:4224
    s_add_u32 s53, s45, 1183744
    v_mfma_f32_16x16x32_bf16 v[140:143], v[40:43], v[116:119], v[140:143]
    ds_read_b64_tr_b16 v[58:59], v5 offset:4480
    s_waitcnt lgkmcnt(10)
    v_mfma_f32_16x16x32_bf16 v[156:159], v[44:47], v[116:119], v[156:159]
    ds_read_b64_tr_b16 v[40:41], v5 offset:0
    buffer_load_dwordx4 v[24:27], v1, s[20:23], s54 offen offset:0 sc1
    v_mfma_f32_16x16x32_bf16 v[156:159], v[60:63], v[124:127], v[156:159]
    ds_read_b64_tr_b16 v[42:43], v5 offset:256
    v_mfma_f32_16x16x32_bf16 v[152:155], v[60:63], v[120:123], v[152:155]
    ds_read_b64_tr_b16 v[60:61], v5 offset:4256
    buffer_load_dwordx4 v[28:31], v1, s[20:23], s53 offen offset:0 sc1
    v_mfma_f32_16x16x32_bf16 v[152:155], v[44:47], v[112:115], v[152:155]
    ds_read_b64_tr_b16 v[62:63], v5 offset:4512
    s_waitcnt lgkmcnt(10)
    v_mfma_f32_16x16x32_bf16 v[168:171], v[48:51], v[112:115], v[168:171]
    ds_read_b64_tr_b16 v[44:45], v5 offset:32
    v_mfma_f32_16x16x32_bf16 v[168:171], v[64:67], v[120:123], v[168:171]
    ds_read_b64_tr_b16 v[46:47], v5 offset:288
    buffer_load_dwordx4 v[32:35], v1, s[20:23], s54 offen offset:2048 sc1
    v_mfma_f32_16x16x32_bf16 v[172:175], v[64:67], v[124:127], v[172:175]
    ds_read_b64_tr_b16 v[64:65], v5 offset:4288
    v_mfma_f32_16x16x32_bf16 v[172:175], v[48:51], v[116:119], v[172:175]
    ds_read_b64_tr_b16 v[66:67], v5 offset:4544
    s_waitcnt lgkmcnt(10)
    v_mfma_f32_16x16x32_bf16 v[188:191], v[52:55], v[116:119], v[188:191]
    ds_read_b64_tr_b16 v[48:49], v5 offset:64
    v_mfma_f32_16x16x32_bf16 v[188:191], v[68:71], v[124:127], v[188:191]
    ds_read_b64_tr_b16 v[50:51], v5 offset:320
    buffer_load_dwordx4 v[36:39], v1, s[20:23], s53 offen offset:2048 sc1
    v_mfma_f32_16x16x32_bf16 v[184:187], v[68:71], v[120:123], v[184:187]
    ds_read_b64_tr_b16 v[68:69], v5 offset:4320
    ds_read_b64_tr_b16 v[70:71], v5 offset:4576
    v_mfma_f32_16x16x32_bf16 v[184:187], v[52:55], v[112:115], v[184:187]
    ds_read_b64_tr_b16 v[52:53], v5 offset:96
    ds_read_b64_tr_b16 v[54:55], v5 offset:352
    s_waitcnt vmcnt(16)
    s_waitcnt lgkmcnt(12)
    v_mfma_f32_16x16x32_bf16 v[192:195], v[40:43], v[8:11], v[192:195]
    v_add_u32 v5, 16896, v5
    v_mfma_f32_16x16x32_bf16 v[192:195], v[56:59], v[16:19], v[192:195]
    v_mfma_f32_16x16x32_bf16 v[196:199], v[56:59], v[20:23], v[196:199]
    ds_read_b64_tr_b16 v[56:57], v5 offset:4224
    v_cvt_pk_bf16_f32 v136, v136, v137
    v_cvt_pk_bf16_f32 v137, v138, v139
    v_mfma_f32_16x16x32_bf16 v[196:199], v[40:43], v[12:15], v[196:199]
    ds_read_b64_tr_b16 v[58:59], v5 offset:4480
    v_cvt_pk_bf16_f32 v138, v152, v153
    s_waitcnt lgkmcnt(10)
    v_mfma_f32_16x16x32_bf16 v[212:215], v[44:47], v[12:15], v[212:215]
    ds_read_b64_tr_b16 v[40:41], v5 offset:0
    v_cvt_pk_bf16_f32 v139, v154, v155
    buffer_store_dwordx4 v[136:139], v7, s[20:23], s62 offen offset:0 sc1
    v_mfma_f32_16x16x32_bf16 v[212:215], v[60:63], v[20:23], v[212:215]
    ds_read_b64_tr_b16 v[42:43], v5 offset:256
    v_cvt_pk_bf16_f32 v140, v140, v141
    v_cvt_pk_bf16_f32 v141, v142, v143
    v_mfma_f32_16x16x32_bf16 v[208:211], v[60:63], v[16:19], v[208:211]
    ds_read_b64_tr_b16 v[60:61], v5 offset:4256
    v_cvt_pk_bf16_f32 v142, v156, v157
    v_cvt_pk_bf16_f32 v143, v158, v159
    v_mfma_f32_16x16x32_bf16 v[208:211], v[44:47], v[8:11], v[208:211]
    ds_read_b64_tr_b16 v[62:63], v5 offset:4512
    s_waitcnt lgkmcnt(10)
    v_mfma_f32_16x16x32_bf16 v[224:227], v[48:51], v[8:11], v[224:227]
    ds_read_b64_tr_b16 v[44:45], v5 offset:32
    v_mfma_f32_16x16x32_bf16 v[224:227], v[64:67], v[16:19], v[224:227]
    ds_read_b64_tr_b16 v[46:47], v5 offset:288
    v_mfma_f32_16x16x32_bf16 v[228:231], v[64:67], v[20:23], v[228:231]
    ds_read_b64_tr_b16 v[64:65], v5 offset:4288
    v_mfma_f32_16x16x32_bf16 v[228:231], v[48:51], v[12:15], v[228:231]
    ds_read_b64_tr_b16 v[66:67], v5 offset:4544
    s_waitcnt lgkmcnt(10)
    v_mfma_f32_16x16x32_bf16 v[244:247], v[52:55], v[12:15], v[244:247]
    ds_read_b64_tr_b16 v[48:49], v5 offset:64
    v_mfma_f32_16x16x32_bf16 v[244:247], v[68:71], v[20:23], v[244:247]
    ds_read_b64_tr_b16 v[50:51], v5 offset:320
    v_mfma_f32_16x16x32_bf16 v[240:243], v[68:71], v[16:19], v[240:243]
    ds_read_b64_tr_b16 v[68:69], v5 offset:4320
    ds_read_b64_tr_b16 v[70:71], v5 offset:4576
    v_mfma_f32_16x16x32_bf16 v[240:243], v[52:55], v[8:11], v[240:243]
    ds_read_b64_tr_b16 v[52:53], v5 offset:96
    ds_read_b64_tr_b16 v[54:55], v5 offset:352
    s_waitcnt vmcnt(11)
    s_waitcnt lgkmcnt(12)
    v_mfma_f32_16x16x32_bf16 v[192:195], v[40:43], v[96:99], v[192:195]
    v_add_u32 v5, 4294849024, v5
    v_cvt_pk_bf16_f32 v168, v168, v169
    v_cvt_pk_bf16_f32 v169, v170, v171
    v_mfma_f32_16x16x32_bf16 v[192:195], v[56:59], v[104:107], v[192:195]
    v_cvt_pk_bf16_f32 v170, v184, v185
    v_cvt_pk_bf16_f32 v171, v186, v187
    buffer_store_dwordx4 v[140:143], v7, s[20:23], s65 offen offset:0 sc1
    v_mfma_f32_16x16x32_bf16 v[196:199], v[56:59], v[108:111], v[196:199]
    ds_read_b64_tr_b16 v[56:57], v5 offset:4224
    v_cvt_pk_bf16_f32 v172, v172, v173
    v_cvt_pk_bf16_f32 v173, v174, v175
    v_mfma_f32_16x16x32_bf16 v[196:199], v[40:43], v[100:103], v[196:199]
    ds_read_b64_tr_b16 v[58:59], v5 offset:4480
    v_cvt_pk_bf16_f32 v174, v188, v189
    s_waitcnt lgkmcnt(10)
    v_mfma_f32_16x16x32_bf16 v[212:215], v[44:47], v[100:103], v[212:215]
    ds_read_b64_tr_b16 v[40:41], v5 offset:0
    v_cvt_pk_bf16_f32 v175, v190, v191
    v_mfma_f32_16x16x32_bf16 v[212:215], v[60:63], v[108:111], v[212:215]
    ds_read_b64_tr_b16 v[42:43], v5 offset:256
    v_mfma_f32_16x16x32_bf16 v[208:211], v[60:63], v[104:107], v[208:211]
    ds_read_b64_tr_b16 v[60:61], v5 offset:4256
    v_mfma_f32_16x16x32_bf16 v[208:211], v[44:47], v[96:99], v[208:211]
    ds_read_b64_tr_b16 v[62:63], v5 offset:4512
    s_waitcnt lgkmcnt(10)
    v_mfma_f32_16x16x32_bf16 v[224:227], v[48:51], v[96:99], v[224:227]
    ds_read_b64_tr_b16 v[44:45], v5 offset:32
    v_mfma_f32_16x16x32_bf16 v[224:227], v[64:67], v[104:107], v[224:227]
    ds_read_b64_tr_b16 v[46:47], v5 offset:288
    v_mfma_f32_16x16x32_bf16 v[228:231], v[64:67], v[108:111], v[228:231]
    ds_read_b64_tr_b16 v[64:65], v5 offset:4288
    v_mfma_f32_16x16x32_bf16 v[228:231], v[48:51], v[100:103], v[228:231]
    ds_read_b64_tr_b16 v[66:67], v5 offset:4544
    s_waitcnt lgkmcnt(10)
    v_mfma_f32_16x16x32_bf16 v[244:247], v[52:55], v[100:103], v[244:247]
    ds_read_b64_tr_b16 v[48:49], v5 offset:64
    v_mfma_f32_16x16x32_bf16 v[244:247], v[68:71], v[108:111], v[244:247]
    ds_read_b64_tr_b16 v[50:51], v5 offset:320
    v_mfma_f32_16x16x32_bf16 v[240:243], v[68:71], v[104:107], v[240:243]
    ds_read_b64_tr_b16 v[68:69], v5 offset:4320
    ds_read_b64_tr_b16 v[70:71], v5 offset:4576
    v_mfma_f32_16x16x32_bf16 v[240:243], v[52:55], v[96:99], v[240:243]
    ds_read_b64_tr_b16 v[52:53], v5 offset:96
    ds_read_b64_tr_b16 v[54:55], v5 offset:352
    s_waitcnt vmcnt(6)
    s_mov_b64 exec, 1
    buffer_store_dword v6, off, s[20:23], s59 sc1
    s_mov_b64 exec, -1
    v_mov_b32 v6, 2
    s_waitcnt lgkmcnt(12)
    v_mfma_f32_16x16x32_bf16 v[192:195], v[40:43], v[72:75], v[192:195]
    v_add_u32 v5, 16896, v5
    buffer_store_dwordx4 v[168:171], v7, s[20:23], s62 offen offset:2048 sc1
    v_mfma_f32_16x16x32_bf16 v[192:195], v[56:59], v[80:83], v[192:195]
    v_mfma_f32_16x16x32_bf16 v[196:199], v[56:59], v[84:87], v[196:199]
    ds_read_b64_tr_b16 v[56:57], v5 offset:4224
    v_mfma_f32_16x16x32_bf16 v[196:199], v[40:43], v[76:79], v[196:199]
    ds_read_b64_tr_b16 v[58:59], v5 offset:4480
    s_waitcnt lgkmcnt(10)
    v_mfma_f32_16x16x32_bf16 v[212:215], v[44:47], v[76:79], v[212:215]
    ds_read_b64_tr_b16 v[40:41], v5 offset:0
    v_mfma_f32_16x16x32_bf16 v[212:215], v[60:63], v[84:87], v[212:215]
    ds_read_b64_tr_b16 v[42:43], v5 offset:256
    v_mfma_f32_16x16x32_bf16 v[208:211], v[60:63], v[80:83], v[208:211]
    ds_read_b64_tr_b16 v[60:61], v5 offset:4256
    v_mfma_f32_16x16x32_bf16 v[208:211], v[44:47], v[72:75], v[208:211]
    ds_read_b64_tr_b16 v[62:63], v5 offset:4512
    s_waitcnt lgkmcnt(10)
    v_mfma_f32_16x16x32_bf16 v[224:227], v[48:51], v[72:75], v[224:227]
    ds_read_b64_tr_b16 v[44:45], v5 offset:32
    v_mfma_f32_16x16x32_bf16 v[224:227], v[64:67], v[80:83], v[224:227]
    ds_read_b64_tr_b16 v[46:47], v5 offset:288
    v_mfma_f32_16x16x32_bf16 v[228:231], v[64:67], v[84:87], v[228:231]
    ds_read_b64_tr_b16 v[64:65], v5 offset:4288
    v_mfma_f32_16x16x32_bf16 v[228:231], v[48:51], v[76:79], v[228:231]
    ds_read_b64_tr_b16 v[66:67], v5 offset:4544
    s_waitcnt lgkmcnt(10)
    v_mfma_f32_16x16x32_bf16 v[244:247], v[52:55], v[76:79], v[244:247]
    ds_read_b64_tr_b16 v[48:49], v5 offset:64
    v_mfma_f32_16x16x32_bf16 v[244:247], v[68:71], v[84:87], v[244:247]
    ds_read_b64_tr_b16 v[50:51], v5 offset:320
    v_mfma_f32_16x16x32_bf16 v[240:243], v[68:71], v[80:83], v[240:243]
    ds_read_b64_tr_b16 v[68:69], v5 offset:4320
    ds_read_b64_tr_b16 v[70:71], v5 offset:4576
    v_mfma_f32_16x16x32_bf16 v[240:243], v[52:55], v[72:75], v[240:243]
    ds_read_b64_tr_b16 v[52:53], v5 offset:96
    ds_read_b64_tr_b16 v[54:55], v5 offset:352
    s_waitcnt vmcnt(4)
    s_waitcnt lgkmcnt(12)
    v_mfma_f32_16x16x32_bf16 v[192:195], v[40:43], v[24:27], v[192:195]
    v_add_u32 v5, 76032, v5
    buffer_store_dwordx4 v[172:175], v7, s[20:23], s65 offen offset:2048 sc1
    v_mfma_f32_16x16x32_bf16 v[192:195], v[56:59], v[32:35], v[192:195]
    s_mov_b32 s54, 33554432
    v_mfma_f32_16x16x32_bf16 v[196:199], v[56:59], v[36:39], v[196:199]
    ds_read_b64_tr_b16 v[56:57], v5 offset:4224
    s_mov_b32 s53, 33558528
    v_mfma_f32_16x16x32_bf16 v[196:199], v[40:43], v[28:31], v[196:199]
    ds_read_b64_tr_b16 v[58:59], v5 offset:4480
    s_waitcnt lgkmcnt(10)
    v_mfma_f32_16x16x32_bf16 v[212:215], v[44:47], v[28:31], v[212:215]
    ds_read_b64_tr_b16 v[40:41], v5 offset:0
    buffer_load_dwordx4 v[112:115], v1, s[20:23], s54 offen offset:0 sc1
    v_mfma_f32_16x16x32_bf16 v[212:215], v[60:63], v[36:39], v[212:215]
    ds_read_b64_tr_b16 v[42:43], v5 offset:256
    v_mfma_f32_16x16x32_bf16 v[208:211], v[60:63], v[32:35], v[208:211]
    ds_read_b64_tr_b16 v[60:61], v5 offset:4256
    buffer_load_dwordx4 v[116:119], v1, s[20:23], s53 offen offset:0 sc1
    v_mfma_f32_16x16x32_bf16 v[208:211], v[44:47], v[24:27], v[208:211]
    ds_read_b64_tr_b16 v[62:63], v5 offset:4512
    s_waitcnt lgkmcnt(10)
    v_mfma_f32_16x16x32_bf16 v[224:227], v[48:51], v[24:27], v[224:227]
    ds_read_b64_tr_b16 v[44:45], v5 offset:32
    v_mfma_f32_16x16x32_bf16 v[224:227], v[64:67], v[32:35], v[224:227]
    ds_read_b64_tr_b16 v[46:47], v5 offset:288
    buffer_load_dwordx4 v[120:123], v1, s[20:23], s54 offen offset:2048 sc1
    v_mfma_f32_16x16x32_bf16 v[228:231], v[64:67], v[36:39], v[228:231]
    ds_read_b64_tr_b16 v[64:65], v5 offset:4288
    v_mfma_f32_16x16x32_bf16 v[228:231], v[48:51], v[28:31], v[228:231]
    ds_read_b64_tr_b16 v[66:67], v5 offset:4544
    s_waitcnt lgkmcnt(10)
    v_mfma_f32_16x16x32_bf16 v[244:247], v[52:55], v[28:31], v[244:247]
    ds_read_b64_tr_b16 v[48:49], v5 offset:64
    v_mfma_f32_16x16x32_bf16 v[244:247], v[68:71], v[36:39], v[244:247]
    ds_read_b64_tr_b16 v[50:51], v5 offset:320
    buffer_load_dwordx4 v[124:127], v1, s[20:23], s53 offen offset:2048 sc1
    v_mfma_f32_16x16x32_bf16 v[240:243], v[68:71], v[32:35], v[240:243]
    ds_read_b64_tr_b16 v[68:69], v5 offset:4320
    ds_read_b64_tr_b16 v[70:71], v5 offset:4576
    v_mfma_f32_16x16x32_bf16 v[240:243], v[52:55], v[24:27], v[240:243]
    ds_read_b64_tr_b16 v[52:53], v5 offset:96
    ds_read_b64_tr_b16 v[54:55], v5 offset:352
    s_waitcnt lgkmcnt(12)
    v_mfma_f32_16x16x32_bf16 v[128:131], v[40:43], v[8:11], v[128:131]
    v_add_u32 v5, 16896, v5
    s_barrier
    v_mfma_f32_16x16x32_bf16 v[128:131], v[56:59], v[16:19], v[128:131]
    s_mov_b32 s54, 33685504
    v_cvt_pk_bf16_f32 v192, v192, v193
    v_cvt_pk_bf16_f32 v193, v194, v195
    v_mfma_f32_16x16x32_bf16 v[132:135], v[56:59], v[20:23], v[132:135]
    ds_read_b64_tr_b16 v[56:57], v5 offset:4224
    s_mov_b32 s53, 33689600
    v_cvt_pk_bf16_f32 v194, v208, v209
    v_mfma_f32_16x16x32_bf16 v[132:135], v[40:43], v[12:15], v[132:135]
    ds_read_b64_tr_b16 v[58:59], v5 offset:4480
    v_cvt_pk_bf16_f32 v195, v210, v211
    s_waitcnt lgkmcnt(10)
    v_mfma_f32_16x16x32_bf16 v[148:151], v[44:47], v[12:15], v[148:151]
    ds_read_b64_tr_b16 v[40:41], v5 offset:0
    buffer_load_dwordx4 v[216:219], v1, s[20:23], s54 offen offset:0 sc1
    buffer_store_dwordx4 v[192:195], v7, s[20:23], s63 offen offset:0 sc1
    v_mfma_f32_16x16x32_bf16 v[148:151], v[60:63], v[20:23], v[148:151]
    ds_read_b64_tr_b16 v[42:43], v5 offset:256
    v_cvt_pk_bf16_f32 v196, v196, v197
    v_cvt_pk_bf16_f32 v197, v198, v199
    v_mfma_f32_16x16x32_bf16 v[144:147], v[60:63], v[16:19], v[144:147]
    ds_read_b64_tr_b16 v[60:61], v5 offset:4256
    buffer_load_dwordx4 v[220:223], v1, s[20:23], s53 offen offset:0 sc1
    v_cvt_pk_bf16_f32 v198, v212, v213
    v_mfma_f32_16x16x32_bf16 v[144:147], v[44:47], v[8:11], v[144:147]
    ds_read_b64_tr_b16 v[62:63], v5 offset:4512
    v_cvt_pk_bf16_f32 v199, v214, v215
    s_waitcnt lgkmcnt(10)
    v_mfma_f32_16x16x32_bf16 v[160:163], v[48:51], v[8:11], v[160:163]
    ds_read_b64_tr_b16 v[44:45], v5 offset:32
    buffer_store_dwordx4 v[196:199], v7, s[20:23], s66 offen offset:0 sc1
    v_mfma_f32_16x16x32_bf16 v[160:163], v[64:67], v[16:19], v[160:163]
    ds_read_b64_tr_b16 v[46:47], v5 offset:288
    buffer_load_dwordx4 v[248:251], v1, s[20:23], s54 offen offset:2048 sc1
    v_mfma_f32_16x16x32_bf16 v[164:167], v[64:67], v[20:23], v[164:167]
    ds_read_b64_tr_b16 v[64:65], v5 offset:4288
    v_mfma_f32_16x16x32_bf16 v[164:167], v[48:51], v[12:15], v[164:167]
    ds_read_b64_tr_b16 v[66:67], v5 offset:4544
    s_waitcnt lgkmcnt(10)
    v_mfma_f32_16x16x32_bf16 v[180:183], v[52:55], v[12:15], v[180:183]
    ds_read_b64_tr_b16 v[48:49], v5 offset:64
    v_mfma_f32_16x16x32_bf16 v[180:183], v[68:71], v[20:23], v[180:183]
    ds_read_b64_tr_b16 v[50:51], v5 offset:320
    buffer_load_dwordx4 v[252:255], v1, s[20:23], s53 offen offset:2048 sc1
    v_mfma_f32_16x16x32_bf16 v[176:179], v[68:71], v[16:19], v[176:179]
    ds_read_b64_tr_b16 v[68:69], v5 offset:4320
    ds_read_b64_tr_b16 v[70:71], v5 offset:4576
    v_mfma_f32_16x16x32_bf16 v[176:179], v[52:55], v[8:11], v[176:179]
    ds_read_b64_tr_b16 v[52:53], v5 offset:96
    ds_read_b64_tr_b16 v[54:55], v5 offset:352
    s_waitcnt lgkmcnt(12)
    v_mfma_f32_16x16x32_bf16 v[128:131], v[40:43], v[96:99], v[128:131]
    v_add_u32 v5, 4294849024, v5
    v_cvt_pk_bf16_f32 v224, v224, v225
    v_cvt_pk_bf16_f32 v225, v226, v227
    v_mfma_f32_16x16x32_bf16 v[128:131], v[56:59], v[104:107], v[128:131]
    s_mov_b32 s54, 33816576
    v_cvt_pk_bf16_f32 v226, v240, v241
    v_cvt_pk_bf16_f32 v227, v242, v243
    v_mfma_f32_16x16x32_bf16 v[132:135], v[56:59], v[108:111], v[132:135]
    ds_read_b64_tr_b16 v[56:57], v5 offset:4224
    s_mov_b32 s53, 33820672
    buffer_store_dwordx4 v[224:227], v7, s[20:23], s63 offen offset:2048 sc1
    v_mfma_f32_16x16x32_bf16 v[132:135], v[40:43], v[100:103], v[132:135]
    ds_read_b64_tr_b16 v[58:59], v5 offset:4480
    v_cvt_pk_bf16_f32 v228, v228, v229
    s_waitcnt lgkmcnt(10)
    v_mfma_f32_16x16x32_bf16 v[148:151], v[44:47], v[100:103], v[148:151]
    ds_read_b64_tr_b16 v[40:41], v5 offset:0
    buffer_load_dwordx4 v[200:203], v1, s[20:23], s54 offen offset:0 sc1
    v_cvt_pk_bf16_f32 v229, v230, v231
    v_mfma_f32_16x16x32_bf16 v[148:151], v[60:63], v[108:111], v[148:151]
    ds_read_b64_tr_b16 v[42:43], v5 offset:256
    v_cvt_pk_bf16_f32 v230, v244, v245
    v_cvt_pk_bf16_f32 v231, v246, v247
    v_mfma_f32_16x16x32_bf16 v[144:147], v[60:63], v[104:107], v[144:147]
    ds_read_b64_tr_b16 v[60:61], v5 offset:4256
    buffer_load_dwordx4 v[204:207], v1, s[20:23], s53 offen offset:0 sc1
    buffer_store_dwordx4 v[228:231], v7, s[20:23], s66 offen offset:2048 sc1
    v_mfma_f32_16x16x32_bf16 v[144:147], v[44:47], v[96:99], v[144:147]
    ds_read_b64_tr_b16 v[62:63], v5 offset:4512
    s_waitcnt lgkmcnt(10)
    v_mfma_f32_16x16x32_bf16 v[160:163], v[48:51], v[96:99], v[160:163]
    ds_read_b64_tr_b16 v[44:45], v5 offset:32
    v_mfma_f32_16x16x32_bf16 v[160:163], v[64:67], v[104:107], v[160:163]
    ds_read_b64_tr_b16 v[46:47], v5 offset:288
    buffer_load_dwordx4 v[232:235], v1, s[20:23], s54 offen offset:2048 sc1
    v_mfma_f32_16x16x32_bf16 v[164:167], v[64:67], v[108:111], v[164:167]
    ds_read_b64_tr_b16 v[64:65], v5 offset:4288
    v_mfma_f32_16x16x32_bf16 v[164:167], v[48:51], v[100:103], v[164:167]
    ds_read_b64_tr_b16 v[66:67], v5 offset:4544
    s_waitcnt lgkmcnt(10)
    v_mfma_f32_16x16x32_bf16 v[180:183], v[52:55], v[100:103], v[180:183]
    ds_read_b64_tr_b16 v[48:49], v5 offset:64
    v_mfma_f32_16x16x32_bf16 v[180:183], v[68:71], v[108:111], v[180:183]
    ds_read_b64_tr_b16 v[50:51], v5 offset:320
    buffer_load_dwordx4 v[236:239], v1, s[20:23], s53 offen offset:2048 sc1
    v_mfma_f32_16x16x32_bf16 v[176:179], v[68:71], v[104:107], v[176:179]
    ds_read_b64_tr_b16 v[68:69], v5 offset:4320
    ds_read_b64_tr_b16 v[70:71], v5 offset:4576
    v_mfma_f32_16x16x32_bf16 v[176:179], v[52:55], v[96:99], v[176:179]
    ds_read_b64_tr_b16 v[52:53], v5 offset:96
    ds_read_b64_tr_b16 v[54:55], v5 offset:352
    s_waitcnt vmcnt(16)
    s_mov_b64 exec, 1
    buffer_store_dword v6, off, s[20:23], s59 sc1
    s_mov_b64 exec, -1
    v_mov_b32 v6, 3
    s_waitcnt lgkmcnt(12)
    v_mfma_f32_16x16x32_bf16 v[128:131], v[40:43], v[72:75], v[128:131]
    v_add_u32 v5, 16896, v5
    v_mfma_f32_16x16x32_bf16 v[128:131], v[56:59], v[80:83], v[128:131]
    s_mov_b32 s54, 33947648
    v_mfma_f32_16x16x32_bf16 v[132:135], v[56:59], v[84:87], v[132:135]
    ds_read_b64_tr_b16 v[56:57], v5 offset:4224
    s_mov_b32 s53, 33951744
    v_mfma_f32_16x16x32_bf16 v[132:135], v[40:43], v[76:79], v[132:135]
    ds_read_b64_tr_b16 v[58:59], v5 offset:4480
    s_waitcnt lgkmcnt(10)
    v_mfma_f32_16x16x32_bf16 v[148:151], v[44:47], v[76:79], v[148:151]
    ds_read_b64_tr_b16 v[40:41], v5 offset:0
    buffer_load_dwordx4 v[152:155], v1, s[20:23], s54 offen offset:0 sc1
    v_mfma_f32_16x16x32_bf16 v[148:151], v[60:63], v[84:87], v[148:151]
    ds_read_b64_tr_b16 v[42:43], v5 offset:256
    v_mfma_f32_16x16x32_bf16 v[144:147], v[60:63], v[80:83], v[144:147]
    ds_read_b64_tr_b16 v[60:61], v5 offset:4256
    buffer_load_dwordx4 v[156:159], v1, s[20:23], s53 offen offset:0 sc1
    v_mfma_f32_16x16x32_bf16 v[144:147], v[44:47], v[72:75], v[144:147]
    ds_read_b64_tr_b16 v[62:63], v5 offset:4512
    s_waitcnt lgkmcnt(10)
    v_mfma_f32_16x16x32_bf16 v[160:163], v[48:51], v[72:75], v[160:163]
    ds_read_b64_tr_b16 v[44:45], v5 offset:32
    v_mfma_f32_16x16x32_bf16 v[160:163], v[64:67], v[80:83], v[160:163]
    ds_read_b64_tr_b16 v[46:47], v5 offset:288
    buffer_load_dwordx4 v[184:187], v1, s[20:23], s54 offen offset:2048 sc1
    v_mfma_f32_16x16x32_bf16 v[164:167], v[64:67], v[84:87], v[164:167]
    ds_read_b64_tr_b16 v[64:65], v5 offset:4288
    v_mfma_f32_16x16x32_bf16 v[164:167], v[48:51], v[76:79], v[164:167]
    ds_read_b64_tr_b16 v[66:67], v5 offset:4544
    s_waitcnt lgkmcnt(10)
    v_mfma_f32_16x16x32_bf16 v[180:183], v[52:55], v[76:79], v[180:183]
    ds_read_b64_tr_b16 v[48:49], v5 offset:64
    v_mfma_f32_16x16x32_bf16 v[180:183], v[68:71], v[84:87], v[180:183]
    ds_read_b64_tr_b16 v[50:51], v5 offset:320
    buffer_load_dwordx4 v[188:191], v1, s[20:23], s53 offen offset:2048 sc1
    v_mfma_f32_16x16x32_bf16 v[176:179], v[68:71], v[80:83], v[176:179]
    ds_read_b64_tr_b16 v[68:69], v5 offset:4320
    ds_read_b64_tr_b16 v[70:71], v5 offset:4576
    v_mfma_f32_16x16x32_bf16 v[176:179], v[52:55], v[72:75], v[176:179]
    ds_read_b64_tr_b16 v[52:53], v5 offset:96
    ds_read_b64_tr_b16 v[54:55], v5 offset:352
    s_waitcnt lgkmcnt(12)
    v_mfma_f32_16x16x32_bf16 v[128:131], v[40:43], v[24:27], v[128:131]
    v_add_u32 v5, 16896, v5
    v_mfma_f32_16x16x32_bf16 v[128:131], v[56:59], v[32:35], v[128:131]
    s_mov_b32 s54, 34078720
    v_mfma_f32_16x16x32_bf16 v[132:135], v[56:59], v[36:39], v[132:135]
    ds_read_b64_tr_b16 v[56:57], v5 offset:4224
    s_mov_b32 s53, 34082816
    v_mfma_f32_16x16x32_bf16 v[132:135], v[40:43], v[28:31], v[132:135]
    ds_read_b64_tr_b16 v[58:59], v5 offset:4480
    s_waitcnt lgkmcnt(10)
    v_mfma_f32_16x16x32_bf16 v[148:151], v[44:47], v[28:31], v[148:151]
    ds_read_b64_tr_b16 v[40:41], v5 offset:0
    buffer_load_dwordx4 v[136:139], v1, s[20:23], s54 offen offset:0 sc1
    v_mfma_f32_16x16x32_bf16 v[148:151], v[60:63], v[36:39], v[148:151]
    ds_read_b64_tr_b16 v[42:43], v5 offset:256
    v_mfma_f32_16x16x32_bf16 v[144:147], v[60:63], v[32:35], v[144:147]
    ds_read_b64_tr_b16 v[60:61], v5 offset:4256
    buffer_load_dwordx4 v[140:143], v1, s[20:23], s53 offen offset:0 sc1
    v_mfma_f32_16x16x32_bf16 v[144:147], v[44:47], v[24:27], v[144:147]
    ds_read_b64_tr_b16 v[62:63], v5 offset:4512
    s_waitcnt lgkmcnt(10)
    v_mfma_f32_16x16x32_bf16 v[160:163], v[48:51], v[24:27], v[160:163]
    ds_read_b64_tr_b16 v[44:45], v5 offset:32
    v_mfma_f32_16x16x32_bf16 v[160:163], v[64:67], v[32:35], v[160:163]
    ds_read_b64_tr_b16 v[46:47], v5 offset:288
    buffer_load_dwordx4 v[168:171], v1, s[20:23], s54 offen offset:2048 sc1
    v_mfma_f32_16x16x32_bf16 v[164:167], v[64:67], v[36:39], v[164:167]
    ds_read_b64_tr_b16 v[64:65], v5 offset:4288
    v_mfma_f32_16x16x32_bf16 v[164:167], v[48:51], v[28:31], v[164:167]
    ds_read_b64_tr_b16 v[66:67], v5 offset:4544
    s_waitcnt lgkmcnt(10)
    v_mfma_f32_16x16x32_bf16 v[180:183], v[52:55], v[28:31], v[180:183]
    ds_read_b64_tr_b16 v[48:49], v5 offset:64
    v_mfma_f32_16x16x32_bf16 v[180:183], v[68:71], v[36:39], v[180:183]
    ds_read_b64_tr_b16 v[50:51], v5 offset:320
    buffer_load_dwordx4 v[172:175], v1, s[20:23], s53 offen offset:2048 sc1
    v_mfma_f32_16x16x32_bf16 v[176:179], v[68:71], v[32:35], v[176:179]
    ds_read_b64_tr_b16 v[68:69], v5 offset:4320
    ds_read_b64_tr_b16 v[70:71], v5 offset:4576
    v_mfma_f32_16x16x32_bf16 v[176:179], v[52:55], v[24:27], v[176:179]
    ds_read_b64_tr_b16 v[52:53], v5 offset:96
    ds_read_b64_tr_b16 v[54:55], v5 offset:352
    s_waitcnt vmcnt(11)
    s_mov_b64 exec, 1
    buffer_store_dword v6, off, s[20:23], s59 sc1
    s_mov_b64 exec, -1
    v_mov_b32 v6, 4
    s_waitcnt lgkmcnt(12)
    v_mfma_f32_16x16x32_bf16 v[128:131], v[40:43], v[112:115], v[128:131]
    v_add_u32 v5, 8448, v5
    v_mfma_f32_16x16x32_bf16 v[128:131], v[56:59], v[120:123], v[128:131]
    s_mov_b32 s54, 34209792
    v_mfma_f32_16x16x32_bf16 v[132:135], v[56:59], v[124:127], v[132:135]
    ds_read_b64_tr_b16 v[56:57], v5 offset:4224
    s_mov_b32 s53, 34213888
    v_mfma_f32_16x16x32_bf16 v[132:135], v[40:43], v[116:119], v[132:135]
    ds_read_b64_tr_b16 v[58:59], v5 offset:4480
    s_waitcnt lgkmcnt(10)
    v_mfma_f32_16x16x32_bf16 v[148:151], v[44:47], v[116:119], v[148:151]
    ds_read_b64_tr_b16 v[40:41], v5 offset:0
    buffer_load_dwordx4 v[8:11], v1, s[20:23], s54 offen offset:0 sc1
    v_mfma_f32_16x16x32_bf16 v[148:151], v[60:63], v[124:127], v[148:151]
    ds_read_b64_tr_b16 v[42:43], v5 offset:256
    v_mfma_f32_16x16x32_bf16 v[144:147], v[60:63], v[120:123], v[144:147]
    ds_read_b64_tr_b16 v[60:61], v5 offset:4256
    buffer_load_dwordx4 v[12:15], v1, s[20:23], s53 offen offset:0 sc1
    v_mfma_f32_16x16x32_bf16 v[144:147], v[44:47], v[112:115], v[144:147]
    ds_read_b64_tr_b16 v[62:63], v5 offset:4512
    s_waitcnt lgkmcnt(10)
    v_mfma_f32_16x16x32_bf16 v[160:163], v[48:51], v[112:115], v[160:163]
    ds_read_b64_tr_b16 v[44:45], v5 offset:32
    v_mfma_f32_16x16x32_bf16 v[160:163], v[64:67], v[120:123], v[160:163]
    ds_read_b64_tr_b16 v[46:47], v5 offset:288
    buffer_load_dwordx4 v[16:19], v1, s[20:23], s54 offen offset:2048 sc1
    v_mfma_f32_16x16x32_bf16 v[164:167], v[64:67], v[124:127], v[164:167]
    ds_read_b64_tr_b16 v[64:65], v5 offset:4288
    v_mfma_f32_16x16x32_bf16 v[164:167], v[48:51], v[116:119], v[164:167]
    ds_read_b64_tr_b16 v[66:67], v5 offset:4544
    s_waitcnt lgkmcnt(10)
    v_mfma_f32_16x16x32_bf16 v[180:183], v[52:55], v[116:119], v[180:183]
    ds_read_b64_tr_b16 v[48:49], v5 offset:64
    v_mfma_f32_16x16x32_bf16 v[180:183], v[68:71], v[124:127], v[180:183]
    ds_read_b64_tr_b16 v[50:51], v5 offset:320
    buffer_load_dwordx4 v[20:23], v1, s[20:23], s53 offen offset:2048 sc1
    v_mfma_f32_16x16x32_bf16 v[176:179], v[68:71], v[120:123], v[176:179]
    ds_read_b64_tr_b16 v[68:69], v5 offset:4320
    ds_read_b64_tr_b16 v[70:71], v5 offset:4576
    v_mfma_f32_16x16x32_bf16 v[176:179], v[52:55], v[112:115], v[176:179]
    ds_read_b64_tr_b16 v[52:53], v5 offset:96
    ds_read_b64_tr_b16 v[54:55], v5 offset:352
    s_waitcnt lgkmcnt(12)
    v_mfma_f32_16x16x32_bf16 v[128:131], v[40:43], v[216:219], v[128:131]
    v_add_u32 v5, 8448, v5
    v_mfma_f32_16x16x32_bf16 v[128:131], v[56:59], v[248:251], v[128:131]
    s_mov_b32 s54, 34340864
    v_mfma_f32_16x16x32_bf16 v[132:135], v[56:59], v[252:255], v[132:135]
    ds_read_b64_tr_b16 v[56:57], v5 offset:4224
    s_mov_b32 s53, 34344960
    v_mfma_f32_16x16x32_bf16 v[132:135], v[40:43], v[220:223], v[132:135]
    ds_read_b64_tr_b16 v[58:59], v5 offset:4480
    s_waitcnt lgkmcnt(10)
    v_mfma_f32_16x16x32_bf16 v[148:151], v[44:47], v[220:223], v[148:151]
    ds_read_b64_tr_b16 v[40:41], v5 offset:0
    buffer_load_dwordx4 v[96:99], v1, s[20:23], s54 offen offset:0 sc1
    v_mfma_f32_16x16x32_bf16 v[148:151], v[60:63], v[252:255], v[148:151]
    ds_read_b64_tr_b16 v[42:43], v5 offset:256
    v_mfma_f32_16x16x32_bf16 v[144:147], v[60:63], v[248:251], v[144:147]
    ds_read_b64_tr_b16 v[60:61], v5 offset:4256
    buffer_load_dwordx4 v[100:103], v1, s[20:23], s53 offen offset:0 sc1
    v_mfma_f32_16x16x32_bf16 v[144:147], v[44:47], v[216:219], v[144:147]
    ds_read_b64_tr_b16 v[62:63], v5 offset:4512
    s_waitcnt lgkmcnt(10)
    v_mfma_f32_16x16x32_bf16 v[160:163], v[48:51], v[216:219], v[160:163]
    ds_read_b64_tr_b16 v[44:45], v5 offset:32
    v_mfma_f32_16x16x32_bf16 v[160:163], v[64:67], v[248:251], v[160:163]
    ds_read_b64_tr_b16 v[46:47], v5 offset:288
    buffer_load_dwordx4 v[104:107], v1, s[20:23], s54 offen offset:2048 sc1
    v_mfma_f32_16x16x32_bf16 v[164:167], v[64:67], v[252:255], v[164:167]
    ds_read_b64_tr_b16 v[64:65], v5 offset:4288
    v_mfma_f32_16x16x32_bf16 v[164:167], v[48:51], v[220:223], v[164:167]
    ds_read_b64_tr_b16 v[66:67], v5 offset:4544
    s_waitcnt lgkmcnt(10)
    v_mfma_f32_16x16x32_bf16 v[180:183], v[52:55], v[220:223], v[180:183]
    ds_read_b64_tr_b16 v[48:49], v5 offset:64
    v_mfma_f32_16x16x32_bf16 v[180:183], v[68:71], v[252:255], v[180:183]
    ds_read_b64_tr_b16 v[50:51], v5 offset:320
    buffer_load_dwordx4 v[108:111], v1, s[20:23], s53 offen offset:2048 sc1
    v_mfma_f32_16x16x32_bf16 v[176:179], v[68:71], v[248:251], v[176:179]
    ds_read_b64_tr_b16 v[68:69], v5 offset:4320
    ds_read_b64_tr_b16 v[70:71], v5 offset:4576
    v_mfma_f32_16x16x32_bf16 v[176:179], v[52:55], v[216:219], v[176:179]
    ds_read_b64_tr_b16 v[52:53], v5 offset:96
    ds_read_b64_tr_b16 v[54:55], v5 offset:352
    s_waitcnt vmcnt(18)
    s_waitcnt lgkmcnt(12)
    v_mfma_f32_16x16x32_bf16 v[128:131], v[40:43], v[200:203], v[128:131]
    v_add_u32 v5, 8448, v5
    v_mfma_f32_16x16x32_bf16 v[128:131], v[56:59], v[232:235], v[128:131]
    s_mov_b32 s54, 34471936
    v_mfma_f32_16x16x32_bf16 v[132:135], v[56:59], v[236:239], v[132:135]
    ds_read_b64_tr_b16 v[56:57], v5 offset:4224
    s_mov_b32 s53, 34476032
    v_mfma_f32_16x16x32_bf16 v[132:135], v[40:43], v[204:207], v[132:135]
    ds_read_b64_tr_b16 v[58:59], v5 offset:4480
    s_waitcnt lgkmcnt(10)
    v_mfma_f32_16x16x32_bf16 v[148:151], v[44:47], v[204:207], v[148:151]
    ds_read_b64_tr_b16 v[40:41], v5 offset:0
    buffer_load_dwordx4 v[72:75], v1, s[20:23], s54 offen offset:0 sc1
    v_mfma_f32_16x16x32_bf16 v[148:151], v[60:63], v[236:239], v[148:151]
    ds_read_b64_tr_b16 v[42:43], v5 offset:256
    v_mfma_f32_16x16x32_bf16 v[144:147], v[60:63], v[232:235], v[144:147]
    ds_read_b64_tr_b16 v[60:61], v5 offset:4256
    buffer_load_dwordx4 v[76:79], v1, s[20:23], s53 offen offset:0 sc1
    v_mfma_f32_16x16x32_bf16 v[144:147], v[44:47], v[200:203], v[144:147]
    ds_read_b64_tr_b16 v[62:63], v5 offset:4512
    s_waitcnt lgkmcnt(10)
    v_mfma_f32_16x16x32_bf16 v[160:163], v[48:51], v[200:203], v[160:163]
    ds_read_b64_tr_b16 v[44:45], v5 offset:32
    v_mfma_f32_16x16x32_bf16 v[160:163], v[64:67], v[232:235], v[160:163]
    ds_read_b64_tr_b16 v[46:47], v5 offset:288
    buffer_load_dwordx4 v[80:83], v1, s[20:23], s54 offen offset:2048 sc1
    v_mfma_f32_16x16x32_bf16 v[164:167], v[64:67], v[236:239], v[164:167]
    ds_read_b64_tr_b16 v[64:65], v5 offset:4288
    v_mfma_f32_16x16x32_bf16 v[164:167], v[48:51], v[204:207], v[164:167]
    ds_read_b64_tr_b16 v[66:67], v5 offset:4544
    s_waitcnt lgkmcnt(10)
    v_mfma_f32_16x16x32_bf16 v[180:183], v[52:55], v[204:207], v[180:183]
    ds_read_b64_tr_b16 v[48:49], v5 offset:64
    v_mfma_f32_16x16x32_bf16 v[180:183], v[68:71], v[236:239], v[180:183]
    ds_read_b64_tr_b16 v[50:51], v5 offset:320
    buffer_load_dwordx4 v[84:87], v1, s[20:23], s53 offen offset:2048 sc1
    v_mfma_f32_16x16x32_bf16 v[176:179], v[68:71], v[232:235], v[176:179]
    ds_read_b64_tr_b16 v[68:69], v5 offset:4320
    ds_read_b64_tr_b16 v[70:71], v5 offset:4576
    v_mfma_f32_16x16x32_bf16 v[176:179], v[52:55], v[200:203], v[176:179]
    ds_read_b64_tr_b16 v[52:53], v5 offset:96
    ds_read_b64_tr_b16 v[54:55], v5 offset:352
    s_waitcnt vmcnt(17)
    s_waitcnt lgkmcnt(12)
    v_mfma_f32_16x16x32_bf16 v[128:131], v[40:43], v[152:155], v[128:131]
    v_add_u32 v5, 8448, v5
    v_mfma_f32_16x16x32_bf16 v[128:131], v[56:59], v[184:187], v[128:131]
    v_mfma_f32_16x16x32_bf16 v[132:135], v[56:59], v[188:191], v[132:135]
    ds_read_b64_tr_b16 v[56:57], v5 offset:4224
    v_mfma_f32_16x16x32_bf16 v[132:135], v[40:43], v[156:159], v[132:135]
    ds_read_b64_tr_b16 v[58:59], v5 offset:4480
    s_waitcnt lgkmcnt(10)
    v_mfma_f32_16x16x32_bf16 v[148:151], v[44:47], v[156:159], v[148:151]
    ds_read_b64_tr_b16 v[40:41], v5 offset:0
    v_mfma_f32_16x16x32_bf16 v[148:151], v[60:63], v[188:191], v[148:151]
    ds_read_b64_tr_b16 v[42:43], v5 offset:256
    v_mfma_f32_16x16x32_bf16 v[144:147], v[60:63], v[184:187], v[144:147]
    ds_read_b64_tr_b16 v[60:61], v5 offset:4256
    v_mfma_f32_16x16x32_bf16 v[144:147], v[44:47], v[152:155], v[144:147]
    ds_read_b64_tr_b16 v[62:63], v5 offset:4512
    s_waitcnt lgkmcnt(10)
    v_mfma_f32_16x16x32_bf16 v[160:163], v[48:51], v[152:155], v[160:163]
    ds_read_b64_tr_b16 v[44:45], v5 offset:32
    v_mfma_f32_16x16x32_bf16 v[160:163], v[64:67], v[184:187], v[160:163]
    ds_read_b64_tr_b16 v[46:47], v5 offset:288
    v_mfma_f32_16x16x32_bf16 v[164:167], v[64:67], v[188:191], v[164:167]
    ds_read_b64_tr_b16 v[64:65], v5 offset:4288
    v_mfma_f32_16x16x32_bf16 v[164:167], v[48:51], v[156:159], v[164:167]
    ds_read_b64_tr_b16 v[66:67], v5 offset:4544
    s_waitcnt lgkmcnt(10)
    v_mfma_f32_16x16x32_bf16 v[180:183], v[52:55], v[156:159], v[180:183]
    ds_read_b64_tr_b16 v[48:49], v5 offset:64
    v_mfma_f32_16x16x32_bf16 v[180:183], v[68:71], v[188:191], v[180:183]
    ds_read_b64_tr_b16 v[50:51], v5 offset:320
    v_mfma_f32_16x16x32_bf16 v[176:179], v[68:71], v[184:187], v[176:179]
    ds_read_b64_tr_b16 v[68:69], v5 offset:4320
    ds_read_b64_tr_b16 v[70:71], v5 offset:4576
    v_mfma_f32_16x16x32_bf16 v[176:179], v[52:55], v[152:155], v[176:179]
    ds_read_b64_tr_b16 v[52:53], v5 offset:96
    ds_read_b64_tr_b16 v[54:55], v5 offset:352
    s_waitcnt vmcnt(13)
    s_waitcnt lgkmcnt(12)
    v_mfma_f32_16x16x32_bf16 v[128:131], v[40:43], v[136:139], v[128:131]
    v_add_u32 v5, 8448, v5
    v_mfma_f32_16x16x32_bf16 v[128:131], v[56:59], v[168:171], v[128:131]
    v_mfma_f32_16x16x32_bf16 v[132:135], v[56:59], v[172:175], v[132:135]
    ds_read_b64_tr_b16 v[56:57], v5 offset:4224
    v_mfma_f32_16x16x32_bf16 v[132:135], v[40:43], v[140:143], v[132:135]
    ds_read_b64_tr_b16 v[58:59], v5 offset:4480
    s_waitcnt lgkmcnt(10)
    v_mfma_f32_16x16x32_bf16 v[148:151], v[44:47], v[140:143], v[148:151]
    ds_read_b64_tr_b16 v[40:41], v5 offset:0
    v_mfma_f32_16x16x32_bf16 v[148:151], v[60:63], v[172:175], v[148:151]
    ds_read_b64_tr_b16 v[42:43], v5 offset:256
    v_mfma_f32_16x16x32_bf16 v[144:147], v[60:63], v[168:171], v[144:147]
    ds_read_b64_tr_b16 v[60:61], v5 offset:4256
    v_mfma_f32_16x16x32_bf16 v[144:147], v[44:47], v[136:139], v[144:147]
    ds_read_b64_tr_b16 v[62:63], v5 offset:4512
    s_waitcnt lgkmcnt(10)
    v_mfma_f32_16x16x32_bf16 v[160:163], v[48:51], v[136:139], v[160:163]
    ds_read_b64_tr_b16 v[44:45], v5 offset:32
    v_mfma_f32_16x16x32_bf16 v[160:163], v[64:67], v[168:171], v[160:163]
    ds_read_b64_tr_b16 v[46:47], v5 offset:288
    v_mfma_f32_16x16x32_bf16 v[164:167], v[64:67], v[172:175], v[164:167]
    ds_read_b64_tr_b16 v[64:65], v5 offset:4288
    v_mfma_f32_16x16x32_bf16 v[164:167], v[48:51], v[140:143], v[164:167]
    ds_read_b64_tr_b16 v[66:67], v5 offset:4544
    s_waitcnt lgkmcnt(10)
    v_mfma_f32_16x16x32_bf16 v[180:183], v[52:55], v[140:143], v[180:183]
    ds_read_b64_tr_b16 v[48:49], v5 offset:64
    v_mfma_f32_16x16x32_bf16 v[180:183], v[68:71], v[172:175], v[180:183]
    ds_read_b64_tr_b16 v[50:51], v5 offset:320
    v_mfma_f32_16x16x32_bf16 v[176:179], v[68:71], v[168:171], v[176:179]
    ds_read_b64_tr_b16 v[68:69], v5 offset:4320
    ds_read_b64_tr_b16 v[70:71], v5 offset:4576
    v_mfma_f32_16x16x32_bf16 v[176:179], v[52:55], v[136:139], v[176:179]
    ds_read_b64_tr_b16 v[52:53], v5 offset:96
    ds_read_b64_tr_b16 v[54:55], v5 offset:352
    s_waitcnt vmcnt(8)
    s_waitcnt lgkmcnt(12)
    v_mfma_f32_16x16x32_bf16 v[128:131], v[40:43], v[8:11], v[128:131]
    v_add_u32 v5, 8448, v5
    v_mfma_f32_16x16x32_bf16 v[128:131], v[56:59], v[16:19], v[128:131]
    v_mfma_f32_16x16x32_bf16 v[132:135], v[56:59], v[20:23], v[132:135]
    ds_read_b64_tr_b16 v[56:57], v5 offset:4224
    v_mfma_f32_16x16x32_bf16 v[132:135], v[40:43], v[12:15], v[132:135]
    ds_read_b64_tr_b16 v[58:59], v5 offset:4480
    s_waitcnt lgkmcnt(10)
    v_mfma_f32_16x16x32_bf16 v[148:151], v[44:47], v[12:15], v[148:151]
    ds_read_b64_tr_b16 v[40:41], v5 offset:0
    v_mfma_f32_16x16x32_bf16 v[148:151], v[60:63], v[20:23], v[148:151]
    ds_read_b64_tr_b16 v[42:43], v5 offset:256
    v_mfma_f32_16x16x32_bf16 v[144:147], v[60:63], v[16:19], v[144:147]
    ds_read_b64_tr_b16 v[60:61], v5 offset:4256
    v_mfma_f32_16x16x32_bf16 v[144:147], v[44:47], v[8:11], v[144:147]
    ds_read_b64_tr_b16 v[62:63], v5 offset:4512
    s_waitcnt lgkmcnt(10)
    v_mfma_f32_16x16x32_bf16 v[160:163], v[48:51], v[8:11], v[160:163]
    ds_read_b64_tr_b16 v[44:45], v5 offset:32
    v_mfma_f32_16x16x32_bf16 v[160:163], v[64:67], v[16:19], v[160:163]
    ds_read_b64_tr_b16 v[46:47], v5 offset:288
    v_mfma_f32_16x16x32_bf16 v[164:167], v[64:67], v[20:23], v[164:167]
    ds_read_b64_tr_b16 v[64:65], v5 offset:4288
    v_mfma_f32_16x16x32_bf16 v[164:167], v[48:51], v[12:15], v[164:167]
    ds_read_b64_tr_b16 v[66:67], v5 offset:4544
    s_waitcnt lgkmcnt(10)
    v_mfma_f32_16x16x32_bf16 v[180:183], v[52:55], v[12:15], v[180:183]
    ds_read_b64_tr_b16 v[48:49], v5 offset:64
    v_mfma_f32_16x16x32_bf16 v[180:183], v[68:71], v[20:23], v[180:183]
    ds_read_b64_tr_b16 v[50:51], v5 offset:320
    v_mfma_f32_16x16x32_bf16 v[176:179], v[68:71], v[16:19], v[176:179]
    ds_read_b64_tr_b16 v[68:69], v5 offset:4320
    ds_read_b64_tr_b16 v[70:71], v5 offset:4576
    v_mfma_f32_16x16x32_bf16 v[176:179], v[52:55], v[8:11], v[176:179]
    ds_read_b64_tr_b16 v[52:53], v5 offset:96
    ds_read_b64_tr_b16 v[54:55], v5 offset:352
    s_waitcnt vmcnt(4)
    s_waitcnt lgkmcnt(12)
    v_mfma_f32_16x16x32_bf16 v[128:131], v[40:43], v[96:99], v[128:131]
    v_add_u32 v5, 8448, v5
    v_mfma_f32_16x16x32_bf16 v[128:131], v[56:59], v[104:107], v[128:131]
    v_mfma_f32_16x16x32_bf16 v[132:135], v[56:59], v[108:111], v[132:135]
    ds_read_b64_tr_b16 v[56:57], v5 offset:4224
    v_mfma_f32_16x16x32_bf16 v[132:135], v[40:43], v[100:103], v[132:135]
    ds_read_b64_tr_b16 v[58:59], v5 offset:4480
    s_waitcnt lgkmcnt(10)
    v_mfma_f32_16x16x32_bf16 v[148:151], v[44:47], v[100:103], v[148:151]
    ds_read_b64_tr_b16 v[40:41], v5 offset:0
    v_mfma_f32_16x16x32_bf16 v[148:151], v[60:63], v[108:111], v[148:151]
    ds_read_b64_tr_b16 v[42:43], v5 offset:256
    v_mfma_f32_16x16x32_bf16 v[144:147], v[60:63], v[104:107], v[144:147]
    ds_read_b64_tr_b16 v[60:61], v5 offset:4256
    v_mfma_f32_16x16x32_bf16 v[144:147], v[44:47], v[96:99], v[144:147]
    ds_read_b64_tr_b16 v[62:63], v5 offset:4512
    s_waitcnt lgkmcnt(10)
    v_mfma_f32_16x16x32_bf16 v[160:163], v[48:51], v[96:99], v[160:163]
    ds_read_b64_tr_b16 v[44:45], v5 offset:32
    v_mfma_f32_16x16x32_bf16 v[160:163], v[64:67], v[104:107], v[160:163]
    ds_read_b64_tr_b16 v[46:47], v5 offset:288
    v_mfma_f32_16x16x32_bf16 v[164:167], v[64:67], v[108:111], v[164:167]
    ds_read_b64_tr_b16 v[64:65], v5 offset:4288
    v_mfma_f32_16x16x32_bf16 v[164:167], v[48:51], v[100:103], v[164:167]
    ds_read_b64_tr_b16 v[66:67], v5 offset:4544
    s_waitcnt lgkmcnt(10)
    v_mfma_f32_16x16x32_bf16 v[180:183], v[52:55], v[100:103], v[180:183]
    ds_read_b64_tr_b16 v[48:49], v5 offset:64
    v_mfma_f32_16x16x32_bf16 v[180:183], v[68:71], v[108:111], v[180:183]
    ds_read_b64_tr_b16 v[50:51], v5 offset:320
    v_mfma_f32_16x16x32_bf16 v[176:179], v[68:71], v[104:107], v[176:179]
    ds_read_b64_tr_b16 v[68:69], v5 offset:4320
    ds_read_b64_tr_b16 v[70:71], v5 offset:4576
    v_mfma_f32_16x16x32_bf16 v[176:179], v[52:55], v[96:99], v[176:179]
    ds_read_b64_tr_b16 v[52:53], v5 offset:96
    ds_read_b64_tr_b16 v[54:55], v5 offset:352
    s_waitcnt vmcnt(0)
    s_waitcnt lgkmcnt(12)
    v_mfma_f32_16x16x32_bf16 v[128:131], v[40:43], v[72:75], v[128:131]
    v_mfma_f32_16x16x32_bf16 v[128:131], v[56:59], v[80:83], v[128:131]
    v_mfma_f32_16x16x32_bf16 v[132:135], v[56:59], v[84:87], v[132:135]
    v_mfma_f32_16x16x32_bf16 v[132:135], v[40:43], v[76:79], v[132:135]
    s_waitcnt lgkmcnt(8)
    v_mfma_f32_16x16x32_bf16 v[148:151], v[44:47], v[76:79], v[148:151]
    v_mfma_f32_16x16x32_bf16 v[148:151], v[60:63], v[84:87], v[148:151]
    v_mfma_f32_16x16x32_bf16 v[144:147], v[60:63], v[80:83], v[144:147]
    v_mfma_f32_16x16x32_bf16 v[144:147], v[44:47], v[72:75], v[144:147]
    s_waitcnt lgkmcnt(4)
    v_mfma_f32_16x16x32_bf16 v[160:163], v[48:51], v[72:75], v[160:163]
    v_mfma_f32_16x16x32_bf16 v[160:163], v[64:67], v[80:83], v[160:163]
    v_mfma_f32_16x16x32_bf16 v[164:167], v[64:67], v[84:87], v[164:167]
    v_mfma_f32_16x16x32_bf16 v[164:167], v[48:51], v[76:79], v[164:167]
    s_waitcnt lgkmcnt(0)
    v_mfma_f32_16x16x32_bf16 v[180:183], v[52:55], v[76:79], v[180:183]
    v_mfma_f32_16x16x32_bf16 v[180:183], v[68:71], v[84:87], v[180:183]
    v_mfma_f32_16x16x32_bf16 v[176:179], v[68:71], v[80:83], v[176:179]
    v_mfma_f32_16x16x32_bf16 v[176:179], v[52:55], v[72:75], v[176:179]
    s_barrier
    ds_read_b128 v[208:211], v2 offset:0
    ds_read_b128 v[24:27], v3 offset:0
    ds_read_b128 v[192:195], v3 offset:4096
    ds_read_b128 v[212:215], v2 offset:1024
    ds_read_b128 v[28:31], v3 offset:1024
    ds_read_b128 v[196:199], v3 offset:5120
    ds_read_b128 v[240:243], v2 offset:2048
    ds_read_b128 v[32:35], v3 offset:2048
    ds_read_b128 v[224:227], v3 offset:6144
    ds_read_b128 v[244:247], v2 offset:3072
    ds_read_b128 v[36:39], v3 offset:3072
    ds_read_b128 v[228:231], v3 offset:7168
    s_mul_i32 s56, s3, 4608
    s_add_u32 s56, s56, 33792
    v_and_b32 v1, 15, v0
    v_mul_u32_u24 v1, 144, v1
    v_lshrrev_b32 v5, 4, v0
    v_lshlrev_b32 v5, 3, v5
    v_add3_u32 v1, v1, v5, s56
    v_lshrrev_b32 v5, 3, v0
    v_mul_u32_u24 v5, 144, v5
    v_and_b32 v6, 0x70, v4
    v_add3_u32 v5, v5, v6, s56
    s_waitcnt lgkmcnt(9)
    v_mfma_f32_16x16x32_bf16 v[128:131], v[90:93], v[208:211], v[128:131]
    v_mfma_f32_16x16x32_bf16 v[128:131], v[90:93], v[24:27], v[128:131]
    v_mfma_f32_16x16x32_bf16 v[128:131], v[90:93], v[192:195], v[128:131]
    v_mfma_f32_16x16x32_bf16 v[144:147], v[88:91], v[208:211], v[144:147]
    v_mfma_f32_16x16x32_bf16 v[144:147], v[88:91], v[24:27], v[144:147]
    v_mfma_f32_16x16x32_bf16 v[144:147], v[88:91], v[192:195], v[144:147]
    s_waitcnt lgkmcnt(6)
    v_mfma_f32_16x16x32_bf16 v[160:163], v[90:93], v[212:215], v[160:163]
    v_mfma_f32_16x16x32_bf16 v[160:163], v[90:93], v[28:31], v[160:163]
    v_mfma_f32_16x16x32_bf16 v[160:163], v[90:93], v[196:199], v[160:163]
    v_mfma_f32_16x16x32_bf16 v[176:179], v[88:91], v[212:215], v[176:179]
    v_mfma_f32_16x16x32_bf16 v[176:179], v[88:91], v[28:31], v[176:179]
    v_mfma_f32_16x16x32_bf16 v[176:179], v[88:91], v[196:199], v[176:179]
    s_waitcnt lgkmcnt(3)
    v_mfma_f32_16x16x32_bf16 v[132:135], v[90:93], v[240:243], v[132:135]
    v_pk_mul_f32 v[128:129], v[128:129], v[94:95] op_sel:[0,0] op_sel_hi:[1,0]
    v_pk_mul_f32 v[130:131], v[130:131], v[94:95] op_sel:[0,0] op_sel_hi:[1,0]
    v_mfma_f32_16x16x32_bf16 v[132:135], v[90:93], v[32:35], v[132:135]
    v_pk_mul_f32 v[144:145], v[144:145], v[94:95] op_sel:[0,0] op_sel_hi:[1,0]
    v_pk_mul_f32 v[146:147], v[146:147], v[94:95] op_sel:[0,0] op_sel_hi:[1,0]
    v_mfma_f32_16x16x32_bf16 v[132:135], v[90:93], v[224:227], v[132:135]
    v_cvt_pk_bf16_f32 v128, v128, v129
    v_cvt_pk_bf16_f32 v129, v130, v131
    v_mfma_f32_16x16x32_bf16 v[148:151], v[88:91], v[240:243], v[148:151]
    v_cvt_pk_bf16_f32 v130, v144, v145
    v_cvt_pk_bf16_f32 v131, v146, v147
    v_mfma_f32_16x16x32_bf16 v[148:151], v[88:91], v[32:35], v[148:151]
    ds_write_b64 v1, v[128:129] offset:0
    ds_write_b64 v1, v[130:131] offset:32
    v_mfma_f32_16x16x32_bf16 v[148:151], v[88:91], v[224:227], v[148:151]
    s_waitcnt lgkmcnt(2)
    v_mfma_f32_16x16x32_bf16 v[164:167], v[90:93], v[244:247], v[164:167]
    v_pk_mul_f32 v[160:161], v[160:161], v[94:95] op_sel:[0,0] op_sel_hi:[1,0]
    v_pk_mul_f32 v[162:163], v[162:163], v[94:95] op_sel:[0,0] op_sel_hi:[1,0]
    v_mfma_f32_16x16x32_bf16 v[164:167], v[90:93], v[36:39], v[164:167]
    v_pk_mul_f32 v[176:177], v[176:177], v[94:95] op_sel:[0,0] op_sel_hi:[1,0]
    v_pk_mul_f32 v[178:179], v[178:179], v[94:95] op_sel:[0,0] op_sel_hi:[1,0]
    v_mfma_f32_16x16x32_bf16 v[164:167], v[90:93], v[228:231], v[164:167]
    v_cvt_pk_bf16_f32 v160, v160, v161
    v_cvt_pk_bf16_f32 v161, v162, v163
    v_mfma_f32_16x16x32_bf16 v[180:183], v[88:91], v[244:247], v[180:183]
    v_cvt_pk_bf16_f32 v162, v176, v177
    v_cvt_pk_bf16_f32 v163, v178, v179
    v_mfma_f32_16x16x32_bf16 v[180:183], v[88:91], v[36:39], v[180:183]
    ds_write_b64 v1, v[160:161] offset:64
    ds_write_b64 v1, v[162:163] offset:96
    v_mfma_f32_16x16x32_bf16 v[180:183], v[88:91], v[228:231], v[180:183]
    ds_read_b128 v[40:43], v5 offset:0
    ds_read_b128 v[44:47], v5 offset:1152
    v_pk_mul_f32 v[132:133], v[132:133], v[94:95] op_sel:[0,1] op_sel_hi:[1,1]
    v_pk_mul_f32 v[134:135], v[134:135], v[94:95] op_sel:[0,1] op_sel_hi:[1,1]
    v_pk_mul_f32 v[148:149], v[148:149], v[94:95] op_sel:[0,1] op_sel_hi:[1,1]
    v_pk_mul_f32 v[150:151], v[150:151], v[94:95] op_sel:[0,1] op_sel_hi:[1,1]
    v_cvt_pk_bf16_f32 v132, v132, v133
    v_cvt_pk_bf16_f32 v133, v134, v135
    v_cvt_pk_bf16_f32 v134, v148, v149
    v_cvt_pk_bf16_f32 v135, v150, v151
    ds_write_b64 v1, v[132:133] offset:2304
    ds_write_b64 v1, v[134:135] offset:2336
    s_waitcnt lgkmcnt(2)
    s_add_u32 s56, s55, 0
    buffer_store_dwordx4 v[40:43], v4, s[28:31], s56 offen sc1
    s_add_u32 s56, s55, 16384
    buffer_store_dwordx4 v[44:47], v4, s[28:31], s56 offen sc1
    v_pk_mul_f32 v[164:165], v[164:165], v[94:95] op_sel:[0,1] op_sel_hi:[1,1]
    v_pk_mul_f32 v[166:167], v[166:167], v[94:95] op_sel:[0,1] op_sel_hi:[1,1]
    v_pk_mul_f32 v[180:181], v[180:181], v[94:95] op_sel:[0,1] op_sel_hi:[1,1]
    v_pk_mul_f32 v[182:183], v[182:183], v[94:95] op_sel:[0,1] op_sel_hi:[1,1]
    v_cvt_pk_bf16_f32 v164, v164, v165
    v_cvt_pk_bf16_f32 v165, v166, v167
    v_cvt_pk_bf16_f32 v166, v180, v181
    v_cvt_pk_bf16_f32 v167, v182, v183
    ds_write_b64 v1, v[164:165] offset:2368
    ds_write_b64 v1, v[166:167] offset:2400
    ds_read_b128 v[48:51], v5 offset:2304
    ds_read_b128 v[52:55], v5 offset:3456
    s_waitcnt lgkmcnt(1)
    s_add_u32 s56, s55, 32768
    buffer_store_dwordx4 v[48:51], v4, s[28:31], s56 offen sc1
    s_waitcnt lgkmcnt(0)
    s_add_u32 s56, s55, 49152
    buffer_store_dwordx4 v[52:55], v4, s[28:31], s56 offen sc1
    s_endpgm
L_exit:
    s_endpgm
L_codeend:
.section .rodata,"a"
.p2align 6
.amdhsa_kernel gated_mix__linear_attn_block__dense_activation_relu__prompt_kernel
  .amdhsa_next_free_vgpr 256
  .amdhsa_next_free_sgpr 102
  .amdhsa_accum_offset 256
  .amdhsa_group_segment_fixed_size 0
  .amdhsa_kernarg_size 80
  .amdhsa_user_sgpr_count 2
  .amdhsa_user_sgpr_kernarg_segment_ptr 1
  .amdhsa_system_sgpr_workgroup_id_x 1
.end_amdhsa_kernel
```
